```python
import torch

def _softmax(x, axis=-1):
    return torch.softmax(x, dim=axis)

def _gelu(x):
    return torch.nn.functional.gelu(x, approximate='tanh')

def _silu(x):
    return torch.nn.functional.silu(x)

def _sigmoid(x):
    return torch.sigmoid(x)

def _layernorm(x, axis=-1, eps=1e-05):
    m = x.mean(dim=axis, keepdim=True)
    v = x.var(dim=axis, keepdim=True, unbiased=False)
    return (x - m) / torch.sqrt(v + eps)

def _scatter_add(tgt, idx, src, axis=0):
    return tgt.clone().index_add_(axis, idx, src)

def _segment_sum(src, seg, n):
    out = torch.zeros((n,) + src.shape[1:], dtype=src.dtype)
    return out.index_add_(0, seg, src)

def _pad(x, pw):
    flat = tuple((v for pair in reversed(pw) for v in pair))
    return torch.nn.functional.pad(x, flat)
kernel_name = 'adaLN_cond__softmax_full_mha__glu_gated_geglu__prompt'

def setup_inputs():

    _w = lambda a: (lambda t: t.to(torch.bfloat16) if t.is_floating_point() else t)(torch.as_tensor(a))

    def _A_setup():
        B, S, D = (1, 2048, 576)
        return {'x': _w((lambda *s: torch.randn(*s, dtype=torch.bfloat16) * 0.05)(B, S, D)), 'wqkv': _w((lambda *s: torch.randn(*s, dtype=torch.bfloat16) * 0.05)(D, 3 * D)), 'wo': _w((lambda *s: torch.randn(*s, dtype=torch.bfloat16) * 0.05)(D, D))}
    _A_in = _A_setup()

    def _B_setup():
        B, S, Dm, Df = (1, 2048, 576, 4608)
        return {'x': _w((lambda *s: torch.randn(*s, dtype=torch.bfloat16) * 0.05)(B, S, Dm)), 'w_gate': _w((lambda *s: torch.randn(*s, dtype=torch.bfloat16) * 0.8)(Dm, Df) * Dm ** (-0.5)), 'w_up': _w((lambda *s: torch.randn(*s, dtype=torch.bfloat16) * 0.8)(Dm, Df) * Dm ** (-0.5)), 'w_down': _w((lambda *s: torch.randn(*s, dtype=torch.bfloat16) * 0.8)(Df, Dm) * Df ** (-0.5))}
    _B_in = _B_setup()
    return {'A_x': _A_in['x'], 'A_wqkv': _A_in['wqkv'], 'A_wo': _A_in['wo'], 'B_x': _B_in['x'], 'B_w_gate': _B_in['w_gate'], 'B_w_up': _B_in['w_up'], 'B_w_down': _B_in['w_down'], 'c': _w((lambda *s: torch.randn(*s, dtype=torch.bfloat16) * 0.1)(1, 576) * 8.0), 'w_mod': _w((lambda *s: torch.randn(*s, dtype=torch.bfloat16) * 0.1)(576, 6 * 576) * 576 ** (-0.5) * 8.0)}

def reference(A_x, A_wqkv, A_wo, B_x, B_w_gate, B_w_up, B_w_down, c, w_mod):

    def _A_ref(x, wqkv, wo):
        B, S, D = x.shape
        H = 32
        Dh = D // H
        qkv = (lambda x, *d: x.permute(*d))((x @ wqkv).reshape(B, S, 3, H, Dh), 2, 0, 3, 1, 4)
        q, k, v = (qkv[0], qkv[1], qkv[2])
        scale = Dh ** (-0.5)
        scores = torch.einsum('bhqd,bhkd->bhqk', q, k) * scale
        p = _softmax(scores, axis=-1)
        o = torch.einsum('bhqk,bhkd->bhqd', p, v)
        return (lambda x, *d: x.permute(*d))(o, 0, 2, 1, 3).reshape(B, S, D) @ wo

    def _B_ref(x, w_gate, w_up, w_down):
        g = torch.einsum('bsd,df->bsf', x, w_gate)
        u = torch.einsum('bsd,df->bsf', x, w_up)
        h = _gelu(g) * u
        return torch.einsum('bsf,fd->bsd', h, w_down)
    x = A_x
    mod = (_silu(c) @ w_mod).reshape(c.shape[0], 6, 1, -1)
    sa, ca, ga, sb, cb, gb = (mod[:, 0].clone(), mod[:, 1].clone(), mod[:, 2].clone(), mod[:, 3].clone(), mod[:, 4].clone(), mod[:, 5].clone())
    h = _layernorm(x, axis=-1) * (1 + ca) + sa
    x = x + ga * _A_ref(h, A_wqkv, A_wo)
    h = _layernorm(x, axis=-1) * (1 + cb) + sb
    x = x + gb * _B_ref(h, B_w_gate, B_w_up, B_w_down)
    return x
```

```asm
; @launch kernel=k0_kernel grid=(190,1,1) block=(256,1,1) lds=38016
; @launch kernel=k1_kernel grid=(256,1,1) block=(256,1,1) lds=152576
; @launch kernel=k2_kernel grid=(256,1,1) block=(512,1,1) lds=163840
; @launch kernel=kf_kernel grid=(256,1,1) block=(256,1,1) lds=148480
.amdgcn_target "amdgcn-amd-amdhsa--gfx950"
.text
.globl k0_kernel
.p2align 8
.type k0_kernel,@function
k0_kernel:
    s_cmp_ge_u32 s2, 190
    s_cbranch_scc1 L0_exit
    s_load_dwordx16 s[4:19], s[0:1], 0
    s_load_dwordx8 s[20:27], s[0:1], 64
    v_lshrrev_b32 v2, 3, v0
    v_and_b32 v3, 7, v0
    v_lshrrev_b32 v1, 6, v0
    s_mul_i32 s58, s2, 0x5556
    s_lshr_b32 s58, s58, 16
    s_mul_i32 s59, s58, 3
    s_sub_u32 s57, s2, s59
    s_mul_i32 s28, s58, 110592
    s_mul_i32 s59, s57, 1152
    s_add_u32 s28, s28, s59
    s_movk_i32 s29, 3456
    s_movk_i32 s30, 128
    v_readfirstlane_b32 s3, v1
    v_mov_b32 v4, v2
    s_sub_u32 s56, s2, 54
    s_mul_i32 s59, s56, 36864
    s_cmp_ge_u32 s2, 54
    s_cselect_b32 s28, s59, s28
    s_cselect_b32 s29, 1152, s29
    s_cmp_lt_u32 s2, 118
    s_cbranch_scc1 L0_ld
    s_cmp_ge_u32 s2, 154
    s_cbranch_scc1 L0_awo
    s_sub_u32 s56, s2, 118
    s_and_b32 s55, s56, 1
    s_lshr_b32 s56, s56, 1
    s_mul_i32 s28, s55, 1990656
    s_lshl_b32 s59, s56, 7
    s_add_u32 s28, s28, s59
    s_movk_i32 s29, 6912
    s_mov_b32 s30, 55296
    v_lshl_add_u32 v4, v1, 6, v2
    s_branch L0_ld
L0_awo:
    s_cmp_ge_u32 s2, 174
    s_cbranch_scc1 L0_pf
    s_sub_u32 s56, s2, 154
    s_mul_i32 s28, s56, 41472
    v_and_b32 v4, 0x13, v2
    v_and_b32 v5, 8, v2
    v_lshrrev_b32 v5, 1, v5
    v_and_b32 v6, 4, v2
    v_lshl_or_b32 v5, v6, 1, v5
    v_lshrrev_b32 v6, 4, v2
    v_lshl_add_u32 v5, v6, 1, v5
    v_add_u32 v4, v4, v5
    s_cmp_lt_u32 s2, 170
    s_cbranch_scc1 L0_ld
    s_sub_u32 s56, s2, 170
    s_mul_i32 s28, s56, 165888
    s_add_u32 s28, s28, 18432
    v_and_b32 v4, 15, v2
    v_lshrrev_b32 v5, 1, v4
    v_lshl_add_u32 v4, v5, 4, v4
L0_ld:
    v_mul_lo_u32 v5, v4, s29
    v_lshl_add_u32 v5, v3, 4, v5
    s_waitcnt lgkmcnt(0)
    s_cmp_ge_u32 s2, 54
    s_cselect_b32 s32, s4, s6
    s_cselect_b32 s33, s5, s7
    s_cselect_b32 s34, 2359296, s29
    s_cbranch_scc1 L0_s1
    s_mov_b32 s34, 1990656
L0_s1:
    s_cmp_ge_u32 s2, 118
    s_cselect_b32 s32, s20, s32
    s_cselect_b32 s33, s21, s33
    s_cselect_b32 s34, 3981312, s34
    s_cmp_ge_u32 s2, 154
    s_cselect_b32 s32, s8, s32
    s_cselect_b32 s33, s9, s33
    s_cselect_b32 s34, 663552, s34
    s_mov_b32 s35, 0x20000
    buffer_load_dwordx4 v[12:15], v5, s[32:35], s28 offen
    s_add_u32 s28, s28, s30
    buffer_load_dwordx4 v[16:19], v5, s[32:35], s28 offen
    s_add_u32 s28, s28, s30
    buffer_load_dwordx4 v[20:23], v5, s[32:35], s28 offen
    s_add_u32 s28, s28, s30
    buffer_load_dwordx4 v[24:27], v5, s[32:35], s28 offen
    s_add_u32 s28, s28, s30
    buffer_load_dwordx4 v[28:31], v5, s[32:35], s28 offen
    s_add_u32 s28, s28, s30
    buffer_load_dwordx4 v[32:35], v5, s[32:35], s28 offen
    s_add_u32 s28, s28, s30
    buffer_load_dwordx4 v[36:39], v5, s[32:35], s28 offen
    s_add_u32 s28, s28, s30
    buffer_load_dwordx4 v[40:43], v5, s[32:35], s28 offen
    s_add_u32 s28, s28, s30
    buffer_load_dwordx4 v[44:47], v5, s[32:35], s28 offen
    v_and_b32 v1, 63, v0
    v_lshlrev_b32 v7, 4, v1
    s_cmp_lt_u32 s2, 54
    s_cbranch_scc1 L0_shuf
    s_cmp_ge_u32 s2, 154
    s_cbranch_scc1 L0_shuf
    s_cmp_ge_u32 s2, 118
    s_cbranch_scc1 L0_gemv
    s_add_u32 s36, s26, 0x100000
    s_addc_u32 s37, s27, 0
    s_mov_b32 s38, 0x240000
    s_mov_b32 s39, 0x20000
    s_add_u32 s52, s26, 0x40000
    s_addc_u32 s53, s27, 0
    s_mov_b32 s54, 0x20000
    s_mov_b32 s55, 0x20000
    v_lshlrev_b32 v8, 3, v0
    v_mov_b32 v10, 0
    v_mov_b32 v11, 0
    s_lshl_b32 s29, s56, 11
    buffer_store_dwordx2 v[10:11], v8, s[52:55], s29 offen
    v_mul_u32_u24 v5, 528, v3
    v_lshl_add_u32 v5, v2, 4, v5
    v_lshrrev_b32 v6, 5, v1
    v_mul_u32_u24 v6, 528, v6
    v_and_b32 v8, 31, v1
    v_lshl_add_u32 v6, v8, 4, v6
    s_mul_i32 s45, s3, 9504
    v_add_u32 v6, s45, v6
    s_mul_i32 s46, s56, 36864
    s_mul_i32 s47, s3, 9216
    s_add_u32 s46, s46, s47
    s_mov_b32 s48, 0x3f803f80
    s_mov_b32 s49, 0x00003f80
    s_mov_b32 s50, 0x3f800000
    v_mov_b32 v8, 0
    v_mov_b32 v9, 0
    s_waitcnt vmcnt(9)
    v_dot2_f32_bf16 v8, v12, s48, v8
    v_dot2_f32_bf16 v9, v13, s48, v9
    v_dot2_f32_bf16 v8, v14, s48, v8
    v_dot2_f32_bf16 v9, v15, s48, v9
    s_waitcnt vmcnt(8)
    v_dot2_f32_bf16 v8, v16, s48, v8
    v_dot2_f32_bf16 v9, v17, s48, v9
    v_dot2_f32_bf16 v8, v18, s48, v8
    v_dot2_f32_bf16 v9, v19, s48, v9
    s_waitcnt vmcnt(7)
    v_dot2_f32_bf16 v8, v20, s48, v8
    v_dot2_f32_bf16 v9, v21, s48, v9
    v_dot2_f32_bf16 v8, v22, s48, v8
    v_dot2_f32_bf16 v9, v23, s48, v9
    s_waitcnt vmcnt(6)
    v_dot2_f32_bf16 v8, v24, s48, v8
    v_dot2_f32_bf16 v9, v25, s48, v9
    v_dot2_f32_bf16 v8, v26, s48, v8
    v_dot2_f32_bf16 v9, v27, s48, v9
    s_waitcnt vmcnt(5)
    v_dot2_f32_bf16 v8, v28, s48, v8
    v_dot2_f32_bf16 v9, v29, s48, v9
    v_dot2_f32_bf16 v8, v30, s48, v8
    v_dot2_f32_bf16 v9, v31, s48, v9
    s_waitcnt vmcnt(4)
    v_dot2_f32_bf16 v8, v32, s48, v8
    v_dot2_f32_bf16 v9, v33, s48, v9
    v_dot2_f32_bf16 v8, v34, s48, v8
    v_dot2_f32_bf16 v9, v35, s48, v9
    s_waitcnt vmcnt(3)
    v_dot2_f32_bf16 v8, v36, s48, v8
    v_dot2_f32_bf16 v9, v37, s48, v9
    v_dot2_f32_bf16 v8, v38, s48, v8
    v_dot2_f32_bf16 v9, v39, s48, v9
    s_waitcnt vmcnt(2)
    v_dot2_f32_bf16 v8, v40, s48, v8
    v_dot2_f32_bf16 v9, v41, s48, v9
    v_dot2_f32_bf16 v8, v42, s48, v8
    v_dot2_f32_bf16 v9, v43, s48, v9
    s_waitcnt vmcnt(1)
    v_dot2_f32_bf16 v8, v44, s48, v8
    v_dot2_f32_bf16 v9, v45, s48, v9
    v_dot2_f32_bf16 v8, v46, s48, v8
    v_dot2_f32_bf16 v9, v47, s48, v9
    s_nop 2
    v_add_f32 v8, v8, v9
    s_nop 1
    v_add_f32_dpp v8, v8, v8 quad_perm:[1,0,3,2] row_mask:0xf bank_mask:0xf
    s_nop 1
    v_add_f32_dpp v8, v8, v8 quad_perm:[2,3,0,1] row_mask:0xf bank_mask:0xf
    s_nop 1
    v_add_f32_dpp v8, v8, v8 row_half_mirror row_mask:0xf bank_mask:0xf
    v_mul_f32 v8, 0xbae38e39, v8
    v_dot2_f32_bf16 v48, v12, s49, v8
    v_dot2_f32_bf16 v49, v12, s50, v8
    v_dot2_f32_bf16 v50, v13, s49, v8
    v_dot2_f32_bf16 v51, v13, s50, v8
    v_dot2_f32_bf16 v52, v14, s49, v8
    v_dot2_f32_bf16 v53, v14, s50, v8
    v_dot2_f32_bf16 v54, v15, s49, v8
    v_dot2_f32_bf16 v55, v15, s50, v8
    v_dot2_f32_bf16 v56, v16, s49, v8
    v_dot2_f32_bf16 v57, v16, s50, v8
    v_dot2_f32_bf16 v58, v17, s49, v8
    v_dot2_f32_bf16 v59, v17, s50, v8
    v_dot2_f32_bf16 v60, v18, s49, v8
    v_dot2_f32_bf16 v61, v18, s50, v8
    v_dot2_f32_bf16 v62, v19, s49, v8
    v_dot2_f32_bf16 v63, v19, s50, v8
    v_dot2_f32_bf16 v64, v20, s49, v8
    v_dot2_f32_bf16 v65, v20, s50, v8
    v_dot2_f32_bf16 v66, v21, s49, v8
    v_dot2_f32_bf16 v67, v21, s50, v8
    v_dot2_f32_bf16 v68, v22, s49, v8
    v_dot2_f32_bf16 v69, v22, s50, v8
    v_dot2_f32_bf16 v70, v23, s49, v8
    v_dot2_f32_bf16 v71, v23, s50, v8
    v_dot2_f32_bf16 v72, v24, s49, v8
    v_dot2_f32_bf16 v73, v24, s50, v8
    v_dot2_f32_bf16 v74, v25, s49, v8
    v_dot2_f32_bf16 v75, v25, s50, v8
    v_dot2_f32_bf16 v76, v26, s49, v8
    v_dot2_f32_bf16 v77, v26, s50, v8
    v_dot2_f32_bf16 v78, v27, s49, v8
    v_dot2_f32_bf16 v79, v27, s50, v8
    v_dot2_f32_bf16 v80, v28, s49, v8
    v_dot2_f32_bf16 v81, v28, s50, v8
    v_dot2_f32_bf16 v82, v29, s49, v8
    v_dot2_f32_bf16 v83, v29, s50, v8
    v_dot2_f32_bf16 v84, v30, s49, v8
    v_dot2_f32_bf16 v85, v30, s50, v8
    v_dot2_f32_bf16 v86, v31, s49, v8
    v_dot2_f32_bf16 v87, v31, s50, v8
    v_dot2_f32_bf16 v88, v32, s49, v8
    v_dot2_f32_bf16 v89, v32, s50, v8
    v_dot2_f32_bf16 v90, v33, s49, v8
    v_dot2_f32_bf16 v91, v33, s50, v8
    v_dot2_f32_bf16 v92, v34, s49, v8
    v_dot2_f32_bf16 v93, v34, s50, v8
    v_dot2_f32_bf16 v94, v35, s49, v8
    v_dot2_f32_bf16 v95, v35, s50, v8
    v_dot2_f32_bf16 v96, v36, s49, v8
    v_dot2_f32_bf16 v97, v36, s50, v8
    v_dot2_f32_bf16 v98, v37, s49, v8
    v_dot2_f32_bf16 v99, v37, s50, v8
    v_dot2_f32_bf16 v100, v38, s49, v8
    v_dot2_f32_bf16 v101, v38, s50, v8
    v_dot2_f32_bf16 v102, v39, s49, v8
    v_dot2_f32_bf16 v103, v39, s50, v8
    v_dot2_f32_bf16 v104, v40, s49, v8
    v_dot2_f32_bf16 v105, v40, s50, v8
    v_dot2_f32_bf16 v106, v41, s49, v8
    v_dot2_f32_bf16 v107, v41, s50, v8
    v_dot2_f32_bf16 v108, v42, s49, v8
    v_dot2_f32_bf16 v109, v42, s50, v8
    v_dot2_f32_bf16 v110, v43, s49, v8
    v_dot2_f32_bf16 v111, v43, s50, v8
    v_dot2_f32_bf16 v112, v44, s49, v8
    v_dot2_f32_bf16 v113, v44, s50, v8
    v_dot2_f32_bf16 v114, v45, s49, v8
    v_dot2_f32_bf16 v115, v45, s50, v8
    v_dot2_f32_bf16 v116, v46, s49, v8
    v_dot2_f32_bf16 v117, v46, s50, v8
    v_dot2_f32_bf16 v118, v47, s49, v8
    v_dot2_f32_bf16 v119, v47, s50, v8
    v_pk_mul_f32 v[10:11], v[48:49], v[48:49]
    v_pk_mul_f32 v[120:121], v[50:51], v[50:51]
    v_pk_fma_f32 v[10:11], v[52:53], v[52:53], v[10:11]
    v_pk_fma_f32 v[120:121], v[54:55], v[54:55], v[120:121]
    v_pk_fma_f32 v[10:11], v[56:57], v[56:57], v[10:11]
    v_pk_fma_f32 v[120:121], v[58:59], v[58:59], v[120:121]
    v_pk_fma_f32 v[10:11], v[60:61], v[60:61], v[10:11]
    v_pk_fma_f32 v[120:121], v[62:63], v[62:63], v[120:121]
    v_pk_fma_f32 v[10:11], v[64:65], v[64:65], v[10:11]
    v_pk_fma_f32 v[120:121], v[66:67], v[66:67], v[120:121]
    v_pk_fma_f32 v[10:11], v[68:69], v[68:69], v[10:11]
    v_pk_fma_f32 v[120:121], v[70:71], v[70:71], v[120:121]
    v_pk_fma_f32 v[10:11], v[72:73], v[72:73], v[10:11]
    v_pk_fma_f32 v[120:121], v[74:75], v[74:75], v[120:121]
    v_pk_fma_f32 v[10:11], v[76:77], v[76:77], v[10:11]
    v_pk_fma_f32 v[120:121], v[78:79], v[78:79], v[120:121]
    v_pk_fma_f32 v[10:11], v[80:81], v[80:81], v[10:11]
    v_pk_fma_f32 v[120:121], v[82:83], v[82:83], v[120:121]
    v_pk_fma_f32 v[10:11], v[84:85], v[84:85], v[10:11]
    v_pk_fma_f32 v[120:121], v[86:87], v[86:87], v[120:121]
    v_pk_fma_f32 v[10:11], v[88:89], v[88:89], v[10:11]
    v_pk_fma_f32 v[120:121], v[90:91], v[90:91], v[120:121]
    v_pk_fma_f32 v[10:11], v[92:93], v[92:93], v[10:11]
    v_pk_fma_f32 v[120:121], v[94:95], v[94:95], v[120:121]
    v_pk_fma_f32 v[10:11], v[96:97], v[96:97], v[10:11]
    v_pk_fma_f32 v[120:121], v[98:99], v[98:99], v[120:121]
    v_pk_fma_f32 v[10:11], v[100:101], v[100:101], v[10:11]
    v_pk_fma_f32 v[120:121], v[102:103], v[102:103], v[120:121]
    v_pk_fma_f32 v[10:11], v[104:105], v[104:105], v[10:11]
    v_pk_fma_f32 v[120:121], v[106:107], v[106:107], v[120:121]
    v_pk_fma_f32 v[10:11], v[108:109], v[108:109], v[10:11]
    v_pk_fma_f32 v[120:121], v[110:111], v[110:111], v[120:121]
    v_pk_fma_f32 v[10:11], v[112:113], v[112:113], v[10:11]
    v_pk_fma_f32 v[120:121], v[114:115], v[114:115], v[120:121]
    v_pk_fma_f32 v[10:11], v[116:117], v[116:117], v[10:11]
    v_pk_fma_f32 v[120:121], v[118:119], v[118:119], v[120:121]
    v_pk_add_f32 v[10:11], v[10:11], v[120:121]
    v_add_f32 v9, v10, v11
    s_nop 1
    v_add_f32_dpp v9, v9, v9 quad_perm:[1,0,3,2] row_mask:0xf bank_mask:0xf
    s_nop 1
    v_add_f32_dpp v9, v9, v9 quad_perm:[2,3,0,1] row_mask:0xf bank_mask:0xf
    s_nop 1
    v_add_f32_dpp v9, v9, v9 row_half_mirror row_mask:0xf bank_mask:0xf
    v_mov_b32 v10, 0x3727c5ac
    v_fmac_f32 v10, 0x3ae38e39, v9
    v_rsq_f32 v10, v10
    s_nop 0
    v_pk_mul_f32 v[48:49], v[48:49], v[10:11] op_sel_hi:[1,0]
    v_pk_mul_f32 v[50:51], v[50:51], v[10:11] op_sel_hi:[1,0]
    v_pk_mul_f32 v[52:53], v[52:53], v[10:11] op_sel_hi:[1,0]
    v_pk_mul_f32 v[54:55], v[54:55], v[10:11] op_sel_hi:[1,0]
    v_cvt_pk_bf16_f32 v12, v48, v49
    v_cvt_pk_bf16_f32 v13, v50, v51
    v_cvt_pk_bf16_f32 v14, v52, v53
    v_cvt_pk_bf16_f32 v15, v54, v55
    ds_write_b128 v5, v[12:15] offset:0
    v_pk_mul_f32 v[56:57], v[56:57], v[10:11] op_sel_hi:[1,0]
    v_pk_mul_f32 v[58:59], v[58:59], v[10:11] op_sel_hi:[1,0]
    v_pk_mul_f32 v[60:61], v[60:61], v[10:11] op_sel_hi:[1,0]
    v_pk_mul_f32 v[62:63], v[62:63], v[10:11] op_sel_hi:[1,0]
    v_cvt_pk_bf16_f32 v16, v56, v57
    v_cvt_pk_bf16_f32 v17, v58, v59
    v_cvt_pk_bf16_f32 v18, v60, v61
    v_cvt_pk_bf16_f32 v19, v62, v63
    ds_write_b128 v5, v[16:19] offset:4224
    v_pk_mul_f32 v[64:65], v[64:65], v[10:11] op_sel_hi:[1,0]
    v_pk_mul_f32 v[66:67], v[66:67], v[10:11] op_sel_hi:[1,0]
    v_pk_mul_f32 v[68:69], v[68:69], v[10:11] op_sel_hi:[1,0]
    v_pk_mul_f32 v[70:71], v[70:71], v[10:11] op_sel_hi:[1,0]
    v_cvt_pk_bf16_f32 v20, v64, v65
    v_cvt_pk_bf16_f32 v21, v66, v67
    v_cvt_pk_bf16_f32 v22, v68, v69
    v_cvt_pk_bf16_f32 v23, v70, v71
    ds_write_b128 v5, v[20:23] offset:8448
    v_pk_mul_f32 v[72:73], v[72:73], v[10:11] op_sel_hi:[1,0]
    v_pk_mul_f32 v[74:75], v[74:75], v[10:11] op_sel_hi:[1,0]
    v_pk_mul_f32 v[76:77], v[76:77], v[10:11] op_sel_hi:[1,0]
    v_pk_mul_f32 v[78:79], v[78:79], v[10:11] op_sel_hi:[1,0]
    v_cvt_pk_bf16_f32 v24, v72, v73
    v_cvt_pk_bf16_f32 v25, v74, v75
    v_cvt_pk_bf16_f32 v26, v76, v77
    v_cvt_pk_bf16_f32 v27, v78, v79
    ds_write_b128 v5, v[24:27] offset:12672
    v_pk_mul_f32 v[80:81], v[80:81], v[10:11] op_sel_hi:[1,0]
    v_pk_mul_f32 v[82:83], v[82:83], v[10:11] op_sel_hi:[1,0]
    v_pk_mul_f32 v[84:85], v[84:85], v[10:11] op_sel_hi:[1,0]
    v_pk_mul_f32 v[86:87], v[86:87], v[10:11] op_sel_hi:[1,0]
    v_cvt_pk_bf16_f32 v28, v80, v81
    v_cvt_pk_bf16_f32 v29, v82, v83
    v_cvt_pk_bf16_f32 v30, v84, v85
    v_cvt_pk_bf16_f32 v31, v86, v87
    ds_write_b128 v5, v[28:31] offset:16896
    v_pk_mul_f32 v[88:89], v[88:89], v[10:11] op_sel_hi:[1,0]
    v_pk_mul_f32 v[90:91], v[90:91], v[10:11] op_sel_hi:[1,0]
    v_pk_mul_f32 v[92:93], v[92:93], v[10:11] op_sel_hi:[1,0]
    v_pk_mul_f32 v[94:95], v[94:95], v[10:11] op_sel_hi:[1,0]
    v_cvt_pk_bf16_f32 v32, v88, v89
    v_cvt_pk_bf16_f32 v33, v90, v91
    v_cvt_pk_bf16_f32 v34, v92, v93
    v_cvt_pk_bf16_f32 v35, v94, v95
    ds_write_b128 v5, v[32:35] offset:21120
    v_pk_mul_f32 v[96:97], v[96:97], v[10:11] op_sel_hi:[1,0]
    v_pk_mul_f32 v[98:99], v[98:99], v[10:11] op_sel_hi:[1,0]
    v_pk_mul_f32 v[100:101], v[100:101], v[10:11] op_sel_hi:[1,0]
    v_pk_mul_f32 v[102:103], v[102:103], v[10:11] op_sel_hi:[1,0]
    v_cvt_pk_bf16_f32 v36, v96, v97
    v_cvt_pk_bf16_f32 v37, v98, v99
    v_cvt_pk_bf16_f32 v38, v100, v101
    v_cvt_pk_bf16_f32 v39, v102, v103
    ds_write_b128 v5, v[36:39] offset:25344
    v_pk_mul_f32 v[104:105], v[104:105], v[10:11] op_sel_hi:[1,0]
    v_pk_mul_f32 v[106:107], v[106:107], v[10:11] op_sel_hi:[1,0]
    v_pk_mul_f32 v[108:109], v[108:109], v[10:11] op_sel_hi:[1,0]
    v_pk_mul_f32 v[110:111], v[110:111], v[10:11] op_sel_hi:[1,0]
    v_cvt_pk_bf16_f32 v40, v104, v105
    v_cvt_pk_bf16_f32 v41, v106, v107
    v_cvt_pk_bf16_f32 v42, v108, v109
    v_cvt_pk_bf16_f32 v43, v110, v111
    ds_write_b128 v5, v[40:43] offset:29568
    v_pk_mul_f32 v[112:113], v[112:113], v[10:11] op_sel_hi:[1,0]
    v_pk_mul_f32 v[114:115], v[114:115], v[10:11] op_sel_hi:[1,0]
    v_pk_mul_f32 v[116:117], v[116:117], v[10:11] op_sel_hi:[1,0]
    v_pk_mul_f32 v[118:119], v[118:119], v[10:11] op_sel_hi:[1,0]
    v_cvt_pk_bf16_f32 v44, v112, v113
    v_cvt_pk_bf16_f32 v45, v114, v115
    v_cvt_pk_bf16_f32 v46, v116, v117
    v_cvt_pk_bf16_f32 v47, v118, v119
    ds_write_b128 v5, v[44:47] offset:33792
    s_waitcnt lgkmcnt(0)
    s_barrier
    ds_read_b128 v[48:51], v6 offset:0
    ds_read_b128 v[52:55], v6 offset:1056
    ds_read_b128 v[56:59], v6 offset:2112
    ds_read_b128 v[60:63], v6 offset:3168
    ds_read_b128 v[64:67], v6 offset:4224
    ds_read_b128 v[68:71], v6 offset:5280
    ds_read_b128 v[72:75], v6 offset:6336
    ds_read_b128 v[76:79], v6 offset:7392
    ds_read_b128 v[80:83], v6 offset:8448
    s_waitcnt lgkmcnt(8)
    buffer_store_dwordx4 v[48:51], v7, s[36:39], s46 offen offset:0
    s_waitcnt lgkmcnt(7)
    buffer_store_dwordx4 v[52:55], v7, s[36:39], s46 offen offset:1024
    s_waitcnt lgkmcnt(6)
    buffer_store_dwordx4 v[56:59], v7, s[36:39], s46 offen offset:2048
    s_waitcnt lgkmcnt(5)
    buffer_store_dwordx4 v[60:63], v7, s[36:39], s46 offen offset:3072
    s_add_u32 s46, s46, 4096
    s_waitcnt lgkmcnt(4)
    buffer_store_dwordx4 v[64:67], v7, s[36:39], s46 offen offset:0
    s_waitcnt lgkmcnt(3)
    buffer_store_dwordx4 v[68:71], v7, s[36:39], s46 offen offset:1024
    s_waitcnt lgkmcnt(2)
    buffer_store_dwordx4 v[72:75], v7, s[36:39], s46 offen offset:2048
    s_waitcnt lgkmcnt(1)
    buffer_store_dwordx4 v[76:79], v7, s[36:39], s46 offen offset:3072
    s_add_u32 s46, s46, 4096
    s_waitcnt lgkmcnt(0)
    buffer_store_dwordx4 v[80:83], v7, s[36:39], s46 offen offset:0
    s_endpgm
L0_gemv:
    s_mov_b32 s36, s18
    s_mov_b32 s37, s19
    s_mov_b32 s38, 0x480
    s_mov_b32 s39, 0x20000
    s_mul_i32 s44, s55, 576
    v_lshlrev_b32 v4, 1, v4
    buffer_load_ushort v50, v4, s[36:39], s44 offen offset:0
    buffer_load_ushort v51, v4, s[36:39], s44 offen offset:16
    buffer_load_ushort v52, v4, s[36:39], s44 offen offset:32
    buffer_load_ushort v53, v4, s[36:39], s44 offen offset:48
    buffer_load_ushort v54, v4, s[36:39], s44 offen offset:64
    buffer_load_ushort v55, v4, s[36:39], s44 offen offset:80
    buffer_load_ushort v56, v4, s[36:39], s44 offen offset:96
    buffer_load_ushort v57, v4, s[36:39], s44 offen offset:112
    buffer_load_ushort v58, v4, s[36:39], s44 offen offset:128
    s_add_u32 s40, s26, 0x60000
    s_addc_u32 s41, s27, 0
    s_mov_b32 s42, 0x6c00
    s_mov_b32 s43, 0x20000
    s_mov_b32 s46, 0x3fb8aa3b
    s_mov_b32 s47, 0xffff0000
    v_lshrrev_b32 v6, 4, v0
    v_lshlrev_b32 v6, 8, v6
    v_lshl_add_u32 v6, v3, 5, v6
    s_waitcnt vmcnt(0)
    v_lshlrev_b32 v50, 16, v50
    v_mul_f32 v60, s46, v50
    v_lshlrev_b32 v51, 16, v51
    v_mul_f32 v62, s46, v51
    v_lshlrev_b32 v52, 16, v52
    v_mul_f32 v64, s46, v52
    v_lshlrev_b32 v53, 16, v53
    v_mul_f32 v66, s46, v53
    v_lshlrev_b32 v54, 16, v54
    v_mul_f32 v68, s46, v54
    v_lshlrev_b32 v55, 16, v55
    v_mul_f32 v70, s46, v55
    v_lshlrev_b32 v56, 16, v56
    v_mul_f32 v72, s46, v56
    v_lshlrev_b32 v57, 16, v57
    v_mul_f32 v74, s46, v57
    v_lshlrev_b32 v58, 16, v58
    v_mul_f32 v76, s46, v58
    v_exp_f32 v60, -v60
    v_exp_f32 v62, -v62
    v_exp_f32 v64, -v64
    v_exp_f32 v66, -v66
    v_exp_f32 v68, -v68
    v_exp_f32 v70, -v70
    v_exp_f32 v72, -v72
    v_exp_f32 v74, -v74
    v_exp_f32 v76, -v76
    v_add_f32 v60, 1.0, v60
    v_add_f32 v62, 1.0, v62
    v_add_f32 v64, 1.0, v64
    v_add_f32 v66, 1.0, v66
    v_add_f32 v68, 1.0, v68
    v_add_f32 v70, 1.0, v70
    v_add_f32 v72, 1.0, v72
    v_add_f32 v74, 1.0, v74
    v_add_f32 v76, 1.0, v76
    v_rcp_f32 v60, v60
    v_rcp_f32 v62, v62
    v_rcp_f32 v64, v64
    v_rcp_f32 v66, v66
    v_rcp_f32 v68, v68
    v_rcp_f32 v70, v70
    v_rcp_f32 v72, v72
    v_rcp_f32 v74, v74
    v_rcp_f32 v76, v76
    v_mul_f32 v50, v50, v60
    v_mul_f32 v51, v51, v62
    v_mul_f32 v52, v52, v64
    v_mul_f32 v53, v53, v66
    v_mul_f32 v54, v54, v68
    v_mul_f32 v55, v55, v70
    v_mul_f32 v56, v56, v72
    v_mul_f32 v57, v57, v74
    v_mul_f32 v58, v58, v76
    v_cvt_pk_bf16_f32 v50, v50, v50
    v_cvt_pk_bf16_f32 v51, v51, v51
    v_cvt_pk_bf16_f32 v52, v52, v52
    v_cvt_pk_bf16_f32 v53, v53, v53
    v_cvt_pk_bf16_f32 v54, v54, v54
    v_cvt_pk_bf16_f32 v55, v55, v55
    v_cvt_pk_bf16_f32 v56, v56, v56
    v_cvt_pk_bf16_f32 v57, v57, v57
    v_cvt_pk_bf16_f32 v58, v58, v58
    v_and_b32 v60, s47, v50
    v_and_b32 v62, s47, v51
    v_and_b32 v64, s47, v52
    v_and_b32 v66, s47, v53
    v_and_b32 v68, s47, v54
    v_and_b32 v70, s47, v55
    v_and_b32 v72, s47, v56
    v_and_b32 v74, s47, v57
    v_and_b32 v76, s47, v58
    v_lshlrev_b32 v80, 16, v12
    v_and_b32 v81, s47, v12
    v_lshlrev_b32 v82, 16, v13
    v_and_b32 v83, s47, v13
    v_lshlrev_b32 v84, 16, v14
    v_and_b32 v85, s47, v14
    v_lshlrev_b32 v86, 16, v15
    v_and_b32 v87, s47, v15
    v_pk_mul_f32 v[90:91], v[80:81], v[60:61] op_sel_hi:[1,0]
    v_pk_mul_f32 v[92:93], v[82:83], v[60:61] op_sel_hi:[1,0]
    v_pk_mul_f32 v[94:95], v[84:85], v[60:61] op_sel_hi:[1,0]
    v_pk_mul_f32 v[96:97], v[86:87], v[60:61] op_sel_hi:[1,0]
    v_lshlrev_b32 v80, 16, v16
    v_and_b32 v81, s47, v16
    v_lshlrev_b32 v82, 16, v17
    v_and_b32 v83, s47, v17
    v_lshlrev_b32 v84, 16, v18
    v_and_b32 v85, s47, v18
    v_lshlrev_b32 v86, 16, v19
    v_and_b32 v87, s47, v19
    v_pk_fma_f32 v[90:91], v[80:81], v[62:63], v[90:91] op_sel_hi:[1,0,1]
    v_pk_fma_f32 v[92:93], v[82:83], v[62:63], v[92:93] op_sel_hi:[1,0,1]
    v_pk_fma_f32 v[94:95], v[84:85], v[62:63], v[94:95] op_sel_hi:[1,0,1]
    v_pk_fma_f32 v[96:97], v[86:87], v[62:63], v[96:97] op_sel_hi:[1,0,1]
    v_lshlrev_b32 v80, 16, v20
    v_and_b32 v81, s47, v20
    v_lshlrev_b32 v82, 16, v21
    v_and_b32 v83, s47, v21
    v_lshlrev_b32 v84, 16, v22
    v_and_b32 v85, s47, v22
    v_lshlrev_b32 v86, 16, v23
    v_and_b32 v87, s47, v23
    v_pk_fma_f32 v[90:91], v[80:81], v[64:65], v[90:91] op_sel_hi:[1,0,1]
    v_pk_fma_f32 v[92:93], v[82:83], v[64:65], v[92:93] op_sel_hi:[1,0,1]
    v_pk_fma_f32 v[94:95], v[84:85], v[64:65], v[94:95] op_sel_hi:[1,0,1]
    v_pk_fma_f32 v[96:97], v[86:87], v[64:65], v[96:97] op_sel_hi:[1,0,1]
    v_lshlrev_b32 v80, 16, v24
    v_and_b32 v81, s47, v24
    v_lshlrev_b32 v82, 16, v25
    v_and_b32 v83, s47, v25
    v_lshlrev_b32 v84, 16, v26
    v_and_b32 v85, s47, v26
    v_lshlrev_b32 v86, 16, v27
    v_and_b32 v87, s47, v27
    v_pk_fma_f32 v[90:91], v[80:81], v[66:67], v[90:91] op_sel_hi:[1,0,1]
    v_pk_fma_f32 v[92:93], v[82:83], v[66:67], v[92:93] op_sel_hi:[1,0,1]
    v_pk_fma_f32 v[94:95], v[84:85], v[66:67], v[94:95] op_sel_hi:[1,0,1]
    v_pk_fma_f32 v[96:97], v[86:87], v[66:67], v[96:97] op_sel_hi:[1,0,1]
    v_lshlrev_b32 v80, 16, v28
    v_and_b32 v81, s47, v28
    v_lshlrev_b32 v82, 16, v29
    v_and_b32 v83, s47, v29
    v_lshlrev_b32 v84, 16, v30
    v_and_b32 v85, s47, v30
    v_lshlrev_b32 v86, 16, v31
    v_and_b32 v87, s47, v31
    v_pk_fma_f32 v[90:91], v[80:81], v[68:69], v[90:91] op_sel_hi:[1,0,1]
    v_pk_fma_f32 v[92:93], v[82:83], v[68:69], v[92:93] op_sel_hi:[1,0,1]
    v_pk_fma_f32 v[94:95], v[84:85], v[68:69], v[94:95] op_sel_hi:[1,0,1]
    v_pk_fma_f32 v[96:97], v[86:87], v[68:69], v[96:97] op_sel_hi:[1,0,1]
    v_lshlrev_b32 v80, 16, v32
    v_and_b32 v81, s47, v32
    v_lshlrev_b32 v82, 16, v33
    v_and_b32 v83, s47, v33
    v_lshlrev_b32 v84, 16, v34
    v_and_b32 v85, s47, v34
    v_lshlrev_b32 v86, 16, v35
    v_and_b32 v87, s47, v35
    v_pk_fma_f32 v[90:91], v[80:81], v[70:71], v[90:91] op_sel_hi:[1,0,1]
    v_pk_fma_f32 v[92:93], v[82:83], v[70:71], v[92:93] op_sel_hi:[1,0,1]
    v_pk_fma_f32 v[94:95], v[84:85], v[70:71], v[94:95] op_sel_hi:[1,0,1]
    v_pk_fma_f32 v[96:97], v[86:87], v[70:71], v[96:97] op_sel_hi:[1,0,1]
    v_lshlrev_b32 v80, 16, v36
    v_and_b32 v81, s47, v36
    v_lshlrev_b32 v82, 16, v37
    v_and_b32 v83, s47, v37
    v_lshlrev_b32 v84, 16, v38
    v_and_b32 v85, s47, v38
    v_lshlrev_b32 v86, 16, v39
    v_and_b32 v87, s47, v39
    v_pk_fma_f32 v[90:91], v[80:81], v[72:73], v[90:91] op_sel_hi:[1,0,1]
    v_pk_fma_f32 v[92:93], v[82:83], v[72:73], v[92:93] op_sel_hi:[1,0,1]
    v_pk_fma_f32 v[94:95], v[84:85], v[72:73], v[94:95] op_sel_hi:[1,0,1]
    v_pk_fma_f32 v[96:97], v[86:87], v[72:73], v[96:97] op_sel_hi:[1,0,1]
    v_lshlrev_b32 v80, 16, v40
    v_and_b32 v81, s47, v40
    v_lshlrev_b32 v82, 16, v41
    v_and_b32 v83, s47, v41
    v_lshlrev_b32 v84, 16, v42
    v_and_b32 v85, s47, v42
    v_lshlrev_b32 v86, 16, v43
    v_and_b32 v87, s47, v43
    v_pk_fma_f32 v[90:91], v[80:81], v[74:75], v[90:91] op_sel_hi:[1,0,1]
    v_pk_fma_f32 v[92:93], v[82:83], v[74:75], v[92:93] op_sel_hi:[1,0,1]
    v_pk_fma_f32 v[94:95], v[84:85], v[74:75], v[94:95] op_sel_hi:[1,0,1]
    v_pk_fma_f32 v[96:97], v[86:87], v[74:75], v[96:97] op_sel_hi:[1,0,1]
    v_lshlrev_b32 v80, 16, v44
    v_and_b32 v81, s47, v44
    v_lshlrev_b32 v82, 16, v45
    v_and_b32 v83, s47, v45
    v_lshlrev_b32 v84, 16, v46
    v_and_b32 v85, s47, v46
    v_lshlrev_b32 v86, 16, v47
    v_and_b32 v87, s47, v47
    v_pk_fma_f32 v[90:91], v[80:81], v[76:77], v[90:91] op_sel_hi:[1,0,1]
    v_pk_fma_f32 v[92:93], v[82:83], v[76:77], v[92:93] op_sel_hi:[1,0,1]
    v_pk_fma_f32 v[94:95], v[84:85], v[76:77], v[94:95] op_sel_hi:[1,0,1]
    v_pk_fma_f32 v[96:97], v[86:87], v[76:77], v[96:97] op_sel_hi:[1,0,1]
    v_add_f32_dpp v90, v90, v90 row_shr:8 row_mask:0xf bank_mask:0xf bound_ctrl:1
    v_add_f32_dpp v91, v91, v91 row_shr:8 row_mask:0xf bank_mask:0xf bound_ctrl:1
    v_add_f32_dpp v92, v92, v92 row_shr:8 row_mask:0xf bank_mask:0xf bound_ctrl:1
    v_add_f32_dpp v93, v93, v93 row_shr:8 row_mask:0xf bank_mask:0xf bound_ctrl:1
    v_add_f32_dpp v94, v94, v94 row_shr:8 row_mask:0xf bank_mask:0xf bound_ctrl:1
    v_add_f32_dpp v95, v95, v95 row_shr:8 row_mask:0xf bank_mask:0xf bound_ctrl:1
    v_add_f32_dpp v96, v96, v96 row_shr:8 row_mask:0xf bank_mask:0xf bound_ctrl:1
    v_add_f32_dpp v97, v97, v97 row_shr:8 row_mask:0xf bank_mask:0xf bound_ctrl:1
    v_and_b32 v8, 8, v0
    v_cmp_ne_u32 vcc, 0, v8
    s_nop 0
    s_and_saveexec_b64 s[48:49], vcc
    ds_write_b128 v6, v[90:93]
    ds_write_b128 v6, v[94:97] offset:16
    s_mov_b64 exec, s[48:49]
    s_waitcnt lgkmcnt(0)
    s_barrier
    s_cmp_lg_u32 s3, 0
    s_cbranch_scc1 L0_exit
    v_lshlrev_b32 v6, 2, v0
    ds_read2st64_b32 v[20:21], v6 offset0:0 offset1:1
    ds_read2st64_b32 v[22:23], v6 offset0:2 offset1:3
    ds_read2st64_b32 v[24:25], v6 offset0:4 offset1:5
    ds_read2st64_b32 v[26:27], v6 offset0:6 offset1:7
    ds_read2st64_b32 v[28:29], v6 offset0:8 offset1:9
    ds_read2st64_b32 v[30:31], v6 offset0:10 offset1:11
    ds_read2st64_b32 v[32:33], v6 offset0:12 offset1:13
    ds_read2st64_b32 v[34:35], v6 offset0:14 offset1:15
    s_mul_i32 s45, s55, 13824
    s_lshl_b32 s44, s56, 8
    s_add_u32 s45, s45, s44
    s_waitcnt lgkmcnt(0)
    v_pk_add_f32 v[20:21], v[20:21], v[22:23]
    v_pk_add_f32 v[24:25], v[24:25], v[26:27]
    v_pk_add_f32 v[28:29], v[28:29], v[30:31]
    v_pk_add_f32 v[32:33], v[32:33], v[34:35]
    v_pk_add_f32 v[20:21], v[20:21], v[24:25]
    v_pk_add_f32 v[28:29], v[28:29], v[32:33]
    v_pk_add_f32 v[20:21], v[20:21], v[28:29]
    v_add_f32 v20, v20, v21
    buffer_store_dword v20, v6, s[40:43], s45 offen
    s_endpgm
L0_shuf:
    v_mul_u32_u24 v5, 1152, v2
    v_lshl_add_u32 v5, v3, 4, v5
    v_and_b32 v3, 31, v1
    v_lshrrev_b32 v4, 5, v1
    v_mul_u32_u24 v9, 9216, v4
    s_lshr_b32 s59, s3, 1
    s_and_b32 s60, s3, 1
    s_mul_i32 s61, s60, 18432
    s_cmp_ge_u32 s2, 154
    s_cbranch_scc1 L0_wo
    s_add_u32 s36, s26, 0x700000
    s_addc_u32 s37, s27, 0
    s_mov_b32 s38, 0x1f8000
    s_mov_b32 s39, 0x20000
    s_lshl_b32 s58, s58, 13
    s_lshl_b32 s60, s60, 12
    s_cmp_eq_u32 s57, 2
    s_cbranch_scc1 L0_wqv
    v_lshrrev_b32 v6, 4, v3
    v_mul_u32_u24 v6, 18, v6
    v_and_b32 v8, 15, v3
    v_add_u32 v6, v6, v8
    v_lshl_add_u32 v6, v6, 1, v9
    v_lshrrev_b32 v8, 1, v3
    v_mul_u32_u24 v8, 18, v8
    v_and_b32 v10, 1, v3
    v_add3_u32 v8, v8, v10, 16
    v_lshl_add_u32 v8, v8, 1, v9
    s_mul_i32 s48, s3, 288
    s_movk_i32 s49, 72
    s_mul_i32 s51, s59, 576
    s_add_u32 s51, s51, s61
    s_lshl_b32 s52, s57, 2
    s_add_u32 s52, s52, s3
    s_mul_i32 s52, s52, 147456
    s_add_u32 s52, s52, s58
    s_lshl_b32 s55, s57, 1
    s_add_u32 s55, s55, s59
    s_lshl_b32 s55, s55, 10
    s_add_u32 s55, s55, s60
    s_add_u32 s55, s55, s58
    s_add_u32 s55, s55, 1179648
    s_branch L0_wq2
L0_wqv:
    v_lshl_add_u32 v6, v3, 1, v9
    v_mov_b32 v8, v6
    s_lshl_b32 s48, s3, 8
    s_movk_i32 s49, 64
    s_lshl_b32 s51, s59, 6
    s_add_u32 s51, s51, 1024
    s_add_u32 s51, s51, s61
    s_add_u32 s52, s3, 9
    s_mul_i32 s52, s52, 147456
    s_add_u32 s52, s52, s58
    s_lshl_b32 s55, s59, 10
    s_add_u32 s55, s55, s60
    s_add_u32 s55, s55, s58
    s_add_u32 s55, s55, 1916928
L0_wq2:
    s_movk_i32 s50, 18432
    s_movk_i32 s53, 4096
    s_movk_i32 s54, 1024
    s_movk_i32 s62, 1024
    s_branch L0_g2
L0_wo:
    s_add_u32 s36, s26, 0x920000
    s_addc_u32 s37, s27, 0
    s_mov_b32 s38, 0xa2000
    s_mov_b32 s39, 0x20000
    v_and_b32 v6, 0x13, v3
    v_and_b32 v8, 8, v3
    v_lshrrev_b32 v8, 1, v8
    v_or_b32 v6, v6, v8
    v_and_b32 v8, 4, v3
    v_lshlrev_b32 v8, 1, v8
    v_or_b32 v6, v6, v8
    v_lshl_add_u32 v6, v6, 1, v9
    v_mov_b32 v8, v6
    s_movk_i32 s49, 64
    s_movk_i32 s54, 1024
    s_lshl_b32 s48, s3, 8
    s_mul_i32 s52, s3, 147456
    s_lshl_b32 s51, s59, 6
    s_add_u32 s51, s51, 1024
    s_lshl_b32 s55, s59, 10
    s_add_u32 s55, s55, 589824
    s_mov_b32 s62, 72704
    s_cmp_ge_u32 s2, 170
    s_cbranch_scc1 L0_wr
    s_lshl_b32 s58, s56, 12
    s_add_u32 s52, s52, s58
    s_add_u32 s55, s55, s58
    s_add_u32 s51, s51, s61
    s_lshl_b32 s60, s60, 11
    s_add_u32 s55, s55, s60
    s_movk_i32 s50, 18432
    s_movk_i32 s53, 2048
    s_branch L0_g2
L0_wr:
    s_lshl_b32 s58, s56, 11
    s_add_u32 s58, s58, 65536
    s_add_u32 s52, s52, s58
    s_add_u32 s55, s55, s58
    s_mov_b32 s50, 0
    s_mov_b32 s53, 0
L0_g2:
    v_mov_b32 v48, 0
    v_mov_b32 v49, 0
    v_mov_b32 v50, 0
    v_mov_b32 v51, 0
    v_mov_b32 v52, 0
    v_mov_b32 v53, 0
    v_mov_b32 v54, 0
    v_mov_b32 v55, 0
    v_mov_b32 v56, 0
    v_mov_b32 v57, 0
    v_mov_b32 v58, 0
    v_mov_b32 v59, 0
    v_mov_b32 v60, 0
    v_mov_b32 v61, 0
    v_mov_b32 v62, 0
    v_mov_b32 v63, 0
    s_waitcnt vmcnt(8)
    ds_write_b128 v5, v[12:15] offset:0
    s_waitcnt vmcnt(7)
    ds_write_b128 v5, v[16:19] offset:128
    s_waitcnt vmcnt(6)
    ds_write_b128 v5, v[20:23] offset:256
    s_waitcnt vmcnt(5)
    ds_write_b128 v5, v[24:27] offset:384
    s_waitcnt vmcnt(4)
    ds_write_b128 v5, v[28:31] offset:512
    s_waitcnt vmcnt(3)
    ds_write_b128 v5, v[32:35] offset:640
    s_waitcnt vmcnt(2)
    ds_write_b128 v5, v[36:39] offset:768
    s_waitcnt vmcnt(1)
    ds_write_b128 v5, v[40:43] offset:896
    s_waitcnt vmcnt(0)
    ds_write_b128 v5, v[44:47] offset:1024
    s_waitcnt lgkmcnt(0)
    s_barrier
    s_mov_b32 s63, s48
    s_mov_b32 s64, s52
    v_add_u32 v10, s63, v6
    ds_read_u16_d16 v48, v10 offset:0
    ds_read_u16_d16_hi v49, v10 offset:1152
    ds_read_u16_d16 v50, v10 offset:2304
    ds_read_u16_d16_hi v51, v10 offset:3456
    ds_read_u16_d16 v52, v10 offset:4608
    ds_read_u16_d16_hi v53, v10 offset:5760
    ds_read_u16_d16 v54, v10 offset:6912
    ds_read_u16_d16_hi v55, v10 offset:8064
    s_add_u32 s63, s48, s50
    s_add_u32 s65, s52, s53
    s_add_u32 s48, s48, s49
    s_add_u32 s52, s52, s54
    v_add_u32 v10, s63, v6
    ds_read_u16_d16 v56, v10 offset:0
    ds_read_u16_d16_hi v57, v10 offset:1152
    ds_read_u16_d16 v58, v10 offset:2304
    ds_read_u16_d16_hi v59, v10 offset:3456
    ds_read_u16_d16 v60, v10 offset:4608
    ds_read_u16_d16_hi v61, v10 offset:5760
    ds_read_u16_d16 v62, v10 offset:6912
    ds_read_u16_d16_hi v63, v10 offset:8064
    s_waitcnt lgkmcnt(8)
    v_or_b32 v64, v48, v49
    v_or_b32 v65, v50, v51
    v_or_b32 v66, v52, v53
    v_or_b32 v67, v54, v55
    buffer_store_dwordx4 v[64:67], v7, s[36:39], s64 offen
    s_mov_b32 s63, s48
    s_mov_b32 s64, s52
    v_add_u32 v10, s63, v6
    ds_read_u16_d16 v48, v10 offset:0
    ds_read_u16_d16_hi v49, v10 offset:1152
    ds_read_u16_d16 v50, v10 offset:2304
    ds_read_u16_d16_hi v51, v10 offset:3456
    ds_read_u16_d16 v52, v10 offset:4608
    ds_read_u16_d16_hi v53, v10 offset:5760
    ds_read_u16_d16 v54, v10 offset:6912
    ds_read_u16_d16_hi v55, v10 offset:8064
    s_waitcnt lgkmcnt(8)
    v_or_b32 v68, v56, v57
    v_or_b32 v69, v58, v59
    v_or_b32 v70, v60, v61
    v_or_b32 v71, v62, v63
    buffer_store_dwordx4 v[68:71], v7, s[36:39], s65 offen
    s_add_u32 s63, s48, s50
    s_add_u32 s65, s52, s53
    s_add_u32 s48, s48, s49
    s_add_u32 s52, s52, s62
    v_add_u32 v10, s63, v6
    ds_read_u16_d16 v56, v10 offset:0
    ds_read_u16_d16_hi v57, v10 offset:1152
    ds_read_u16_d16 v58, v10 offset:2304
    ds_read_u16_d16_hi v59, v10 offset:3456
    ds_read_u16_d16 v60, v10 offset:4608
    ds_read_u16_d16_hi v61, v10 offset:5760
    ds_read_u16_d16 v62, v10 offset:6912
    ds_read_u16_d16_hi v63, v10 offset:8064
    s_waitcnt lgkmcnt(8)
    v_or_b32 v72, v48, v49
    v_or_b32 v73, v50, v51
    v_or_b32 v74, v52, v53
    v_or_b32 v75, v54, v55
    buffer_store_dwordx4 v[72:75], v7, s[36:39], s64 offen
    s_mov_b32 s63, s48
    s_mov_b32 s64, s52
    v_add_u32 v10, s63, v6
    ds_read_u16_d16 v48, v10 offset:0
    ds_read_u16_d16_hi v49, v10 offset:1152
    ds_read_u16_d16 v50, v10 offset:2304
    ds_read_u16_d16_hi v51, v10 offset:3456
    ds_read_u16_d16 v52, v10 offset:4608
    ds_read_u16_d16_hi v53, v10 offset:5760
    ds_read_u16_d16 v54, v10 offset:6912
    ds_read_u16_d16_hi v55, v10 offset:8064
    s_waitcnt lgkmcnt(8)
    v_or_b32 v64, v56, v57
    v_or_b32 v65, v58, v59
    v_or_b32 v66, v60, v61
    v_or_b32 v67, v62, v63
    buffer_store_dwordx4 v[64:67], v7, s[36:39], s65 offen
    s_add_u32 s63, s48, s50
    s_add_u32 s65, s52, s53
    s_add_u32 s48, s48, s49
    s_add_u32 s52, s52, s54
    v_add_u32 v10, s63, v6
    ds_read_u16_d16 v56, v10 offset:0
    ds_read_u16_d16_hi v57, v10 offset:1152
    ds_read_u16_d16 v58, v10 offset:2304
    ds_read_u16_d16_hi v59, v10 offset:3456
    ds_read_u16_d16 v60, v10 offset:4608
    ds_read_u16_d16_hi v61, v10 offset:5760
    ds_read_u16_d16 v62, v10 offset:6912
    ds_read_u16_d16_hi v63, v10 offset:8064
    s_waitcnt lgkmcnt(8)
    v_or_b32 v68, v48, v49
    v_or_b32 v69, v50, v51
    v_or_b32 v70, v52, v53
    v_or_b32 v71, v54, v55
    buffer_store_dwordx4 v[68:71], v7, s[36:39], s64 offen
    s_mov_b32 s63, s48
    s_mov_b32 s64, s52
    v_add_u32 v10, s63, v6
    ds_read_u16_d16 v48, v10 offset:0
    ds_read_u16_d16_hi v49, v10 offset:1152
    ds_read_u16_d16 v50, v10 offset:2304
    ds_read_u16_d16_hi v51, v10 offset:3456
    ds_read_u16_d16 v52, v10 offset:4608
    ds_read_u16_d16_hi v53, v10 offset:5760
    ds_read_u16_d16 v54, v10 offset:6912
    ds_read_u16_d16_hi v55, v10 offset:8064
    s_waitcnt lgkmcnt(8)
    v_or_b32 v72, v56, v57
    v_or_b32 v73, v58, v59
    v_or_b32 v74, v60, v61
    v_or_b32 v75, v62, v63
    buffer_store_dwordx4 v[72:75], v7, s[36:39], s65 offen
    s_add_u32 s63, s48, s50
    s_add_u32 s65, s52, s53
    s_add_u32 s48, s48, s49
    s_add_u32 s52, s52, s62
    v_add_u32 v10, s63, v6
    ds_read_u16_d16 v56, v10 offset:0
    ds_read_u16_d16_hi v57, v10 offset:1152
    ds_read_u16_d16 v58, v10 offset:2304
    ds_read_u16_d16_hi v59, v10 offset:3456
    ds_read_u16_d16 v60, v10 offset:4608
    ds_read_u16_d16_hi v61, v10 offset:5760
    ds_read_u16_d16 v62, v10 offset:6912
    ds_read_u16_d16_hi v63, v10 offset:8064
    s_waitcnt lgkmcnt(8)
    v_or_b32 v64, v48, v49
    v_or_b32 v65, v50, v51
    v_or_b32 v66, v52, v53
    v_or_b32 v67, v54, v55
    buffer_store_dwordx4 v[64:67], v7, s[36:39], s64 offen
    s_mov_b32 s63, s51
    s_mov_b32 s64, s55
    v_add_u32 v10, s63, v8
    ds_read_u16_d16 v48, v10 offset:0
    ds_read_u16_d16_hi v49, v10 offset:1152
    ds_read_u16_d16 v50, v10 offset:2304
    ds_read_u16_d16_hi v51, v10 offset:3456
    ds_read_u16_d16 v52, v10 offset:4608
    ds_read_u16_d16_hi v53, v10 offset:5760
    ds_read_u16_d16 v54, v10 offset:6912
    ds_read_u16_d16_hi v55, v10 offset:8064
    s_waitcnt lgkmcnt(8)
    v_or_b32 v68, v56, v57
    v_or_b32 v69, v58, v59
    v_or_b32 v70, v60, v61
    v_or_b32 v71, v62, v63
    buffer_store_dwordx4 v[68:71], v7, s[36:39], s65 offen
    s_waitcnt lgkmcnt(0)
    v_or_b32 v72, v48, v49
    v_or_b32 v73, v50, v51
    v_or_b32 v74, v52, v53
    v_or_b32 v75, v54, v55
    buffer_store_dwordx4 v[72:75], v7, s[36:39], s64 offen
    s_cmp_ge_u32 s2, 54
    s_cbranch_scc1 L0_exit
    s_cmp_lg_u32 s57, 2
    s_cbranch_scc1 L0_exit
    v_mov_b32 v16, 0
    v_mov_b32 v17, 0
    v_mov_b32 v18, 0
    v_mov_b32 v19, 0
    buffer_store_dwordx4 v[16:19], v7, s[36:39], s64 offen offset:2048
    s_endpgm
L0_pf:
    v_and_b32 v1, 63, v0
    v_lshlrev_b32 v2, 4, v1
    s_getpc_b64 s[28:29]
Lpc0:
    s_add_u32 s28, s28, k1_kernel-Lpc0
    s_addc_u32 s29, s29, 0
    s_mul_i32 s30, s3, 7168
    v_add_u32 v4, s30, v2
    v_min_u32 v5, L1_exit-k1_kernel-16, v4
    global_load_dwordx4 v[8:11], v5, s[28:29]
    v_add_u32 v4, 1024, v4
    v_min_u32 v5, L1_exit-k1_kernel-16, v4
    global_load_dwordx4 v[8:11], v5, s[28:29]
    v_add_u32 v4, 1024, v4
    v_min_u32 v5, L1_exit-k1_kernel-16, v4
    global_load_dwordx4 v[8:11], v5, s[28:29]
    v_add_u32 v4, 1024, v4
    v_min_u32 v5, L1_exit-k1_kernel-16, v4
    global_load_dwordx4 v[8:11], v5, s[28:29]
    v_add_u32 v4, 1024, v4
    v_min_u32 v5, L1_exit-k1_kernel-16, v4
    global_load_dwordx4 v[8:11], v5, s[28:29]
    v_add_u32 v4, 1024, v4
    v_min_u32 v5, L1_exit-k1_kernel-16, v4
    global_load_dwordx4 v[8:11], v5, s[28:29]
    v_add_u32 v4, 1024, v4
    v_min_u32 v5, L1_exit-k1_kernel-16, v4
    global_load_dwordx4 v[8:11], v5, s[28:29]
L0_exit:
    s_endpgm
.text
.globl k1_kernel
.p2align 8
.type k1_kernel,@function
k1_kernel:
    s_cmp_ge_u32 s2, 256
    s_cbranch_scc1 L1_exit
    s_load_dwordx16 s[4:19], s[0:1], 0
    s_load_dwordx8 s[20:27], s[0:1], 64
    v_lshrrev_b32 v1, 6, v0
    s_nop 0
    v_readfirstlane_b32 s3, v1
    s_and_b32 s28, s2, 3
    s_lshl_b32 s28, s28, 2
    s_bfe_u32 s29, s2, 0x20003
    s_add_u32 s28, s28, s29
    s_lshr_b32 s30, s2, 5
    s_cmp_eq_u32 s30, 7
    s_cbranch_scc1 L1_idle
    s_bfe_u32 s29, s2, 0x10002
    s_mul_i32 s29, s29, 7
    s_add_u32 s29, s29, s30
    s_cmp_ge_u32 s29, 14
    s_cbranch_scc1 L1_exit
    s_lshl_b32 s30, s28, 2
    s_add_u32 s30, s30, s3
    v_and_b32 v1, 63, v0
    v_lshlrev_b32 v2, 4, v1
    v_add_u32 v3, 5120, v2
    v_add_u32 v4, 0x10000, v3
    v_add_u32 v18, 0x20000, v3
    s_mov_b32 s68, 0xffff0000
    v_lshrrev_b32 v6, 5, v1
    v_lshlrev_b32 v5, 6, v6
    s_waitcnt lgkmcnt(0)
    s_add_u32 s32, s26, 0x100000
    s_addc_u32 s33, s27, 0
    s_mov_b32 s34, 0x240000
    s_mov_b32 s35, 0x20000
    s_add_u32 s36, s26, 0x700000
    s_addc_u32 s37, s27, 0
    s_mov_b32 s38, 0x1f8000
    s_mov_b32 s39, 0x20000
    s_add_u32 s34, s30, 1
    s_mul_i32 s34, s34, 36864
    s_add_u32 s40, s26, 0x60000
    s_addc_u32 s41, s27, 0
    s_mov_b32 s42, 0x6c00
    s_mov_b32 s43, 0x20000
    s_add_u32 s44, s26, 0xa00000
    s_addc_u32 s45, s27, 0
    s_mov_b32 s46, 0x7c0000
    s_mov_b32 s47, 0x20000
    v_lshlrev_b32 v7, 4, v0
    buffer_load_dwordx4 v[8:11], v7, s[40:43], 0 offen offset:2304
    buffer_load_dwordx4 v[12:15], v7, s[40:43], 0 offen
    s_movk_i32 s48, 13824
    buffer_load_dwordx4 v[24:27], v7, s[40:43], s48 offen offset:2304
    buffer_load_dwordx4 v[28:31], v7, s[40:43], s48 offen
    s_mul_i32 s48, s30, 36864
    s_mul_i32 s49, s29, 147456
    s_add_u32 s38, s49, 147456
    s_mul_i32 s50, s3, 6144
    s_add_u32 s49, s49, s50
    s_add_u32 s50, s50, 5120
    s_cmp_ge_u32 s29, 9
    s_cbranch_scc1 L1_v
    s_add_u32 m0, s50, 0
    s_add_u32 s67, s49, 0
    buffer_load_dwordx4 v2, s[36:39], s67 offen offset:0 lds
    buffer_load_dwordx4 v2, s[36:39], s67 offen offset:1024 lds
    buffer_load_dwordx4 v2, s[36:39], s67 offen offset:2048 lds
    buffer_load_dwordx4 v2, s[36:39], s67 offen offset:3072 lds
    s_add_u32 m0, s50, 4096
    s_add_u32 s67, s67, 4096
    buffer_load_dwordx4 v2, s[36:39], s67 offen offset:0 lds
    buffer_load_dwordx4 v2, s[36:39], s67 offen offset:1024 lds
    buffer_load_dwordx4 v[32:35], v2, s[32:35], s48 offen offset:0
    buffer_load_dwordx4 v[36:39], v2, s[32:35], s48 offen offset:1024
    buffer_load_dwordx4 v[40:43], v2, s[32:35], s48 offen offset:2048
    buffer_load_dwordx4 v[44:47], v2, s[32:35], s48 offen offset:3072
    s_add_u32 s48, s48, 4096
    buffer_load_dwordx4 v[48:51], v2, s[32:35], s48 offen offset:0
    buffer_load_dwordx4 v[52:55], v2, s[32:35], s48 offen offset:1024
    s_waitcnt vmcnt(12)
    v_add_f32 v8, v8, v24
    v_add_f32 v9, v9, v25
    v_add_f32 v10, v10, v26
    v_add_f32 v11, v11, v27
    v_add_f32 v12, v12, v28
    v_add_f32 v13, v13, v29
    v_add_f32 v14, v14, v30
    v_add_f32 v15, v15, v31
    v_cvt_pk_bf16_f32 v8, v8, v8
    v_cvt_pk_bf16_f32 v9, v9, v9
    v_cvt_pk_bf16_f32 v10, v10, v10
    v_cvt_pk_bf16_f32 v11, v11, v11
    v_cvt_pk_bf16_f32 v12, v12, v12
    v_cvt_pk_bf16_f32 v13, v13, v13
    v_cvt_pk_bf16_f32 v14, v14, v14
    v_cvt_pk_bf16_f32 v15, v15, v15
    v_and_b32 v8, s68, v8
    v_and_b32 v9, s68, v9
    v_and_b32 v10, s68, v10
    v_and_b32 v11, s68, v11
    v_and_b32 v12, s68, v12
    v_and_b32 v13, s68, v13
    v_and_b32 v14, s68, v14
    v_and_b32 v15, s68, v15
    s_add_u32 m0, s50, 24576
    s_add_u32 s67, s49, 24576
    buffer_load_dwordx4 v2, s[36:39], s67 offen offset:0 lds
    buffer_load_dwordx4 v2, s[36:39], s67 offen offset:1024 lds
    v_add_f32 v8, 1.0, v8
    v_add_f32 v9, 1.0, v9
    v_add_f32 v10, 1.0, v10
    v_add_f32 v11, 1.0, v11
    v_cvt_pk_bf16_f32 v8, v8, v8
    v_cvt_pk_bf16_f32 v9, v9, v9
    v_cvt_pk_bf16_f32 v10, v10, v10
    v_cvt_pk_bf16_f32 v11, v11, v11
    v_and_b32 v8, s68, v8
    v_and_b32 v9, s68, v9
    v_and_b32 v10, s68, v10
    v_and_b32 v11, s68, v11
    v_lshrrev_b32 v16, 1, v0
    v_lshlrev_b32 v16, 6, v16
    v_and_b32 v17, 1, v0
    v_lshl_add_u32 v16, v17, 4, v16
    v_cmp_gt_u32 vcc, 144, v0
    s_nop 0
    s_and_saveexec_b64 s[52:53], vcc
    ds_write_b128 v16, v[8:11]
    ds_write_b128 v16, v[12:15] offset:32
    s_mov_b64 exec, s[52:53]
    s_waitcnt vmcnt(8) lgkmcnt(0)
    s_barrier
    ds_read_b128 v[200:203], v5 offset:0
    ds_read_b128 v[204:207], v5 offset:16
    ds_read_b128 v[208:211], v5 offset:32
    ds_read_b128 v[212:215], v5 offset:48
    ds_read_b128 v[216:219], v5 offset:128
    ds_read_b128 v[220:223], v5 offset:144
    ds_read_b128 v[224:227], v5 offset:160
    ds_read_b128 v[228:231], v5 offset:176
    ds_read_b128 a[0:3], v3 offset:0
    ds_read_b128 a[4:7], v3 offset:1024
    ds_read_b128 a[8:11], v3 offset:2048
    ds_read_b128 a[12:15], v3 offset:3072
    buffer_load_dwordx4 v2, s[36:39], s67 offen offset:2048 lds
    buffer_load_dwordx4 v2, s[36:39], s67 offen offset:3072 lds
    s_waitcnt vmcnt(8) lgkmcnt(4)
    ds_read_b128 a[16:19], v3 offset:4096
    ds_read_b128 a[20:23], v3 offset:5120
    ds_read_b128 a[24:27], v3 offset:6144
    ds_read_b128 a[28:31], v3 offset:7168
    v_lshlrev_b32 v232, 16, v32
    v_and_b32 v233, s68, v32
    v_lshlrev_b32 v234, 16, v33
    v_and_b32 v235, s68, v33
    v_lshlrev_b32 v236, 16, v34
    v_and_b32 v237, s68, v34
    v_lshlrev_b32 v238, 16, v35
    v_and_b32 v239, s68, v35
    v_lshlrev_b32 v240, 16, v36
    v_and_b32 v241, s68, v36
    v_lshlrev_b32 v242, 16, v37
    v_and_b32 v243, s68, v37
    v_lshlrev_b32 v244, 16, v38
    v_and_b32 v245, s68, v38
    v_lshlrev_b32 v246, 16, v39
    v_and_b32 v247, s68, v39
    v_pk_fma_f32 v[232:233], v[232:233], v[200:201], v[208:209]
    v_pk_fma_f32 v[234:235], v[234:235], v[202:203], v[210:211]
    v_pk_fma_f32 v[236:237], v[236:237], v[204:205], v[212:213]
    v_pk_fma_f32 v[238:239], v[238:239], v[206:207], v[214:215]
    v_pk_fma_f32 v[240:241], v[240:241], v[216:217], v[224:225]
    v_pk_fma_f32 v[242:243], v[242:243], v[218:219], v[226:227]
    v_pk_fma_f32 v[244:245], v[244:245], v[220:221], v[228:229]
    v_pk_fma_f32 v[246:247], v[246:247], v[222:223], v[230:231]
    v_cvt_pk_bf16_f32 v248, v232, v233
    v_cvt_pk_bf16_f32 v249, v234, v235
    v_cvt_pk_bf16_f32 v250, v236, v237
    v_cvt_pk_bf16_f32 v251, v238, v239
    s_waitcnt lgkmcnt(4)
    s_nop 0
    v_mfma_f32_32x32x16_bf16 v[136:151], a[0:3], v[248:251], 0
    v_cvt_pk_bf16_f32 v252, v240, v241
    v_cvt_pk_bf16_f32 v253, v242, v243
    v_cvt_pk_bf16_f32 v254, v244, v245
    v_cvt_pk_bf16_f32 v255, v246, v247
    ds_read_b128 v[200:203], v5 offset:256
    ds_read_b128 v[204:207], v5 offset:272
    s_add_u32 m0, s50, 28672
    s_add_u32 s67, s67, 4096
    buffer_load_dwordx4 v2, s[36:39], s67 offen offset:0 lds
    v_mfma_f32_32x32x16_bf16 v[152:167], a[4:7], v[248:251], 0
    s_waitcnt vmcnt(7)
    ds_read_b128 v[208:211], v5 offset:288
    ds_read_b128 v[212:215], v5 offset:304
    ds_read_b128 v[216:219], v5 offset:384
    buffer_load_dwordx4 v2, s[36:39], s67 offen offset:1024 lds
    v_mfma_f32_32x32x16_bf16 v[168:183], a[8:11], v[248:251], 0
    v_lshlrev_b32 v232, 16, v40
    v_and_b32 v233, s68, v40
    v_lshlrev_b32 v234, 16, v41
    ds_read_b128 v[220:223], v5 offset:400
    ds_read_b128 v[224:227], v5 offset:416
    ds_read_b128 v[228:231], v5 offset:432
    buffer_load_dwordx4 v[56:59], v2, s[32:35], s48 offen offset:2048
    v_mfma_f32_32x32x16_bf16 v[184:199], a[12:15], v[248:251], 0
    v_and_b32 v235, s68, v41
    v_lshlrev_b32 v236, 16, v42
    v_and_b32 v237, s68, v42
    ds_read_b128 a[32:35], v3 offset:8192
    ds_read_b128 a[36:39], v3 offset:9216
    buffer_load_dwordx4 v[60:63], v2, s[32:35], s48 offen offset:3072
    s_waitcnt lgkmcnt(10)
    v_mfma_f32_32x32x16_bf16 v[136:151], a[16:19], v[252:255], v[136:151]
    v_lshlrev_b32 v238, 16, v43
    v_and_b32 v239, s68, v43
    v_lshlrev_b32 v240, 16, v44
    ds_read_b128 a[40:43], v3 offset:10240
    ds_read_b128 a[44:47], v3 offset:11264
    s_add_u32 s48, s48, 4096
    buffer_load_dwordx4 v[64:67], v2, s[32:35], s48 offen offset:0
    v_mfma_f32_32x32x16_bf16 v[152:167], a[20:23], v[252:255], v[152:167]
    v_and_b32 v241, s68, v44
    v_lshlrev_b32 v242, 16, v45
    v_and_b32 v243, s68, v45
    ds_read_b128 a[48:51], v3 offset:12288
    ds_read_b128 a[52:55], v3 offset:13312
    buffer_load_dwordx4 v[68:71], v2, s[32:35], s48 offen offset:1024
    v_mfma_f32_32x32x16_bf16 v[168:183], a[24:27], v[252:255], v[168:183]
    v_lshlrev_b32 v244, 16, v46
    v_and_b32 v245, s68, v46
    ds_read_b128 a[56:59], v3 offset:14336
    ds_read_b128 a[60:63], v3 offset:15360
    v_mfma_f32_32x32x16_bf16 v[184:199], a[28:31], v[252:255], v[184:199]
    v_lshlrev_b32 v246, 16, v47
    v_and_b32 v247, s68, v47
    buffer_load_dwordx4 v[72:75], v2, s[32:35], s48 offen offset:2048
    s_waitcnt lgkmcnt(8)
    v_pk_fma_f32 v[232:233], v[232:233], v[200:201], v[208:209]
    v_pk_fma_f32 v[234:235], v[234:235], v[202:203], v[210:211]
    v_pk_fma_f32 v[236:237], v[236:237], v[204:205], v[212:213]
    v_pk_fma_f32 v[238:239], v[238:239], v[206:207], v[214:215]
    v_pk_fma_f32 v[240:241], v[240:241], v[216:217], v[224:225]
    v_pk_fma_f32 v[242:243], v[242:243], v[218:219], v[226:227]
    v_pk_fma_f32 v[244:245], v[244:245], v[220:221], v[228:229]
    v_pk_fma_f32 v[246:247], v[246:247], v[222:223], v[230:231]
    v_cvt_pk_bf16_f32 v248, v232, v233
    v_cvt_pk_bf16_f32 v249, v234, v235
    v_cvt_pk_bf16_f32 v250, v236, v237
    v_cvt_pk_bf16_f32 v251, v238, v239
    s_waitcnt lgkmcnt(4)
    s_nop 0
    v_mfma_f32_32x32x16_bf16 v[136:151], a[32:35], v[248:251], v[136:151]
    v_cvt_pk_bf16_f32 v252, v240, v241
    v_cvt_pk_bf16_f32 v253, v242, v243
    v_cvt_pk_bf16_f32 v254, v244, v245
    v_cvt_pk_bf16_f32 v255, v246, v247
    ds_read_b128 v[200:203], v5 offset:512
    ds_read_b128 v[204:207], v5 offset:528
    buffer_load_dwordx4 v[76:79], v2, s[32:35], s48 offen offset:3072
    v_mfma_f32_32x32x16_bf16 v[152:167], a[36:39], v[248:251], v[152:167]
    s_waitcnt vmcnt(12)
    ds_read_b128 v[208:211], v5 offset:544
    ds_read_b128 v[212:215], v5 offset:560
    ds_read_b128 v[216:219], v5 offset:640
    s_add_u32 s48, s48, 4096
    s_add_u32 m0, s50, 49152
    s_add_u32 s67, s49, 49152
    buffer_load_dwordx4 v2, s[36:39], s67 offen offset:0 lds
    v_mfma_f32_32x32x16_bf16 v[168:183], a[40:43], v[248:251], v[168:183]
    v_lshlrev_b32 v232, 16, v48
    v_and_b32 v233, s68, v48
    v_lshlrev_b32 v234, 16, v49
    ds_read_b128 v[220:223], v5 offset:656
    ds_read_b128 v[224:227], v5 offset:672
    ds_read_b128 v[228:231], v5 offset:688
    buffer_load_dwordx4 v2, s[36:39], s67 offen offset:1024 lds
    v_mfma_f32_32x32x16_bf16 v[184:199], a[44:47], v[248:251], v[184:199]
    v_and_b32 v235, s68, v49
    v_lshlrev_b32 v236, 16, v50
    v_and_b32 v237, s68, v50
    ds_read_b128 a[0:3], v3 offset:16384
    ds_read_b128 a[4:7], v3 offset:17408
    buffer_load_dwordx4 v2, s[36:39], s67 offen offset:2048 lds
    s_waitcnt lgkmcnt(10)
    v_mfma_f32_32x32x16_bf16 v[136:151], a[48:51], v[252:255], v[136:151]
    v_lshlrev_b32 v238, 16, v51
    v_and_b32 v239, s68, v51
    v_lshlrev_b32 v240, 16, v52
    ds_read_b128 a[8:11], v3 offset:18432
    ds_read_b128 a[12:15], v3 offset:19456
    buffer_load_dwordx4 v2, s[36:39], s67 offen offset:3072 lds
    v_mfma_f32_32x32x16_bf16 v[152:167], a[52:55], v[252:255], v[152:167]
    v_and_b32 v241, s68, v52
    v_lshlrev_b32 v242, 16, v53
    v_and_b32 v243, s68, v53
    ds_read_b128 a[16:19], v3 offset:20480
    ds_read_b128 a[20:23], v3 offset:21504
    s_add_u32 m0, s50, 53248
    s_add_u32 s67, s67, 4096
    buffer_load_dwordx4 v2, s[36:39], s67 offen offset:0 lds
    v_mfma_f32_32x32x16_bf16 v[168:183], a[56:59], v[252:255], v[168:183]
    v_lshlrev_b32 v244, 16, v54
    v_and_b32 v245, s68, v54
    ds_read_b128 a[24:27], v3 offset:22528
    ds_read_b128 a[28:31], v3 offset:23552
    v_mfma_f32_32x32x16_bf16 v[184:199], a[60:63], v[252:255], v[184:199]
    v_lshlrev_b32 v246, 16, v55
    v_and_b32 v247, s68, v55
    buffer_load_dwordx4 v2, s[36:39], s67 offen offset:1024 lds
    s_waitcnt lgkmcnt(8)
    v_pk_fma_f32 v[232:233], v[232:233], v[200:201], v[208:209]
    v_pk_fma_f32 v[234:235], v[234:235], v[202:203], v[210:211]
    v_pk_fma_f32 v[236:237], v[236:237], v[204:205], v[212:213]
    v_pk_fma_f32 v[238:239], v[238:239], v[206:207], v[214:215]
    v_pk_fma_f32 v[240:241], v[240:241], v[216:217], v[224:225]
    v_pk_fma_f32 v[242:243], v[242:243], v[218:219], v[226:227]
    v_pk_fma_f32 v[244:245], v[244:245], v[220:221], v[228:229]
    v_pk_fma_f32 v[246:247], v[246:247], v[222:223], v[230:231]
    v_cvt_pk_bf16_f32 v248, v232, v233
    v_cvt_pk_bf16_f32 v249, v234, v235
    v_cvt_pk_bf16_f32 v250, v236, v237
    v_cvt_pk_bf16_f32 v251, v238, v239
    s_waitcnt lgkmcnt(4)
    s_nop 0
    v_mfma_f32_32x32x16_bf16 v[136:151], a[0:3], v[248:251], v[136:151]
    v_cvt_pk_bf16_f32 v252, v240, v241
    v_cvt_pk_bf16_f32 v253, v242, v243
    v_cvt_pk_bf16_f32 v254, v244, v245
    v_cvt_pk_bf16_f32 v255, v246, v247
    ds_read_b128 v[200:203], v5 offset:768
    ds_read_b128 v[204:207], v5 offset:784
    buffer_load_dwordx4 v[80:83], v2, s[32:35], s48 offen offset:0
    v_mfma_f32_32x32x16_bf16 v[152:167], a[4:7], v[248:251], v[152:167]
    s_waitcnt vmcnt(11)
    ds_read_b128 v[208:211], v5 offset:800
    ds_read_b128 v[212:215], v5 offset:816
    ds_read_b128 v[216:219], v5 offset:896
    buffer_load_dwordx4 v[84:87], v2, s[32:35], s48 offen offset:1024
    v_mfma_f32_32x32x16_bf16 v[168:183], a[8:11], v[248:251], v[168:183]
    v_lshlrev_b32 v232, 16, v56
    v_and_b32 v233, s68, v56
    v_lshlrev_b32 v234, 16, v57
    ds_read_b128 v[220:223], v5 offset:912
    ds_read_b128 v[224:227], v5 offset:928
    ds_read_b128 v[228:231], v5 offset:944
    buffer_load_dwordx4 v[88:91], v2, s[32:35], s48 offen offset:2048
    v_mfma_f32_32x32x16_bf16 v[184:199], a[12:15], v[248:251], v[184:199]
    v_and_b32 v235, s68, v57
    v_lshlrev_b32 v236, 16, v58
    v_and_b32 v237, s68, v58
    s_barrier
    buffer_load_dwordx4 v[92:95], v2, s[32:35], s48 offen offset:3072
    s_waitcnt lgkmcnt(8)
    v_mfma_f32_32x32x16_bf16 v[136:151], a[16:19], v[252:255], v[136:151]
    v_lshlrev_b32 v238, 16, v59
    v_and_b32 v239, s68, v59
    v_lshlrev_b32 v240, 16, v60
    ds_read_b128 a[32:35], v3 offset:24576
    ds_read_b128 a[36:39], v3 offset:25600
    s_add_u32 s48, s48, 4096
    buffer_load_dwordx4 v[96:99], v2, s[32:35], s48 offen offset:0
    v_mfma_f32_32x32x16_bf16 v[152:167], a[20:23], v[252:255], v[152:167]
    v_and_b32 v241, s68, v60
    v_lshlrev_b32 v242, 16, v61
    v_and_b32 v243, s68, v61
    ds_read_b128 a[40:43], v3 offset:26624
    ds_read_b128 a[44:47], v3 offset:27648
    buffer_load_dwordx4 v[100:103], v2, s[32:35], s48 offen offset:1024
    v_mfma_f32_32x32x16_bf16 v[168:183], a[24:27], v[252:255], v[168:183]
    v_lshlrev_b32 v244, 16, v62
    v_and_b32 v245, s68, v62
    ds_read_b128 a[48:51], v3 offset:28672
    ds_read_b128 a[52:55], v3 offset:29696
    v_mfma_f32_32x32x16_bf16 v[184:199], a[28:31], v[252:255], v[184:199]
    v_lshlrev_b32 v246, 16, v63
    v_and_b32 v247, s68, v63
    ds_read_b128 a[56:59], v3 offset:30720
    ds_read_b128 a[60:63], v3 offset:31744
    s_add_u32 m0, s50, 73728
    s_add_u32 s67, s49, 73728
    buffer_load_dwordx4 v2, s[36:39], s67 offen offset:0 lds
    s_waitcnt lgkmcnt(8)
    v_pk_fma_f32 v[232:233], v[232:233], v[200:201], v[208:209]
    v_pk_fma_f32 v[234:235], v[234:235], v[202:203], v[210:211]
    v_pk_fma_f32 v[236:237], v[236:237], v[204:205], v[212:213]
    v_pk_fma_f32 v[238:239], v[238:239], v[206:207], v[214:215]
    v_pk_fma_f32 v[240:241], v[240:241], v[216:217], v[224:225]
    v_pk_fma_f32 v[242:243], v[242:243], v[218:219], v[226:227]
    v_pk_fma_f32 v[244:245], v[244:245], v[220:221], v[228:229]
    v_pk_fma_f32 v[246:247], v[246:247], v[222:223], v[230:231]
    v_cvt_pk_bf16_f32 v248, v232, v233
    v_cvt_pk_bf16_f32 v249, v234, v235
    v_cvt_pk_bf16_f32 v250, v236, v237
    v_cvt_pk_bf16_f32 v251, v238, v239
    s_waitcnt lgkmcnt(4)
    s_nop 0
    v_mfma_f32_32x32x16_bf16 v[136:151], a[32:35], v[248:251], v[136:151]
    v_cvt_pk_bf16_f32 v252, v240, v241
    v_cvt_pk_bf16_f32 v253, v242, v243
    v_cvt_pk_bf16_f32 v254, v244, v245
    v_cvt_pk_bf16_f32 v255, v246, v247
    ds_read_b128 v[200:203], v5 offset:1024
    ds_read_b128 v[204:207], v5 offset:1040
    buffer_load_dwordx4 v2, s[36:39], s67 offen offset:1024 lds
    v_mfma_f32_32x32x16_bf16 v[152:167], a[36:39], v[248:251], v[152:167]
    s_waitcnt vmcnt(16)
    ds_read_b128 v[208:211], v5 offset:1056
    ds_read_b128 v[212:215], v5 offset:1072
    ds_read_b128 v[216:219], v5 offset:1152
    buffer_load_dwordx4 v2, s[36:39], s67 offen offset:2048 lds
    v_mfma_f32_32x32x16_bf16 v[168:183], a[40:43], v[248:251], v[168:183]
    v_lshlrev_b32 v232, 16, v64
    v_and_b32 v233, s68, v64
    v_lshlrev_b32 v234, 16, v65
    ds_read_b128 v[220:223], v5 offset:1168
    ds_read_b128 v[224:227], v5 offset:1184
    ds_read_b128 v[228:231], v5 offset:1200
    buffer_load_dwordx4 v2, s[36:39], s67 offen offset:3072 lds
    v_mfma_f32_32x32x16_bf16 v[184:199], a[44:47], v[248:251], v[184:199]
    v_and_b32 v235, s68, v65
    v_lshlrev_b32 v236, 16, v66
    v_and_b32 v237, s68, v66
    ds_read_b128 a[0:3], v3 offset:32768
    ds_read_b128 a[4:7], v3 offset:33792
    s_add_u32 m0, s50, 77824
    s_add_u32 s67, s67, 4096
    buffer_load_dwordx4 v2, s[36:39], s67 offen offset:0 lds
    s_waitcnt lgkmcnt(10)
    v_mfma_f32_32x32x16_bf16 v[136:151], a[48:51], v[252:255], v[136:151]
    v_lshlrev_b32 v238, 16, v67
    v_and_b32 v239, s68, v67
    v_lshlrev_b32 v240, 16, v68
    ds_read_b128 a[8:11], v3 offset:34816
    ds_read_b128 a[12:15], v3 offset:35840
    buffer_load_dwordx4 v2, s[36:39], s67 offen offset:1024 lds
    v_mfma_f32_32x32x16_bf16 v[152:167], a[52:55], v[252:255], v[152:167]
    v_and_b32 v241, s68, v68
    v_lshlrev_b32 v242, 16, v69
    v_and_b32 v243, s68, v69
    ds_read_b128 a[16:19], v3 offset:36864
    ds_read_b128 a[20:23], v3 offset:37888
    buffer_load_dwordx4 v[104:107], v2, s[32:35], s48 offen offset:2048
    v_mfma_f32_32x32x16_bf16 v[168:183], a[56:59], v[252:255], v[168:183]
    v_lshlrev_b32 v244, 16, v70
    v_and_b32 v245, s68, v70
    ds_read_b128 a[24:27], v3 offset:38912
    ds_read_b128 a[28:31], v3 offset:39936
    v_mfma_f32_32x32x16_bf16 v[184:199], a[60:63], v[252:255], v[184:199]
    v_lshlrev_b32 v246, 16, v71
    v_and_b32 v247, s68, v71
    buffer_load_dwordx4 v[108:111], v2, s[32:35], s48 offen offset:3072
    s_waitcnt lgkmcnt(8)
    v_pk_fma_f32 v[232:233], v[232:233], v[200:201], v[208:209]
    v_pk_fma_f32 v[234:235], v[234:235], v[202:203], v[210:211]
    v_pk_fma_f32 v[236:237], v[236:237], v[204:205], v[212:213]
    v_pk_fma_f32 v[238:239], v[238:239], v[206:207], v[214:215]
    v_pk_fma_f32 v[240:241], v[240:241], v[216:217], v[224:225]
    v_pk_fma_f32 v[242:243], v[242:243], v[218:219], v[226:227]
    v_pk_fma_f32 v[244:245], v[244:245], v[220:221], v[228:229]
    v_pk_fma_f32 v[246:247], v[246:247], v[222:223], v[230:231]
    v_cvt_pk_bf16_f32 v248, v232, v233
    v_cvt_pk_bf16_f32 v249, v234, v235
    v_cvt_pk_bf16_f32 v250, v236, v237
    v_cvt_pk_bf16_f32 v251, v238, v239
    s_waitcnt lgkmcnt(4)
    s_nop 0
    v_mfma_f32_32x32x16_bf16 v[136:151], a[0:3], v[248:251], v[136:151]
    v_cvt_pk_bf16_f32 v252, v240, v241
    v_cvt_pk_bf16_f32 v253, v242, v243
    v_cvt_pk_bf16_f32 v254, v244, v245
    v_cvt_pk_bf16_f32 v255, v246, v247
    ds_read_b128 v[200:203], v5 offset:1280
    ds_read_b128 v[204:207], v5 offset:1296
    v_mfma_f32_32x32x16_bf16 v[152:167], a[4:7], v[248:251], v[152:167]
    s_waitcnt vmcnt(20)
    ds_read_b128 v[208:211], v5 offset:1312
    ds_read_b128 v[212:215], v5 offset:1328
    ds_read_b128 v[216:219], v5 offset:1408
    s_add_u32 s48, s48, 4096
    buffer_load_dwordx4 v[112:115], v2, s[32:35], s48 offen offset:0
    v_mfma_f32_32x32x16_bf16 v[168:183], a[8:11], v[248:251], v[168:183]
    v_lshlrev_b32 v232, 16, v72
    v_and_b32 v233, s68, v72
    v_lshlrev_b32 v234, 16, v73
    ds_read_b128 v[220:223], v5 offset:1424
    ds_read_b128 v[224:227], v5 offset:1440
    ds_read_b128 v[228:231], v5 offset:1456
    v_mfma_f32_32x32x16_bf16 v[184:199], a[12:15], v[248:251], v[184:199]
    v_and_b32 v235, s68, v73
    v_lshlrev_b32 v236, 16, v74
    v_and_b32 v237, s68, v74
    ds_read_b128 a[32:35], v3 offset:40960
    ds_read_b128 a[36:39], v3 offset:41984
    buffer_load_dwordx4 v[116:119], v2, s[32:35], s48 offen offset:1024
    s_waitcnt lgkmcnt(10)
    v_mfma_f32_32x32x16_bf16 v[136:151], a[16:19], v[252:255], v[136:151]
    v_lshlrev_b32 v238, 16, v75
    v_and_b32 v239, s68, v75
    v_lshlrev_b32 v240, 16, v76
    ds_read_b128 a[40:43], v3 offset:43008
    ds_read_b128 a[44:47], v3 offset:44032
    v_mfma_f32_32x32x16_bf16 v[152:167], a[20:23], v[252:255], v[152:167]
    v_and_b32 v241, s68, v76
    v_lshlrev_b32 v242, 16, v77
    v_and_b32 v243, s68, v77
    ds_read_b128 a[48:51], v3 offset:45056
    ds_read_b128 a[52:55], v3 offset:46080
    buffer_load_dwordx4 v[120:123], v2, s[32:35], s48 offen offset:2048
    v_mfma_f32_32x32x16_bf16 v[168:183], a[24:27], v[252:255], v[168:183]
    v_lshlrev_b32 v244, 16, v78
    v_and_b32 v245, s68, v78
    ds_read_b128 a[56:59], v3 offset:47104
    ds_read_b128 a[60:63], v3 offset:48128
    v_mfma_f32_32x32x16_bf16 v[184:199], a[28:31], v[252:255], v[184:199]
    v_lshlrev_b32 v246, 16, v79
    v_and_b32 v247, s68, v79
    buffer_load_dwordx4 v[124:127], v2, s[32:35], s48 offen offset:3072
    s_waitcnt lgkmcnt(8)
    v_pk_fma_f32 v[232:233], v[232:233], v[200:201], v[208:209]
    v_pk_fma_f32 v[234:235], v[234:235], v[202:203], v[210:211]
    v_pk_fma_f32 v[236:237], v[236:237], v[204:205], v[212:213]
    v_pk_fma_f32 v[238:239], v[238:239], v[206:207], v[214:215]
    v_pk_fma_f32 v[240:241], v[240:241], v[216:217], v[224:225]
    v_pk_fma_f32 v[242:243], v[242:243], v[218:219], v[226:227]
    v_pk_fma_f32 v[244:245], v[244:245], v[220:221], v[228:229]
    v_pk_fma_f32 v[246:247], v[246:247], v[222:223], v[230:231]
    v_cvt_pk_bf16_f32 v248, v232, v233
    v_cvt_pk_bf16_f32 v249, v234, v235
    v_cvt_pk_bf16_f32 v250, v236, v237
    v_cvt_pk_bf16_f32 v251, v238, v239
    s_waitcnt lgkmcnt(4)
    s_nop 0
    v_mfma_f32_32x32x16_bf16 v[136:151], a[32:35], v[248:251], v[136:151]
    v_cvt_pk_bf16_f32 v252, v240, v241
    v_cvt_pk_bf16_f32 v253, v242, v243
    v_cvt_pk_bf16_f32 v254, v244, v245
    v_cvt_pk_bf16_f32 v255, v246, v247
    ds_read_b128 v[200:203], v5 offset:1536
    ds_read_b128 v[204:207], v5 offset:1552
    v_mfma_f32_32x32x16_bf16 v[152:167], a[36:39], v[248:251], v[152:167]
    s_waitcnt vmcnt(16)
    ds_read_b128 v[208:211], v5 offset:1568
    ds_read_b128 v[212:215], v5 offset:1584
    ds_read_b128 v[216:219], v5 offset:1664
    s_add_u32 s48, s48, 4096
    s_add_u32 m0, s50, 98304
    s_add_u32 s67, s49, 98304
    buffer_load_dwordx4 v2, s[36:39], s67 offen offset:0 lds
    v_mfma_f32_32x32x16_bf16 v[168:183], a[40:43], v[248:251], v[168:183]
    v_lshlrev_b32 v232, 16, v80
    v_and_b32 v233, s68, v80
    v_lshlrev_b32 v234, 16, v81
    ds_read_b128 v[220:223], v5 offset:1680
    ds_read_b128 v[224:227], v5 offset:1696
    ds_read_b128 v[228:231], v5 offset:1712
    v_mfma_f32_32x32x16_bf16 v[184:199], a[44:47], v[248:251], v[184:199]
    v_and_b32 v235, s68, v81
    v_lshlrev_b32 v236, 16, v82
    v_and_b32 v237, s68, v82
    s_barrier
    buffer_load_dwordx4 v2, s[36:39], s67 offen offset:1024 lds
    s_waitcnt lgkmcnt(8)
    v_mfma_f32_32x32x16_bf16 v[136:151], a[48:51], v[252:255], v[136:151]
    v_lshlrev_b32 v238, 16, v83
    v_and_b32 v239, s68, v83
    v_lshlrev_b32 v240, 16, v84
    ds_read_b128 a[0:3], v3 offset:49152
    ds_read_b128 a[4:7], v3 offset:50176
    v_mfma_f32_32x32x16_bf16 v[152:167], a[52:55], v[252:255], v[152:167]
    v_and_b32 v241, s68, v84
    v_lshlrev_b32 v242, 16, v85
    v_and_b32 v243, s68, v85
    ds_read_b128 a[8:11], v3 offset:51200
    ds_read_b128 a[12:15], v3 offset:52224
    buffer_load_dwordx4 v2, s[36:39], s67 offen offset:2048 lds
    v_mfma_f32_32x32x16_bf16 v[168:183], a[56:59], v[252:255], v[168:183]
    v_lshlrev_b32 v244, 16, v86
    v_and_b32 v245, s68, v86
    ds_read_b128 a[16:19], v3 offset:53248
    ds_read_b128 a[20:23], v3 offset:54272
    v_mfma_f32_32x32x16_bf16 v[184:199], a[60:63], v[252:255], v[184:199]
    v_lshlrev_b32 v246, 16, v87
    v_and_b32 v247, s68, v87
    ds_read_b128 a[24:27], v3 offset:55296
    ds_read_b128 a[28:31], v3 offset:56320
    buffer_load_dwordx4 v2, s[36:39], s67 offen offset:3072 lds
    s_waitcnt lgkmcnt(8)
    v_pk_fma_f32 v[232:233], v[232:233], v[200:201], v[208:209]
    v_pk_fma_f32 v[234:235], v[234:235], v[202:203], v[210:211]
    v_pk_fma_f32 v[236:237], v[236:237], v[204:205], v[212:213]
    v_pk_fma_f32 v[238:239], v[238:239], v[206:207], v[214:215]
    v_pk_fma_f32 v[240:241], v[240:241], v[216:217], v[224:225]
    v_pk_fma_f32 v[242:243], v[242:243], v[218:219], v[226:227]
    v_pk_fma_f32 v[244:245], v[244:245], v[220:221], v[228:229]
    v_pk_fma_f32 v[246:247], v[246:247], v[222:223], v[230:231]
    v_cvt_pk_bf16_f32 v248, v232, v233
    v_cvt_pk_bf16_f32 v249, v234, v235
    v_cvt_pk_bf16_f32 v250, v236, v237
    v_cvt_pk_bf16_f32 v251, v238, v239
    s_waitcnt lgkmcnt(4)
    s_nop 0
    v_mfma_f32_32x32x16_bf16 v[136:151], a[0:3], v[248:251], v[136:151]
    v_cvt_pk_bf16_f32 v252, v240, v241
    v_cvt_pk_bf16_f32 v253, v242, v243
    v_cvt_pk_bf16_f32 v254, v244, v245
    v_cvt_pk_bf16_f32 v255, v246, v247
    ds_read_b128 v[200:203], v5 offset:1792
    ds_read_b128 v[204:207], v5 offset:1808
    v_mfma_f32_32x32x16_bf16 v[152:167], a[4:7], v[248:251], v[152:167]
    s_waitcnt vmcnt(18)
    ds_read_b128 v[208:211], v5 offset:1824
    ds_read_b128 v[212:215], v5 offset:1840
    ds_read_b128 v[216:219], v5 offset:1920
    s_add_u32 m0, s50, 102400
    s_add_u32 s67, s67, 4096
    buffer_load_dwordx4 v2, s[36:39], s67 offen offset:0 lds
    v_mfma_f32_32x32x16_bf16 v[168:183], a[8:11], v[248:251], v[168:183]
    v_lshlrev_b32 v232, 16, v88
    v_and_b32 v233, s68, v88
    v_lshlrev_b32 v234, 16, v89
    ds_read_b128 v[220:223], v5 offset:1936
    ds_read_b128 v[224:227], v5 offset:1952
    ds_read_b128 v[228:231], v5 offset:1968
    v_mfma_f32_32x32x16_bf16 v[184:199], a[12:15], v[248:251], v[184:199]
    v_and_b32 v235, s68, v89
    v_lshlrev_b32 v236, 16, v90
    v_and_b32 v237, s68, v90
    ds_read_b128 a[32:35], v3 offset:57344
    ds_read_b128 a[36:39], v3 offset:58368
    buffer_load_dwordx4 v2, s[36:39], s67 offen offset:1024 lds
    s_waitcnt lgkmcnt(10)
    v_mfma_f32_32x32x16_bf16 v[136:151], a[16:19], v[252:255], v[136:151]
    v_lshlrev_b32 v238, 16, v91
    v_and_b32 v239, s68, v91
    v_lshlrev_b32 v240, 16, v92
    ds_read_b128 a[40:43], v3 offset:59392
    ds_read_b128 a[44:47], v3 offset:60416
    v_mfma_f32_32x32x16_bf16 v[152:167], a[20:23], v[252:255], v[152:167]
    v_and_b32 v241, s68, v92
    v_lshlrev_b32 v242, 16, v93
    v_and_b32 v243, s68, v93
    ds_read_b128 a[48:51], v3 offset:61440
    ds_read_b128 a[52:55], v3 offset:62464
    buffer_load_dwordx4 v[128:131], v2, s[32:35], s48 offen offset:0
    v_mfma_f32_32x32x16_bf16 v[168:183], a[24:27], v[252:255], v[168:183]
    v_lshlrev_b32 v244, 16, v94
    v_and_b32 v245, s68, v94
    ds_read_b128 a[56:59], v3 offset:63488
    ds_read_b128 a[60:63], v3 offset:64512
    v_mfma_f32_32x32x16_bf16 v[184:199], a[28:31], v[252:255], v[184:199]
    v_lshlrev_b32 v246, 16, v95
    v_and_b32 v247, s68, v95
    buffer_load_dwordx4 v[132:135], v2, s[32:35], s48 offen offset:1024
    s_waitcnt lgkmcnt(8)
    v_pk_fma_f32 v[232:233], v[232:233], v[200:201], v[208:209]
    v_pk_fma_f32 v[234:235], v[234:235], v[202:203], v[210:211]
    v_pk_fma_f32 v[236:237], v[236:237], v[204:205], v[212:213]
    v_pk_fma_f32 v[238:239], v[238:239], v[206:207], v[214:215]
    v_pk_fma_f32 v[240:241], v[240:241], v[216:217], v[224:225]
    v_pk_fma_f32 v[242:243], v[242:243], v[218:219], v[226:227]
    v_pk_fma_f32 v[244:245], v[244:245], v[220:221], v[228:229]
    v_pk_fma_f32 v[246:247], v[246:247], v[222:223], v[230:231]
    v_cvt_pk_bf16_f32 v248, v232, v233
    v_cvt_pk_bf16_f32 v249, v234, v235
    v_cvt_pk_bf16_f32 v250, v236, v237
    v_cvt_pk_bf16_f32 v251, v238, v239
    s_waitcnt lgkmcnt(4)
    s_nop 0
    v_mfma_f32_32x32x16_bf16 v[136:151], a[32:35], v[248:251], v[136:151]
    v_cvt_pk_bf16_f32 v252, v240, v241
    v_cvt_pk_bf16_f32 v253, v242, v243
    v_cvt_pk_bf16_f32 v254, v244, v245
    v_cvt_pk_bf16_f32 v255, v246, v247
    ds_read_b128 v[200:203], v5 offset:2048
    ds_read_b128 v[204:207], v5 offset:2064
    v_mfma_f32_32x32x16_bf16 v[152:167], a[36:39], v[248:251], v[152:167]
    s_waitcnt vmcnt(20)
    ds_read_b128 v[208:211], v5 offset:2080
    ds_read_b128 v[212:215], v5 offset:2096
    ds_read_b128 v[216:219], v5 offset:2176
    buffer_load_dwordx4 v[32:35], v2, s[32:35], s48 offen offset:2048
    v_mfma_f32_32x32x16_bf16 v[168:183], a[40:43], v[248:251], v[168:183]
    v_lshlrev_b32 v232, 16, v96
    v_and_b32 v233, s68, v96
    v_lshlrev_b32 v234, 16, v97
    ds_read_b128 v[220:223], v5 offset:2192
    ds_read_b128 v[224:227], v5 offset:2208
    ds_read_b128 v[228:231], v5 offset:2224
    v_mfma_f32_32x32x16_bf16 v[184:199], a[44:47], v[248:251], v[184:199]
    v_and_b32 v235, s68, v97
    v_lshlrev_b32 v236, 16, v98
    v_and_b32 v237, s68, v98
    ds_read_b128 a[0:3], v4 offset:0
    ds_read_b128 a[4:7], v4 offset:1024
    buffer_load_dwordx4 v[36:39], v2, s[32:35], s48 offen offset:3072
    s_waitcnt lgkmcnt(10)
    v_mfma_f32_32x32x16_bf16 v[136:151], a[48:51], v[252:255], v[136:151]
    v_lshlrev_b32 v238, 16, v99
    v_and_b32 v239, s68, v99
    v_lshlrev_b32 v240, 16, v100
    ds_read_b128 a[8:11], v4 offset:2048
    ds_read_b128 a[12:15], v4 offset:3072
    v_mfma_f32_32x32x16_bf16 v[152:167], a[52:55], v[252:255], v[152:167]
    v_and_b32 v241, s68, v100
    v_lshlrev_b32 v242, 16, v101
    v_and_b32 v243, s68, v101
    ds_read_b128 a[16:19], v4 offset:4096
    ds_read_b128 a[20:23], v4 offset:5120
    s_add_u32 s48, s48, 4096
    buffer_load_dwordx4 v[40:43], v2, s[32:35], s48 offen offset:0
    v_mfma_f32_32x32x16_bf16 v[168:183], a[56:59], v[252:255], v[168:183]
    v_lshlrev_b32 v244, 16, v102
    v_and_b32 v245, s68, v102
    ds_read_b128 a[24:27], v4 offset:6144
    ds_read_b128 a[28:31], v4 offset:7168
    v_mfma_f32_32x32x16_bf16 v[184:199], a[60:63], v[252:255], v[184:199]
    v_lshlrev_b32 v246, 16, v103
    v_and_b32 v247, s68, v103
    buffer_load_dwordx4 v[44:47], v2, s[32:35], s48 offen offset:1024
    s_waitcnt lgkmcnt(8)
    v_pk_fma_f32 v[232:233], v[232:233], v[200:201], v[208:209]
    v_pk_fma_f32 v[234:235], v[234:235], v[202:203], v[210:211]
    v_pk_fma_f32 v[236:237], v[236:237], v[204:205], v[212:213]
    v_pk_fma_f32 v[238:239], v[238:239], v[206:207], v[214:215]
    v_pk_fma_f32 v[240:241], v[240:241], v[216:217], v[224:225]
    v_pk_fma_f32 v[242:243], v[242:243], v[218:219], v[226:227]
    v_pk_fma_f32 v[244:245], v[244:245], v[220:221], v[228:229]
    v_pk_fma_f32 v[246:247], v[246:247], v[222:223], v[230:231]
    v_cvt_pk_bf16_f32 v248, v232, v233
    v_cvt_pk_bf16_f32 v249, v234, v235
    v_cvt_pk_bf16_f32 v250, v236, v237
    v_cvt_pk_bf16_f32 v251, v238, v239
    s_waitcnt lgkmcnt(4)
    s_nop 0
    v_mfma_f32_32x32x16_bf16 v[136:151], a[0:3], v[248:251], v[136:151]
    v_cvt_pk_bf16_f32 v252, v240, v241
    v_cvt_pk_bf16_f32 v253, v242, v243
    v_cvt_pk_bf16_f32 v254, v244, v245
    v_cvt_pk_bf16_f32 v255, v246, v247
    ds_read_b128 v[200:203], v5 offset:2304
    ds_read_b128 v[204:207], v5 offset:2320
    v_mfma_f32_32x32x16_bf16 v[152:167], a[4:7], v[248:251], v[152:167]
    s_waitcnt vmcnt(16)
    ds_read_b128 v[208:211], v5 offset:2336
    ds_read_b128 v[212:215], v5 offset:2352
    ds_read_b128 v[216:219], v5 offset:2432
    s_add_u32 m0, s50, 122880
    s_add_u32 s67, s49, 122880
    buffer_load_dwordx4 v2, s[36:39], s67 offen offset:0 lds
    v_mfma_f32_32x32x16_bf16 v[168:183], a[8:11], v[248:251], v[168:183]
    v_lshlrev_b32 v232, 16, v104
    v_and_b32 v233, s68, v104
    v_lshlrev_b32 v234, 16, v105
    ds_read_b128 v[220:223], v5 offset:2448
    ds_read_b128 v[224:227], v5 offset:2464
    ds_read_b128 v[228:231], v5 offset:2480
    v_mfma_f32_32x32x16_bf16 v[184:199], a[12:15], v[248:251], v[184:199]
    v_and_b32 v235, s68, v105
    v_lshlrev_b32 v236, 16, v106
    v_and_b32 v237, s68, v106
    s_barrier
    buffer_load_dwordx4 v2, s[36:39], s67 offen offset:1024 lds
    s_waitcnt lgkmcnt(8)
    v_mfma_f32_32x32x16_bf16 v[136:151], a[16:19], v[252:255], v[136:151]
    v_lshlrev_b32 v238, 16, v107
    v_and_b32 v239, s68, v107
    v_lshlrev_b32 v240, 16, v108
    ds_read_b128 a[32:35], v4 offset:8192
    ds_read_b128 a[36:39], v4 offset:9216
    v_mfma_f32_32x32x16_bf16 v[152:167], a[20:23], v[252:255], v[152:167]
    v_and_b32 v241, s68, v108
    v_lshlrev_b32 v242, 16, v109
    v_and_b32 v243, s68, v109
    ds_read_b128 a[40:43], v4 offset:10240
    ds_read_b128 a[44:47], v4 offset:11264
    buffer_load_dwordx4 v2, s[36:39], s67 offen offset:2048 lds
    v_mfma_f32_32x32x16_bf16 v[168:183], a[24:27], v[252:255], v[168:183]
    v_lshlrev_b32 v244, 16, v110
    v_and_b32 v245, s68, v110
    ds_read_b128 a[48:51], v4 offset:12288
    ds_read_b128 a[52:55], v4 offset:13312
    v_mfma_f32_32x32x16_bf16 v[184:199], a[28:31], v[252:255], v[184:199]
    v_lshlrev_b32 v246, 16, v111
    v_and_b32 v247, s68, v111
    ds_read_b128 a[56:59], v4 offset:14336
    ds_read_b128 a[60:63], v4 offset:15360
    buffer_load_dwordx4 v2, s[36:39], s67 offen offset:3072 lds
    s_waitcnt lgkmcnt(8)
    v_pk_fma_f32 v[232:233], v[232:233], v[200:201], v[208:209]
    v_pk_fma_f32 v[234:235], v[234:235], v[202:203], v[210:211]
    v_pk_fma_f32 v[236:237], v[236:237], v[204:205], v[212:213]
    v_pk_fma_f32 v[238:239], v[238:239], v[206:207], v[214:215]
    v_pk_fma_f32 v[240:241], v[240:241], v[216:217], v[224:225]
    v_pk_fma_f32 v[242:243], v[242:243], v[218:219], v[226:227]
    v_pk_fma_f32 v[244:245], v[244:245], v[220:221], v[228:229]
    v_pk_fma_f32 v[246:247], v[246:247], v[222:223], v[230:231]
    v_cvt_pk_bf16_f32 v248, v232, v233
    v_cvt_pk_bf16_f32 v249, v234, v235
    v_cvt_pk_bf16_f32 v250, v236, v237
    v_cvt_pk_bf16_f32 v251, v238, v239
    s_waitcnt lgkmcnt(4)
    s_nop 0
    v_mfma_f32_32x32x16_bf16 v[136:151], a[32:35], v[248:251], v[136:151]
    v_cvt_pk_bf16_f32 v252, v240, v241
    v_cvt_pk_bf16_f32 v253, v242, v243
    v_cvt_pk_bf16_f32 v254, v244, v245
    v_cvt_pk_bf16_f32 v255, v246, v247
    ds_read_b128 v[200:203], v5 offset:2560
    ds_read_b128 v[204:207], v5 offset:2576
    v_mfma_f32_32x32x16_bf16 v[152:167], a[36:39], v[248:251], v[152:167]
    s_waitcnt vmcnt(18)
    ds_read_b128 v[208:211], v5 offset:2592
    ds_read_b128 v[212:215], v5 offset:2608
    ds_read_b128 v[216:219], v5 offset:2688
    s_add_u32 m0, s50, 126976
    s_add_u32 s67, s67, 4096
    buffer_load_dwordx4 v2, s[36:39], s67 offen offset:0 lds
    v_mfma_f32_32x32x16_bf16 v[168:183], a[40:43], v[248:251], v[168:183]
    v_lshlrev_b32 v232, 16, v112
    v_and_b32 v233, s68, v112
    v_lshlrev_b32 v234, 16, v113
    ds_read_b128 v[220:223], v5 offset:2704
    ds_read_b128 v[224:227], v5 offset:2720
    ds_read_b128 v[228:231], v5 offset:2736
    v_mfma_f32_32x32x16_bf16 v[184:199], a[44:47], v[248:251], v[184:199]
    v_and_b32 v235, s68, v113
    v_lshlrev_b32 v236, 16, v114
    v_and_b32 v237, s68, v114
    ds_read_b128 a[0:3], v4 offset:16384
    ds_read_b128 a[4:7], v4 offset:17408
    buffer_load_dwordx4 v2, s[36:39], s67 offen offset:1024 lds
    s_waitcnt lgkmcnt(10)
    v_mfma_f32_32x32x16_bf16 v[136:151], a[48:51], v[252:255], v[136:151]
    v_lshlrev_b32 v238, 16, v115
    v_and_b32 v239, s68, v115
    v_lshlrev_b32 v240, 16, v116
    ds_read_b128 a[8:11], v4 offset:18432
    ds_read_b128 a[12:15], v4 offset:19456
    v_mfma_f32_32x32x16_bf16 v[152:167], a[52:55], v[252:255], v[152:167]
    v_and_b32 v241, s68, v116
    v_lshlrev_b32 v242, 16, v117
    v_and_b32 v243, s68, v117
    ds_read_b128 a[16:19], v4 offset:20480
    ds_read_b128 a[20:23], v4 offset:21504
    buffer_load_dwordx4 v[48:51], v2, s[32:35], s48 offen offset:2048
    v_mfma_f32_32x32x16_bf16 v[168:183], a[56:59], v[252:255], v[168:183]
    v_lshlrev_b32 v244, 16, v118
    v_and_b32 v245, s68, v118
    ds_read_b128 a[24:27], v4 offset:22528
    ds_read_b128 a[28:31], v4 offset:23552
    v_mfma_f32_32x32x16_bf16 v[184:199], a[60:63], v[252:255], v[184:199]
    v_lshlrev_b32 v246, 16, v119
    v_and_b32 v247, s68, v119
    buffer_load_dwordx4 v[52:55], v2, s[32:35], s48 offen offset:3072
    s_waitcnt lgkmcnt(8)
    v_pk_fma_f32 v[232:233], v[232:233], v[200:201], v[208:209]
    v_pk_fma_f32 v[234:235], v[234:235], v[202:203], v[210:211]
    v_pk_fma_f32 v[236:237], v[236:237], v[204:205], v[212:213]
    v_pk_fma_f32 v[238:239], v[238:239], v[206:207], v[214:215]
    v_pk_fma_f32 v[240:241], v[240:241], v[216:217], v[224:225]
    v_pk_fma_f32 v[242:243], v[242:243], v[218:219], v[226:227]
    v_pk_fma_f32 v[244:245], v[244:245], v[220:221], v[228:229]
    v_pk_fma_f32 v[246:247], v[246:247], v[222:223], v[230:231]
    v_cvt_pk_bf16_f32 v248, v232, v233
    v_cvt_pk_bf16_f32 v249, v234, v235
    v_cvt_pk_bf16_f32 v250, v236, v237
    v_cvt_pk_bf16_f32 v251, v238, v239
    s_waitcnt lgkmcnt(4)
    s_nop 0
    v_mfma_f32_32x32x16_bf16 v[136:151], a[0:3], v[248:251], v[136:151]
    v_cvt_pk_bf16_f32 v252, v240, v241
    v_cvt_pk_bf16_f32 v253, v242, v243
    v_cvt_pk_bf16_f32 v254, v244, v245
    v_cvt_pk_bf16_f32 v255, v246, v247
    ds_read_b128 v[200:203], v5 offset:2816
    ds_read_b128 v[204:207], v5 offset:2832
    v_mfma_f32_32x32x16_bf16 v[152:167], a[4:7], v[248:251], v[152:167]
    s_waitcnt vmcnt(20)
    ds_read_b128 v[208:211], v5 offset:2848
    ds_read_b128 v[212:215], v5 offset:2864
    ds_read_b128 v[216:219], v5 offset:2944
    s_add_u32 s48, s48, 4096
    buffer_load_dwordx4 v[56:59], v2, s[32:35], s48 offen offset:0
    v_mfma_f32_32x32x16_bf16 v[168:183], a[8:11], v[248:251], v[168:183]
    v_lshlrev_b32 v232, 16, v120
    v_and_b32 v233, s68, v120
    v_lshlrev_b32 v234, 16, v121
    ds_read_b128 v[220:223], v5 offset:2960
    ds_read_b128 v[224:227], v5 offset:2976
    ds_read_b128 v[228:231], v5 offset:2992
    v_mfma_f32_32x32x16_bf16 v[184:199], a[12:15], v[248:251], v[184:199]
    v_and_b32 v235, s68, v121
    v_lshlrev_b32 v236, 16, v122
    v_and_b32 v237, s68, v122
    ds_read_b128 a[32:35], v4 offset:24576
    ds_read_b128 a[36:39], v4 offset:25600
    buffer_load_dwordx4 v[60:63], v2, s[32:35], s48 offen offset:1024
    s_waitcnt lgkmcnt(10)
    v_mfma_f32_32x32x16_bf16 v[136:151], a[16:19], v[252:255], v[136:151]
    v_lshlrev_b32 v238, 16, v123
    v_and_b32 v239, s68, v123
    v_lshlrev_b32 v240, 16, v124
    ds_read_b128 a[40:43], v4 offset:26624
    ds_read_b128 a[44:47], v4 offset:27648
    v_mfma_f32_32x32x16_bf16 v[152:167], a[20:23], v[252:255], v[152:167]
    v_and_b32 v241, s68, v124
    v_lshlrev_b32 v242, 16, v125
    v_and_b32 v243, s68, v125
    ds_read_b128 a[48:51], v4 offset:28672
    ds_read_b128 a[52:55], v4 offset:29696
    buffer_load_dwordx4 v[64:67], v2, s[32:35], s48 offen offset:2048
    v_mfma_f32_32x32x16_bf16 v[168:183], a[24:27], v[252:255], v[168:183]
    v_lshlrev_b32 v244, 16, v126
    v_and_b32 v245, s68, v126
    ds_read_b128 a[56:59], v4 offset:30720
    ds_read_b128 a[60:63], v4 offset:31744
    v_mfma_f32_32x32x16_bf16 v[184:199], a[28:31], v[252:255], v[184:199]
    v_lshlrev_b32 v246, 16, v127
    v_and_b32 v247, s68, v127
    buffer_load_dwordx4 v[68:71], v2, s[32:35], s48 offen offset:3072
    s_waitcnt lgkmcnt(8)
    v_pk_fma_f32 v[232:233], v[232:233], v[200:201], v[208:209]
    v_pk_fma_f32 v[234:235], v[234:235], v[202:203], v[210:211]
    v_pk_fma_f32 v[236:237], v[236:237], v[204:205], v[212:213]
    v_pk_fma_f32 v[238:239], v[238:239], v[206:207], v[214:215]
    v_pk_fma_f32 v[240:241], v[240:241], v[216:217], v[224:225]
    v_pk_fma_f32 v[242:243], v[242:243], v[218:219], v[226:227]
    v_pk_fma_f32 v[244:245], v[244:245], v[220:221], v[228:229]
    v_pk_fma_f32 v[246:247], v[246:247], v[222:223], v[230:231]
    v_cvt_pk_bf16_f32 v248, v232, v233
    v_cvt_pk_bf16_f32 v249, v234, v235
    v_cvt_pk_bf16_f32 v250, v236, v237
    v_cvt_pk_bf16_f32 v251, v238, v239
    s_waitcnt lgkmcnt(4)
    s_nop 0
    v_mfma_f32_32x32x16_bf16 v[136:151], a[32:35], v[248:251], v[136:151]
    v_cvt_pk_bf16_f32 v252, v240, v241
    v_cvt_pk_bf16_f32 v253, v242, v243
    v_cvt_pk_bf16_f32 v254, v244, v245
    v_cvt_pk_bf16_f32 v255, v246, v247
    ds_read_b128 v[200:203], v5 offset:3072
    ds_read_b128 v[204:207], v5 offset:3088
    v_mfma_f32_32x32x16_bf16 v[152:167], a[36:39], v[248:251], v[152:167]
    s_waitcnt vmcnt(16)
    ds_read_b128 v[208:211], v5 offset:3104
    ds_read_b128 v[212:215], v5 offset:3120
    ds_read_b128 v[216:219], v5 offset:3200
    v_mfma_f32_32x32x16_bf16 v[168:183], a[40:43], v[248:251], v[168:183]
    v_lshlrev_b32 v232, 16, v128
    v_and_b32 v233, s68, v128
    v_lshlrev_b32 v234, 16, v129
    ds_read_b128 v[220:223], v5 offset:3216
    ds_read_b128 v[224:227], v5 offset:3232
    ds_read_b128 v[228:231], v5 offset:3248
    v_mfma_f32_32x32x16_bf16 v[184:199], a[44:47], v[248:251], v[184:199]
    v_and_b32 v235, s68, v129
    v_lshlrev_b32 v236, 16, v130
    v_and_b32 v237, s68, v130
    s_barrier
    s_waitcnt lgkmcnt(8)
    v_mfma_f32_32x32x16_bf16 v[136:151], a[48:51], v[252:255], v[136:151]
    v_lshlrev_b32 v238, 16, v131
    v_and_b32 v239, s68, v131
    v_lshlrev_b32 v240, 16, v132
    ds_read_b128 a[0:3], v4 offset:32768
    ds_read_b128 a[4:7], v4 offset:33792
    v_mfma_f32_32x32x16_bf16 v[152:167], a[52:55], v[252:255], v[152:167]
    v_and_b32 v241, s68, v132
    v_lshlrev_b32 v242, 16, v133
    v_and_b32 v243, s68, v133
    ds_read_b128 a[8:11], v4 offset:34816
    ds_read_b128 a[12:15], v4 offset:35840
    v_mfma_f32_32x32x16_bf16 v[168:183], a[56:59], v[252:255], v[168:183]
    v_lshlrev_b32 v244, 16, v134
    v_and_b32 v245, s68, v134
    ds_read_b128 a[16:19], v4 offset:36864
    ds_read_b128 a[20:23], v4 offset:37888
    v_mfma_f32_32x32x16_bf16 v[184:199], a[60:63], v[252:255], v[184:199]
    v_lshlrev_b32 v246, 16, v135
    v_and_b32 v247, s68, v135
    ds_read_b128 a[24:27], v4 offset:38912
    ds_read_b128 a[28:31], v4 offset:39936
    s_waitcnt lgkmcnt(8)
    v_pk_fma_f32 v[232:233], v[232:233], v[200:201], v[208:209]
    v_pk_fma_f32 v[234:235], v[234:235], v[202:203], v[210:211]
    v_pk_fma_f32 v[236:237], v[236:237], v[204:205], v[212:213]
    v_pk_fma_f32 v[238:239], v[238:239], v[206:207], v[214:215]
    v_pk_fma_f32 v[240:241], v[240:241], v[216:217], v[224:225]
    v_pk_fma_f32 v[242:243], v[242:243], v[218:219], v[226:227]
    v_pk_fma_f32 v[244:245], v[244:245], v[220:221], v[228:229]
    v_pk_fma_f32 v[246:247], v[246:247], v[222:223], v[230:231]
    v_cvt_pk_bf16_f32 v248, v232, v233
    v_cvt_pk_bf16_f32 v249, v234, v235
    v_cvt_pk_bf16_f32 v250, v236, v237
    v_cvt_pk_bf16_f32 v251, v238, v239
    s_waitcnt lgkmcnt(4)
    s_nop 0
    v_mfma_f32_32x32x16_bf16 v[136:151], a[0:3], v[248:251], v[136:151]
    v_cvt_pk_bf16_f32 v252, v240, v241
    v_cvt_pk_bf16_f32 v253, v242, v243
    v_cvt_pk_bf16_f32 v254, v244, v245
    v_cvt_pk_bf16_f32 v255, v246, v247
    ds_read_b128 v[200:203], v5 offset:3328
    ds_read_b128 v[204:207], v5 offset:3344
    v_mfma_f32_32x32x16_bf16 v[152:167], a[4:7], v[248:251], v[152:167]
    s_waitcnt vmcnt(14)
    ds_read_b128 v[208:211], v5 offset:3360
    ds_read_b128 v[212:215], v5 offset:3376
    ds_read_b128 v[216:219], v5 offset:3456
    v_mfma_f32_32x32x16_bf16 v[168:183], a[8:11], v[248:251], v[168:183]
    v_lshlrev_b32 v232, 16, v32
    v_and_b32 v233, s68, v32
    v_lshlrev_b32 v234, 16, v33
    ds_read_b128 v[220:223], v5 offset:3472
    ds_read_b128 v[224:227], v5 offset:3488
    ds_read_b128 v[228:231], v5 offset:3504
    v_mfma_f32_32x32x16_bf16 v[184:199], a[12:15], v[248:251], v[184:199]
    v_and_b32 v235, s68, v33
    v_lshlrev_b32 v236, 16, v34
    v_and_b32 v237, s68, v34
    ds_read_b128 a[32:35], v4 offset:40960
    ds_read_b128 a[36:39], v4 offset:41984
    s_waitcnt lgkmcnt(10)
    v_mfma_f32_32x32x16_bf16 v[136:151], a[16:19], v[252:255], v[136:151]
    v_lshlrev_b32 v238, 16, v35
    v_and_b32 v239, s68, v35
    v_lshlrev_b32 v240, 16, v36
    ds_read_b128 a[40:43], v4 offset:43008
    ds_read_b128 a[44:47], v4 offset:44032
    v_mfma_f32_32x32x16_bf16 v[152:167], a[20:23], v[252:255], v[152:167]
    v_and_b32 v241, s68, v36
    v_lshlrev_b32 v242, 16, v37
    v_and_b32 v243, s68, v37
    ds_read_b128 a[48:51], v4 offset:45056
    ds_read_b128 a[52:55], v4 offset:46080
    v_mfma_f32_32x32x16_bf16 v[168:183], a[24:27], v[252:255], v[168:183]
    v_lshlrev_b32 v244, 16, v38
    v_and_b32 v245, s68, v38
    ds_read_b128 a[56:59], v4 offset:47104
    ds_read_b128 a[60:63], v4 offset:48128
    v_mfma_f32_32x32x16_bf16 v[184:199], a[28:31], v[252:255], v[184:199]
    v_lshlrev_b32 v246, 16, v39
    v_and_b32 v247, s68, v39
    s_waitcnt lgkmcnt(8)
    v_pk_fma_f32 v[232:233], v[232:233], v[200:201], v[208:209]
    v_pk_fma_f32 v[234:235], v[234:235], v[202:203], v[210:211]
    v_pk_fma_f32 v[236:237], v[236:237], v[204:205], v[212:213]
    v_pk_fma_f32 v[238:239], v[238:239], v[206:207], v[214:215]
    v_pk_fma_f32 v[240:241], v[240:241], v[216:217], v[224:225]
    v_pk_fma_f32 v[242:243], v[242:243], v[218:219], v[226:227]
    v_pk_fma_f32 v[244:245], v[244:245], v[220:221], v[228:229]
    v_pk_fma_f32 v[246:247], v[246:247], v[222:223], v[230:231]
    v_cvt_pk_bf16_f32 v248, v232, v233
    v_cvt_pk_bf16_f32 v249, v234, v235
    v_cvt_pk_bf16_f32 v250, v236, v237
    v_cvt_pk_bf16_f32 v251, v238, v239
    s_waitcnt lgkmcnt(4)
    s_nop 0
    v_mfma_f32_32x32x16_bf16 v[136:151], a[32:35], v[248:251], v[136:151]
    v_cvt_pk_bf16_f32 v252, v240, v241
    v_cvt_pk_bf16_f32 v253, v242, v243
    v_cvt_pk_bf16_f32 v254, v244, v245
    v_cvt_pk_bf16_f32 v255, v246, v247
    ds_read_b128 v[200:203], v5 offset:3584
    ds_read_b128 v[204:207], v5 offset:3600
    v_mfma_f32_32x32x16_bf16 v[152:167], a[36:39], v[248:251], v[152:167]
    s_waitcnt vmcnt(12)
    ds_read_b128 v[208:211], v5 offset:3616
    ds_read_b128 v[212:215], v5 offset:3632
    ds_read_b128 v[216:219], v5 offset:3712
    v_mfma_f32_32x32x16_bf16 v[168:183], a[40:43], v[248:251], v[168:183]
    v_lshlrev_b32 v232, 16, v40
    v_and_b32 v233, s68, v40
    v_lshlrev_b32 v234, 16, v41
    ds_read_b128 v[220:223], v5 offset:3728
    ds_read_b128 v[224:227], v5 offset:3744
    ds_read_b128 v[228:231], v5 offset:3760
    v_mfma_f32_32x32x16_bf16 v[184:199], a[44:47], v[248:251], v[184:199]
    v_and_b32 v235, s68, v41
    v_lshlrev_b32 v236, 16, v42
    v_and_b32 v237, s68, v42
    ds_read_b128 a[0:3], v4 offset:49152
    ds_read_b128 a[4:7], v4 offset:50176
    s_waitcnt lgkmcnt(10)
    v_mfma_f32_32x32x16_bf16 v[136:151], a[48:51], v[252:255], v[136:151]
    v_lshlrev_b32 v238, 16, v43
    v_and_b32 v239, s68, v43
    v_lshlrev_b32 v240, 16, v44
    ds_read_b128 a[8:11], v4 offset:51200
    ds_read_b128 a[12:15], v4 offset:52224
    v_mfma_f32_32x32x16_bf16 v[152:167], a[52:55], v[252:255], v[152:167]
    v_and_b32 v241, s68, v44
    v_lshlrev_b32 v242, 16, v45
    v_and_b32 v243, s68, v45
    ds_read_b128 a[16:19], v4 offset:53248
    ds_read_b128 a[20:23], v4 offset:54272
    v_mfma_f32_32x32x16_bf16 v[168:183], a[56:59], v[252:255], v[168:183]
    v_lshlrev_b32 v244, 16, v46
    v_and_b32 v245, s68, v46
    ds_read_b128 a[24:27], v4 offset:55296
    ds_read_b128 a[28:31], v4 offset:56320
    v_mfma_f32_32x32x16_bf16 v[184:199], a[60:63], v[252:255], v[184:199]
    v_lshlrev_b32 v246, 16, v47
    v_and_b32 v247, s68, v47
    s_waitcnt lgkmcnt(8)
    v_pk_fma_f32 v[232:233], v[232:233], v[200:201], v[208:209]
    v_pk_fma_f32 v[234:235], v[234:235], v[202:203], v[210:211]
    v_pk_fma_f32 v[236:237], v[236:237], v[204:205], v[212:213]
    v_pk_fma_f32 v[238:239], v[238:239], v[206:207], v[214:215]
    v_pk_fma_f32 v[240:241], v[240:241], v[216:217], v[224:225]
    v_pk_fma_f32 v[242:243], v[242:243], v[218:219], v[226:227]
    v_pk_fma_f32 v[244:245], v[244:245], v[220:221], v[228:229]
    v_pk_fma_f32 v[246:247], v[246:247], v[222:223], v[230:231]
    v_cvt_pk_bf16_f32 v248, v232, v233
    v_cvt_pk_bf16_f32 v249, v234, v235
    v_cvt_pk_bf16_f32 v250, v236, v237
    v_cvt_pk_bf16_f32 v251, v238, v239
    s_waitcnt lgkmcnt(4)
    s_nop 0
    v_mfma_f32_32x32x16_bf16 v[136:151], a[0:3], v[248:251], v[136:151]
    v_cvt_pk_bf16_f32 v252, v240, v241
    v_cvt_pk_bf16_f32 v253, v242, v243
    v_cvt_pk_bf16_f32 v254, v244, v245
    v_cvt_pk_bf16_f32 v255, v246, v247
    ds_read_b128 v[200:203], v5 offset:3840
    ds_read_b128 v[204:207], v5 offset:3856
    v_mfma_f32_32x32x16_bf16 v[152:167], a[4:7], v[248:251], v[152:167]
    s_waitcnt vmcnt(4)
    ds_read_b128 v[208:211], v5 offset:3872
    ds_read_b128 v[212:215], v5 offset:3888
    ds_read_b128 v[216:219], v5 offset:3968
    v_mfma_f32_32x32x16_bf16 v[168:183], a[8:11], v[248:251], v[168:183]
    v_lshlrev_b32 v232, 16, v48
    v_and_b32 v233, s68, v48
    v_lshlrev_b32 v234, 16, v49
    ds_read_b128 v[220:223], v5 offset:3984
    ds_read_b128 v[224:227], v5 offset:4000
    ds_read_b128 v[228:231], v5 offset:4016
    v_mfma_f32_32x32x16_bf16 v[184:199], a[12:15], v[248:251], v[184:199]
    v_and_b32 v235, s68, v49
    v_lshlrev_b32 v236, 16, v50
    v_and_b32 v237, s68, v50
    s_barrier
    s_waitcnt lgkmcnt(8)
    v_mfma_f32_32x32x16_bf16 v[136:151], a[16:19], v[252:255], v[136:151]
    v_lshlrev_b32 v238, 16, v51
    v_and_b32 v239, s68, v51
    v_lshlrev_b32 v240, 16, v52
    ds_read_b128 a[32:35], v4 offset:57344
    ds_read_b128 a[36:39], v4 offset:58368
    v_mfma_f32_32x32x16_bf16 v[152:167], a[20:23], v[252:255], v[152:167]
    v_and_b32 v241, s68, v52
    v_lshlrev_b32 v242, 16, v53
    v_and_b32 v243, s68, v53
    ds_read_b128 a[40:43], v4 offset:59392
    ds_read_b128 a[44:47], v4 offset:60416
    v_mfma_f32_32x32x16_bf16 v[168:183], a[24:27], v[252:255], v[168:183]
    v_lshlrev_b32 v244, 16, v54
    v_and_b32 v245, s68, v54
    ds_read_b128 a[48:51], v4 offset:61440
    ds_read_b128 a[52:55], v4 offset:62464
    v_mfma_f32_32x32x16_bf16 v[184:199], a[28:31], v[252:255], v[184:199]
    v_lshlrev_b32 v246, 16, v55
    v_and_b32 v247, s68, v55
    ds_read_b128 a[56:59], v4 offset:63488
    ds_read_b128 a[60:63], v4 offset:64512
    s_waitcnt lgkmcnt(8)
    v_pk_fma_f32 v[232:233], v[232:233], v[200:201], v[208:209]
    v_pk_fma_f32 v[234:235], v[234:235], v[202:203], v[210:211]
    v_pk_fma_f32 v[236:237], v[236:237], v[204:205], v[212:213]
    v_pk_fma_f32 v[238:239], v[238:239], v[206:207], v[214:215]
    v_pk_fma_f32 v[240:241], v[240:241], v[216:217], v[224:225]
    v_pk_fma_f32 v[242:243], v[242:243], v[218:219], v[226:227]
    v_pk_fma_f32 v[244:245], v[244:245], v[220:221], v[228:229]
    v_pk_fma_f32 v[246:247], v[246:247], v[222:223], v[230:231]
    v_cvt_pk_bf16_f32 v248, v232, v233
    v_cvt_pk_bf16_f32 v249, v234, v235
    v_cvt_pk_bf16_f32 v250, v236, v237
    v_cvt_pk_bf16_f32 v251, v238, v239
    s_waitcnt lgkmcnt(4)
    s_nop 0
    v_mfma_f32_32x32x16_bf16 v[136:151], a[32:35], v[248:251], v[136:151]
    v_cvt_pk_bf16_f32 v252, v240, v241
    v_cvt_pk_bf16_f32 v253, v242, v243
    v_cvt_pk_bf16_f32 v254, v244, v245
    v_cvt_pk_bf16_f32 v255, v246, v247
    ds_read_b128 v[200:203], v5 offset:4096
    ds_read_b128 v[204:207], v5 offset:4112
    v_mfma_f32_32x32x16_bf16 v[152:167], a[36:39], v[248:251], v[152:167]
    s_waitcnt vmcnt(2)
    ds_read_b128 v[208:211], v5 offset:4128
    ds_read_b128 v[212:215], v5 offset:4144
    ds_read_b128 v[216:219], v5 offset:4224
    v_mfma_f32_32x32x16_bf16 v[168:183], a[40:43], v[248:251], v[168:183]
    v_lshlrev_b32 v232, 16, v56
    v_and_b32 v233, s68, v56
    v_lshlrev_b32 v234, 16, v57
    ds_read_b128 v[220:223], v5 offset:4240
    ds_read_b128 v[224:227], v5 offset:4256
    ds_read_b128 v[228:231], v5 offset:4272
    v_mfma_f32_32x32x16_bf16 v[184:199], a[44:47], v[248:251], v[184:199]
    v_and_b32 v235, s68, v57
    v_lshlrev_b32 v236, 16, v58
    v_and_b32 v237, s68, v58
    ds_read_b128 a[0:3], v18 offset:0
    ds_read_b128 a[4:7], v18 offset:1024
    s_waitcnt lgkmcnt(10)
    v_mfma_f32_32x32x16_bf16 v[136:151], a[48:51], v[252:255], v[136:151]
    v_lshlrev_b32 v238, 16, v59
    v_and_b32 v239, s68, v59
    v_lshlrev_b32 v240, 16, v60
    ds_read_b128 a[8:11], v18 offset:2048
    ds_read_b128 a[12:15], v18 offset:3072
    v_mfma_f32_32x32x16_bf16 v[152:167], a[52:55], v[252:255], v[152:167]
    v_and_b32 v241, s68, v60
    v_lshlrev_b32 v242, 16, v61
    v_and_b32 v243, s68, v61
    ds_read_b128 a[16:19], v18 offset:4096
    ds_read_b128 a[20:23], v18 offset:5120
    v_mfma_f32_32x32x16_bf16 v[168:183], a[56:59], v[252:255], v[168:183]
    v_lshlrev_b32 v244, 16, v62
    v_and_b32 v245, s68, v62
    ds_read_b128 a[24:27], v18 offset:6144
    ds_read_b128 a[28:31], v18 offset:7168
    v_mfma_f32_32x32x16_bf16 v[184:199], a[60:63], v[252:255], v[184:199]
    v_lshlrev_b32 v246, 16, v63
    v_and_b32 v247, s68, v63
    s_waitcnt lgkmcnt(8)
    v_pk_fma_f32 v[232:233], v[232:233], v[200:201], v[208:209]
    v_pk_fma_f32 v[234:235], v[234:235], v[202:203], v[210:211]
    v_pk_fma_f32 v[236:237], v[236:237], v[204:205], v[212:213]
    v_pk_fma_f32 v[238:239], v[238:239], v[206:207], v[214:215]
    v_pk_fma_f32 v[240:241], v[240:241], v[216:217], v[224:225]
    v_pk_fma_f32 v[242:243], v[242:243], v[218:219], v[226:227]
    v_pk_fma_f32 v[244:245], v[244:245], v[220:221], v[228:229]
    v_pk_fma_f32 v[246:247], v[246:247], v[222:223], v[230:231]
    v_cvt_pk_bf16_f32 v248, v232, v233
    v_cvt_pk_bf16_f32 v249, v234, v235
    v_cvt_pk_bf16_f32 v250, v236, v237
    v_cvt_pk_bf16_f32 v251, v238, v239
    s_waitcnt lgkmcnt(4)
    s_nop 0
    v_mfma_f32_32x32x16_bf16 v[136:151], a[0:3], v[248:251], v[136:151]
    v_cvt_pk_bf16_f32 v252, v240, v241
    v_cvt_pk_bf16_f32 v253, v242, v243
    v_cvt_pk_bf16_f32 v254, v244, v245
    v_cvt_pk_bf16_f32 v255, v246, v247
    ds_read_b128 v[200:203], v5 offset:4352
    ds_read_b128 v[204:207], v5 offset:4368
    v_mfma_f32_32x32x16_bf16 v[152:167], a[4:7], v[248:251], v[152:167]
    s_waitcnt vmcnt(0)
    ds_read_b128 v[208:211], v5 offset:4384
    ds_read_b128 v[212:215], v5 offset:4400
    ds_read_b128 v[216:219], v5 offset:4480
    v_mfma_f32_32x32x16_bf16 v[168:183], a[8:11], v[248:251], v[168:183]
    v_lshlrev_b32 v232, 16, v64
    v_and_b32 v233, s68, v64
    v_lshlrev_b32 v234, 16, v65
    ds_read_b128 v[220:223], v5 offset:4496
    ds_read_b128 v[224:227], v5 offset:4512
    ds_read_b128 v[228:231], v5 offset:4528
    v_mfma_f32_32x32x16_bf16 v[184:199], a[12:15], v[248:251], v[184:199]
    v_and_b32 v235, s68, v65
    v_lshlrev_b32 v236, 16, v66
    v_and_b32 v237, s68, v66
    ds_read_b128 a[32:35], v18 offset:8192
    ds_read_b128 a[36:39], v18 offset:9216
    s_waitcnt lgkmcnt(10)
    v_mfma_f32_32x32x16_bf16 v[136:151], a[16:19], v[252:255], v[136:151]
    v_lshlrev_b32 v238, 16, v67
    v_and_b32 v239, s68, v67
    v_lshlrev_b32 v240, 16, v68
    ds_read_b128 a[40:43], v18 offset:10240
    ds_read_b128 a[44:47], v18 offset:11264
    v_mfma_f32_32x32x16_bf16 v[152:167], a[20:23], v[252:255], v[152:167]
    v_and_b32 v241, s68, v68
    v_lshlrev_b32 v242, 16, v69
    v_and_b32 v243, s68, v69
    ds_read_b128 a[48:51], v18 offset:12288
    ds_read_b128 a[52:55], v18 offset:13312
    v_mfma_f32_32x32x16_bf16 v[168:183], a[24:27], v[252:255], v[168:183]
    v_lshlrev_b32 v244, 16, v70
    v_and_b32 v245, s68, v70
    ds_read_b128 a[56:59], v18 offset:14336
    ds_read_b128 a[60:63], v18 offset:15360
    v_mfma_f32_32x32x16_bf16 v[184:199], a[28:31], v[252:255], v[184:199]
    v_lshlrev_b32 v246, 16, v71
    v_and_b32 v247, s68, v71
    s_waitcnt lgkmcnt(8)
    v_pk_fma_f32 v[232:233], v[232:233], v[200:201], v[208:209]
    v_pk_fma_f32 v[234:235], v[234:235], v[202:203], v[210:211]
    v_pk_fma_f32 v[236:237], v[236:237], v[204:205], v[212:213]
    v_pk_fma_f32 v[238:239], v[238:239], v[206:207], v[214:215]
    v_pk_fma_f32 v[240:241], v[240:241], v[216:217], v[224:225]
    v_pk_fma_f32 v[242:243], v[242:243], v[218:219], v[226:227]
    v_pk_fma_f32 v[244:245], v[244:245], v[220:221], v[228:229]
    v_pk_fma_f32 v[246:247], v[246:247], v[222:223], v[230:231]
    v_cvt_pk_bf16_f32 v248, v232, v233
    v_cvt_pk_bf16_f32 v249, v234, v235
    v_cvt_pk_bf16_f32 v250, v236, v237
    v_cvt_pk_bf16_f32 v251, v238, v239
    s_waitcnt lgkmcnt(4)
    s_nop 0
    v_mfma_f32_32x32x16_bf16 v[136:151], a[32:35], v[248:251], v[136:151]
    v_cvt_pk_bf16_f32 v252, v240, v241
    v_cvt_pk_bf16_f32 v253, v242, v243
    v_cvt_pk_bf16_f32 v254, v244, v245
    v_cvt_pk_bf16_f32 v255, v246, v247
    v_mfma_f32_32x32x16_bf16 v[152:167], a[36:39], v[248:251], v[152:167]
    v_mfma_f32_32x32x16_bf16 v[168:183], a[40:43], v[248:251], v[168:183]
    v_mfma_f32_32x32x16_bf16 v[184:199], a[44:47], v[248:251], v[184:199]
    s_waitcnt lgkmcnt(0)
    v_mfma_f32_32x32x16_bf16 v[136:151], a[48:51], v[252:255], v[136:151]
    v_mfma_f32_32x32x16_bf16 v[152:167], a[52:55], v[252:255], v[152:167]
    v_mfma_f32_32x32x16_bf16 v[168:183], a[56:59], v[252:255], v[168:183]
    v_mfma_f32_32x32x16_bf16 v[184:199], a[60:63], v[252:255], v[184:199]
    s_cmp_eq_u32 s29, 8
    s_cbranch_scc1 L1_rem
    s_and_b32 s51, s29, 3
    s_lshl_b32 s51, s51, 3
    s_cmp_lt_u32 s29, 4
    s_cbranch_scc0 L1_k
    s_mov_b32 s52, 0x3eae1a93
    s_mov_b32 s58, 65536
    s_lshl_b32 s54, s30, 10
    s_branch L1_main
L1_k:
    s_mov_b32 s52, 1.0
    s_mov_b32 s58, 155648
    s_lshr_b32 s54, s30, 3
    s_mul_i32 s54, s54, 19456
    s_and_b32 s55, s30, 7
    s_lshl_b32 s55, s55, 10
    s_add_u32 s54, s54, s55
    s_add_u32 s54, s54, 3145728
L1_main:
    s_mul_i32 s55, s51, s58
    s_add_u32 s54, s54, s55
    s_nop 7
    v_pk_mul_f32 v[136:137], v[136:137], s[52:53] op_sel_hi:[1,0]
    v_pk_mul_f32 v[138:139], v[138:139], s[52:53] op_sel_hi:[1,0]
    v_pk_mul_f32 v[140:141], v[140:141], s[52:53] op_sel_hi:[1,0]
    v_pk_mul_f32 v[142:143], v[142:143], s[52:53] op_sel_hi:[1,0]
    v_cvt_pk_bf16_f32 v32, v136, v137
    v_cvt_pk_bf16_f32 v33, v138, v139
    v_cvt_pk_bf16_f32 v34, v140, v141
    v_cvt_pk_bf16_f32 v35, v142, v143
    buffer_store_dwordx4 v[32:35], v2, s[44:47], s54 offen
    s_add_u32 s54, s54, s58
    v_pk_mul_f32 v[144:145], v[144:145], s[52:53] op_sel_hi:[1,0]
    v_pk_mul_f32 v[146:147], v[146:147], s[52:53] op_sel_hi:[1,0]
    v_pk_mul_f32 v[148:149], v[148:149], s[52:53] op_sel_hi:[1,0]
    v_pk_mul_f32 v[150:151], v[150:151], s[52:53] op_sel_hi:[1,0]
    v_cvt_pk_bf16_f32 v36, v144, v145
    v_cvt_pk_bf16_f32 v37, v146, v147
    v_cvt_pk_bf16_f32 v38, v148, v149
    v_cvt_pk_bf16_f32 v39, v150, v151
    buffer_store_dwordx4 v[36:39], v2, s[44:47], s54 offen
    s_add_u32 s54, s54, s58
    v_pk_mul_f32 v[152:153], v[152:153], s[52:53] op_sel_hi:[1,0]
    v_pk_mul_f32 v[154:155], v[154:155], s[52:53] op_sel_hi:[1,0]
    v_pk_mul_f32 v[156:157], v[156:157], s[52:53] op_sel_hi:[1,0]
    v_pk_mul_f32 v[158:159], v[158:159], s[52:53] op_sel_hi:[1,0]
    v_cvt_pk_bf16_f32 v40, v152, v153
    v_cvt_pk_bf16_f32 v41, v154, v155
    v_cvt_pk_bf16_f32 v42, v156, v157
    v_cvt_pk_bf16_f32 v43, v158, v159
    buffer_store_dwordx4 v[40:43], v2, s[44:47], s54 offen
    s_add_u32 s54, s54, s58
    v_pk_mul_f32 v[160:161], v[160:161], s[52:53] op_sel_hi:[1,0]
    v_pk_mul_f32 v[162:163], v[162:163], s[52:53] op_sel_hi:[1,0]
    v_pk_mul_f32 v[164:165], v[164:165], s[52:53] op_sel_hi:[1,0]
    v_pk_mul_f32 v[166:167], v[166:167], s[52:53] op_sel_hi:[1,0]
    v_cvt_pk_bf16_f32 v44, v160, v161
    v_cvt_pk_bf16_f32 v45, v162, v163
    v_cvt_pk_bf16_f32 v46, v164, v165
    v_cvt_pk_bf16_f32 v47, v166, v167
    buffer_store_dwordx4 v[44:47], v2, s[44:47], s54 offen
    s_add_u32 s54, s54, s58
    v_pk_mul_f32 v[168:169], v[168:169], s[52:53] op_sel_hi:[1,0]
    v_pk_mul_f32 v[170:171], v[170:171], s[52:53] op_sel_hi:[1,0]
    v_pk_mul_f32 v[172:173], v[172:173], s[52:53] op_sel_hi:[1,0]
    v_pk_mul_f32 v[174:175], v[174:175], s[52:53] op_sel_hi:[1,0]
    v_cvt_pk_bf16_f32 v48, v168, v169
    v_cvt_pk_bf16_f32 v49, v170, v171
    v_cvt_pk_bf16_f32 v50, v172, v173
    v_cvt_pk_bf16_f32 v51, v174, v175
    buffer_store_dwordx4 v[48:51], v2, s[44:47], s54 offen
    s_add_u32 s54, s54, s58
    v_pk_mul_f32 v[176:177], v[176:177], s[52:53] op_sel_hi:[1,0]
    v_pk_mul_f32 v[178:179], v[178:179], s[52:53] op_sel_hi:[1,0]
    v_pk_mul_f32 v[180:181], v[180:181], s[52:53] op_sel_hi:[1,0]
    v_pk_mul_f32 v[182:183], v[182:183], s[52:53] op_sel_hi:[1,0]
    v_cvt_pk_bf16_f32 v52, v176, v177
    v_cvt_pk_bf16_f32 v53, v178, v179
    v_cvt_pk_bf16_f32 v54, v180, v181
    v_cvt_pk_bf16_f32 v55, v182, v183
    buffer_store_dwordx4 v[52:55], v2, s[44:47], s54 offen
    s_add_u32 s54, s54, s58
    v_pk_mul_f32 v[184:185], v[184:185], s[52:53] op_sel_hi:[1,0]
    v_pk_mul_f32 v[186:187], v[186:187], s[52:53] op_sel_hi:[1,0]
    v_pk_mul_f32 v[188:189], v[188:189], s[52:53] op_sel_hi:[1,0]
    v_pk_mul_f32 v[190:191], v[190:191], s[52:53] op_sel_hi:[1,0]
    v_cvt_pk_bf16_f32 v56, v184, v185
    v_cvt_pk_bf16_f32 v57, v186, v187
    v_cvt_pk_bf16_f32 v58, v188, v189
    v_cvt_pk_bf16_f32 v59, v190, v191
    buffer_store_dwordx4 v[56:59], v2, s[44:47], s54 offen
    s_add_u32 s54, s54, s58
    v_pk_mul_f32 v[192:193], v[192:193], s[52:53] op_sel_hi:[1,0]
    v_pk_mul_f32 v[194:195], v[194:195], s[52:53] op_sel_hi:[1,0]
    v_pk_mul_f32 v[196:197], v[196:197], s[52:53] op_sel_hi:[1,0]
    v_pk_mul_f32 v[198:199], v[198:199], s[52:53] op_sel_hi:[1,0]
    v_cvt_pk_bf16_f32 v60, v192, v193
    v_cvt_pk_bf16_f32 v61, v194, v195
    v_cvt_pk_bf16_f32 v62, v196, v197
    v_cvt_pk_bf16_f32 v63, v198, v199
    buffer_store_dwordx4 v[60:63], v2, s[44:47], s54 offen
    s_endpgm
L1_rem:
    v_and_b32 v7, 31, v1
    v_lshlrev_b32 v7, 2, v7
    v_lshl_add_u32 v8, v6, 14, v7
    v_mul_u32_u24 v9, 311296, v6
    v_add_u32 v9, v9, v7
    s_lshl_b32 s52, s30, 7
    s_add_u32 s52, s52, 2097152
    s_lshr_b32 s54, s30, 3
    s_mul_i32 s54, s54, 19456
    s_and_b32 s55, s30, 7
    s_lshl_b32 s55, s55, 7
    s_add_u32 s54, s54, s55
    s_add_u32 s54, s54, 3153920
    s_mov_b32 s56, 0x3eae1a93
    s_nop 7
    v_mul_f32 v136, s56, v136
    v_mul_f32 v137, s56, v137
    v_cvt_pk_bf16_f32 v136, v136, v137
    s_add_u32 s57, s52, 0
    buffer_store_dword v136, v8, s[44:47], s57 offen
    v_mul_f32 v138, s56, v138
    v_mul_f32 v139, s56, v139
    v_cvt_pk_bf16_f32 v138, v138, v139
    s_add_u32 s57, s52, 8192
    buffer_store_dword v138, v8, s[44:47], s57 offen
    v_mul_f32 v140, s56, v140
    v_mul_f32 v141, s56, v141
    v_cvt_pk_bf16_f32 v140, v140, v141
    s_add_u32 s57, s52, 32768
    buffer_store_dword v140, v8, s[44:47], s57 offen
    v_mul_f32 v142, s56, v142
    v_mul_f32 v143, s56, v143
    v_cvt_pk_bf16_f32 v142, v142, v143
    s_add_u32 s57, s52, 40960
    buffer_store_dword v142, v8, s[44:47], s57 offen
    v_mul_f32 v144, s56, v144
    v_mul_f32 v145, s56, v145
    v_cvt_pk_bf16_f32 v144, v144, v145
    s_add_u32 s57, s52, 65536
    buffer_store_dword v144, v8, s[44:47], s57 offen
    v_mul_f32 v146, s56, v146
    v_mul_f32 v147, s56, v147
    v_cvt_pk_bf16_f32 v146, v146, v147
    s_add_u32 s57, s52, 73728
    buffer_store_dword v146, v8, s[44:47], s57 offen
    v_mul_f32 v148, s56, v148
    v_mul_f32 v149, s56, v149
    v_cvt_pk_bf16_f32 v148, v148, v149
    s_add_u32 s57, s52, 98304
    buffer_store_dword v148, v8, s[44:47], s57 offen
    v_mul_f32 v150, s56, v150
    v_mul_f32 v151, s56, v151
    v_cvt_pk_bf16_f32 v150, v150, v151
    s_add_u32 s57, s52, 106496
    buffer_store_dword v150, v8, s[44:47], s57 offen
    v_mul_f32 v152, s56, v152
    v_mul_f32 v153, s56, v153
    v_cvt_pk_bf16_f32 v152, v152, v153
    s_add_u32 s57, s52, 131072
    buffer_store_dword v152, v8, s[44:47], s57 offen
    v_mul_f32 v154, s56, v154
    v_mul_f32 v155, s56, v155
    v_cvt_pk_bf16_f32 v154, v154, v155
    s_add_u32 s57, s52, 139264
    buffer_store_dword v154, v8, s[44:47], s57 offen
    v_mul_f32 v156, s56, v156
    v_mul_f32 v157, s56, v157
    v_cvt_pk_bf16_f32 v156, v156, v157
    s_add_u32 s57, s52, 163840
    buffer_store_dword v156, v8, s[44:47], s57 offen
    v_mul_f32 v158, s56, v158
    v_mul_f32 v159, s56, v159
    v_cvt_pk_bf16_f32 v158, v158, v159
    s_add_u32 s57, s52, 172032
    buffer_store_dword v158, v8, s[44:47], s57 offen
    v_mul_f32 v160, s56, v160
    v_mul_f32 v161, s56, v161
    v_cvt_pk_bf16_f32 v160, v160, v161
    s_add_u32 s57, s52, 196608
    buffer_store_dword v160, v8, s[44:47], s57 offen
    v_mul_f32 v162, s56, v162
    v_mul_f32 v163, s56, v163
    v_cvt_pk_bf16_f32 v162, v162, v163
    s_add_u32 s57, s52, 204800
    buffer_store_dword v162, v8, s[44:47], s57 offen
    v_mul_f32 v164, s56, v164
    v_mul_f32 v165, s56, v165
    v_cvt_pk_bf16_f32 v164, v164, v165
    s_add_u32 s57, s52, 229376
    buffer_store_dword v164, v8, s[44:47], s57 offen
    v_mul_f32 v166, s56, v166
    v_mul_f32 v167, s56, v167
    v_cvt_pk_bf16_f32 v166, v166, v167
    s_add_u32 s57, s52, 237568
    buffer_store_dword v166, v8, s[44:47], s57 offen
    v_cvt_pk_bf16_f32 v168, v168, v169
    s_add_u32 s57, s54, 0
    buffer_store_dword v168, v9, s[44:47], s57 offen
    v_cvt_pk_bf16_f32 v170, v170, v171
    s_add_u32 s57, s54, 155648
    buffer_store_dword v170, v9, s[44:47], s57 offen
    v_cvt_pk_bf16_f32 v172, v172, v173
    s_add_u32 s57, s54, 622592
    buffer_store_dword v172, v9, s[44:47], s57 offen
    v_cvt_pk_bf16_f32 v174, v174, v175
    s_add_u32 s57, s54, 778240
    buffer_store_dword v174, v9, s[44:47], s57 offen
    v_cvt_pk_bf16_f32 v176, v176, v177
    s_add_u32 s57, s54, 1245184
    buffer_store_dword v176, v9, s[44:47], s57 offen
    v_cvt_pk_bf16_f32 v178, v178, v179
    s_add_u32 s57, s54, 1400832
    buffer_store_dword v178, v9, s[44:47], s57 offen
    v_cvt_pk_bf16_f32 v180, v180, v181
    s_add_u32 s57, s54, 1867776
    buffer_store_dword v180, v9, s[44:47], s57 offen
    v_cvt_pk_bf16_f32 v182, v182, v183
    s_add_u32 s57, s54, 2023424
    buffer_store_dword v182, v9, s[44:47], s57 offen
    v_cvt_pk_bf16_f32 v184, v184, v185
    s_add_u32 s57, s54, 2490368
    buffer_store_dword v184, v9, s[44:47], s57 offen
    v_cvt_pk_bf16_f32 v186, v186, v187
    s_add_u32 s57, s54, 2646016
    buffer_store_dword v186, v9, s[44:47], s57 offen
    v_cvt_pk_bf16_f32 v188, v188, v189
    s_add_u32 s57, s54, 3112960
    buffer_store_dword v188, v9, s[44:47], s57 offen
    v_cvt_pk_bf16_f32 v190, v190, v191
    s_add_u32 s57, s54, 3268608
    buffer_store_dword v190, v9, s[44:47], s57 offen
    v_cvt_pk_bf16_f32 v192, v192, v193
    s_add_u32 s57, s54, 3735552
    buffer_store_dword v192, v9, s[44:47], s57 offen
    v_cvt_pk_bf16_f32 v194, v194, v195
    s_add_u32 s57, s54, 3891200
    buffer_store_dword v194, v9, s[44:47], s57 offen
    v_cvt_pk_bf16_f32 v196, v196, v197
    s_add_u32 s57, s54, 4358144
    buffer_store_dword v196, v9, s[44:47], s57 offen
    v_cvt_pk_bf16_f32 v198, v198, v199
    s_add_u32 s57, s54, 4513792
    buffer_store_dword v198, v9, s[44:47], s57 offen
    s_endpgm
L1_v:
    s_sub_u32 s51, s29, 9
    s_add_u32 m0, s50, 0
    s_add_u32 s67, s49, 0
    buffer_load_dwordx4 v2, s[36:39], s67 offen offset:0 lds
    buffer_load_dwordx4 v2, s[36:39], s67 offen offset:1024 lds
    buffer_load_dwordx4 v2, s[36:39], s67 offen offset:2048 lds
    buffer_load_dwordx4 v2, s[36:39], s67 offen offset:3072 lds
    s_add_u32 m0, s50, 4096
    s_add_u32 s67, s67, 4096
    buffer_load_dwordx4 v2, s[36:39], s67 offen offset:0 lds
    buffer_load_dwordx4 v2, s[36:39], s67 offen offset:1024 lds
    buffer_load_dwordx4 v[32:35], v2, s[32:35], s48 offen offset:0
    buffer_load_dwordx4 v[36:39], v2, s[32:35], s48 offen offset:1024
    buffer_load_dwordx4 v[40:43], v2, s[32:35], s48 offen offset:2048
    buffer_load_dwordx4 v[44:47], v2, s[32:35], s48 offen offset:3072
    s_add_u32 s48, s48, 4096
    buffer_load_dwordx4 v[48:51], v2, s[32:35], s48 offen offset:0
    buffer_load_dwordx4 v[52:55], v2, s[32:35], s48 offen offset:1024
    s_waitcnt vmcnt(12)
    v_add_f32 v8, v8, v24
    v_add_f32 v9, v9, v25
    v_add_f32 v10, v10, v26
    v_add_f32 v11, v11, v27
    v_add_f32 v12, v12, v28
    v_add_f32 v13, v13, v29
    v_add_f32 v14, v14, v30
    v_add_f32 v15, v15, v31
    v_cvt_pk_bf16_f32 v8, v8, v8
    v_cvt_pk_bf16_f32 v9, v9, v9
    v_cvt_pk_bf16_f32 v10, v10, v10
    v_cvt_pk_bf16_f32 v11, v11, v11
    v_cvt_pk_bf16_f32 v12, v12, v12
    v_cvt_pk_bf16_f32 v13, v13, v13
    v_cvt_pk_bf16_f32 v14, v14, v14
    v_cvt_pk_bf16_f32 v15, v15, v15
    v_and_b32 v8, s68, v8
    v_and_b32 v9, s68, v9
    v_and_b32 v10, s68, v10
    v_and_b32 v11, s68, v11
    v_and_b32 v12, s68, v12
    v_and_b32 v13, s68, v13
    v_and_b32 v14, s68, v14
    v_and_b32 v15, s68, v15
    s_add_u32 m0, s50, 24576
    s_add_u32 s67, s49, 24576
    buffer_load_dwordx4 v2, s[36:39], s67 offen offset:0 lds
    buffer_load_dwordx4 v2, s[36:39], s67 offen offset:1024 lds
    v_add_f32 v8, 1.0, v8
    v_add_f32 v9, 1.0, v9
    v_add_f32 v10, 1.0, v10
    v_add_f32 v11, 1.0, v11
    v_cvt_pk_bf16_f32 v8, v8, v8
    v_cvt_pk_bf16_f32 v9, v9, v9
    v_cvt_pk_bf16_f32 v10, v10, v10
    v_cvt_pk_bf16_f32 v11, v11, v11
    v_and_b32 v8, s68, v8
    v_and_b32 v9, s68, v9
    v_and_b32 v10, s68, v10
    v_and_b32 v11, s68, v11
    v_lshrrev_b32 v16, 1, v0
    v_lshlrev_b32 v16, 6, v16
    v_and_b32 v17, 1, v0
    v_lshl_add_u32 v16, v17, 4, v16
    v_cmp_gt_u32 vcc, 144, v0
    s_nop 0
    s_and_saveexec_b64 s[52:53], vcc
    ds_write_b128 v16, v[8:11]
    ds_write_b128 v16, v[12:15] offset:32
    s_mov_b64 exec, s[52:53]
    s_waitcnt vmcnt(8) lgkmcnt(0)
    s_barrier
    ds_read_b128 v[200:203], v5 offset:0
    ds_read_b128 v[204:207], v5 offset:16
    ds_read_b128 v[208:211], v5 offset:32
    ds_read_b128 v[212:215], v5 offset:48
    ds_read_b128 v[216:219], v5 offset:128
    ds_read_b128 v[220:223], v5 offset:144
    ds_read_b128 v[224:227], v5 offset:160
    ds_read_b128 v[228:231], v5 offset:176
    ds_read_b128 a[0:3], v3 offset:0
    ds_read_b128 a[4:7], v3 offset:1024
    ds_read_b128 a[8:11], v3 offset:2048
    ds_read_b128 a[12:15], v3 offset:3072
    buffer_load_dwordx4 v2, s[36:39], s67 offen offset:2048 lds
    buffer_load_dwordx4 v2, s[36:39], s67 offen offset:3072 lds
    s_waitcnt vmcnt(8) lgkmcnt(4)
    ds_read_b128 a[16:19], v3 offset:4096
    ds_read_b128 a[20:23], v3 offset:5120
    ds_read_b128 a[24:27], v3 offset:6144
    ds_read_b128 a[28:31], v3 offset:7168
    v_lshlrev_b32 v232, 16, v32
    v_and_b32 v233, s68, v32
    v_lshlrev_b32 v234, 16, v33
    v_and_b32 v235, s68, v33
    v_lshlrev_b32 v236, 16, v34
    v_and_b32 v237, s68, v34
    v_lshlrev_b32 v238, 16, v35
    v_and_b32 v239, s68, v35
    v_lshlrev_b32 v240, 16, v36
    v_and_b32 v241, s68, v36
    v_lshlrev_b32 v242, 16, v37
    v_and_b32 v243, s68, v37
    v_lshlrev_b32 v244, 16, v38
    v_and_b32 v245, s68, v38
    v_lshlrev_b32 v246, 16, v39
    v_and_b32 v247, s68, v39
    v_pk_fma_f32 v[232:233], v[232:233], v[200:201], v[208:209]
    v_pk_fma_f32 v[234:235], v[234:235], v[202:203], v[210:211]
    v_pk_fma_f32 v[236:237], v[236:237], v[204:205], v[212:213]
    v_pk_fma_f32 v[238:239], v[238:239], v[206:207], v[214:215]
    v_pk_fma_f32 v[240:241], v[240:241], v[216:217], v[224:225]
    v_pk_fma_f32 v[242:243], v[242:243], v[218:219], v[226:227]
    v_pk_fma_f32 v[244:245], v[244:245], v[220:221], v[228:229]
    v_pk_fma_f32 v[246:247], v[246:247], v[222:223], v[230:231]
    v_cvt_pk_bf16_f32 v248, v232, v233
    v_cvt_pk_bf16_f32 v249, v234, v235
    v_cvt_pk_bf16_f32 v250, v236, v237
    v_cvt_pk_bf16_f32 v251, v238, v239
    s_waitcnt lgkmcnt(4)
    s_nop 0
    v_mfma_f32_32x32x16_bf16 v[136:151], v[248:251], a[0:3], 0
    v_cvt_pk_bf16_f32 v252, v240, v241
    v_cvt_pk_bf16_f32 v253, v242, v243
    v_cvt_pk_bf16_f32 v254, v244, v245
    v_cvt_pk_bf16_f32 v255, v246, v247
    ds_read_b128 v[200:203], v5 offset:256
    ds_read_b128 v[204:207], v5 offset:272
    s_add_u32 m0, s50, 28672
    s_add_u32 s67, s67, 4096
    buffer_load_dwordx4 v2, s[36:39], s67 offen offset:0 lds
    v_mfma_f32_32x32x16_bf16 v[152:167], v[248:251], a[4:7], 0
    s_waitcnt vmcnt(7)
    ds_read_b128 v[208:211], v5 offset:288
    ds_read_b128 v[212:215], v5 offset:304
    ds_read_b128 v[216:219], v5 offset:384
    buffer_load_dwordx4 v2, s[36:39], s67 offen offset:1024 lds
    v_mfma_f32_32x32x16_bf16 v[168:183], v[248:251], a[8:11], 0
    v_lshlrev_b32 v232, 16, v40
    v_and_b32 v233, s68, v40
    v_lshlrev_b32 v234, 16, v41
    ds_read_b128 v[220:223], v5 offset:400
    ds_read_b128 v[224:227], v5 offset:416
    ds_read_b128 v[228:231], v5 offset:432
    buffer_load_dwordx4 v[56:59], v2, s[32:35], s48 offen offset:2048
    v_mfma_f32_32x32x16_bf16 v[184:199], v[248:251], a[12:15], 0
    v_and_b32 v235, s68, v41
    v_lshlrev_b32 v236, 16, v42
    v_and_b32 v237, s68, v42
    ds_read_b128 a[32:35], v3 offset:8192
    ds_read_b128 a[36:39], v3 offset:9216
    buffer_load_dwordx4 v[60:63], v2, s[32:35], s48 offen offset:3072
    s_waitcnt lgkmcnt(10)
    v_mfma_f32_32x32x16_bf16 v[136:151], v[252:255], a[16:19], v[136:151]
    v_lshlrev_b32 v238, 16, v43
    v_and_b32 v239, s68, v43
    v_lshlrev_b32 v240, 16, v44
    ds_read_b128 a[40:43], v3 offset:10240
    ds_read_b128 a[44:47], v3 offset:11264
    s_add_u32 s48, s48, 4096
    buffer_load_dwordx4 v[64:67], v2, s[32:35], s48 offen offset:0
    v_mfma_f32_32x32x16_bf16 v[152:167], v[252:255], a[20:23], v[152:167]
    v_and_b32 v241, s68, v44
    v_lshlrev_b32 v242, 16, v45
    v_and_b32 v243, s68, v45
    ds_read_b128 a[48:51], v3 offset:12288
    ds_read_b128 a[52:55], v3 offset:13312
    buffer_load_dwordx4 v[68:71], v2, s[32:35], s48 offen offset:1024
    v_mfma_f32_32x32x16_bf16 v[168:183], v[252:255], a[24:27], v[168:183]
    v_lshlrev_b32 v244, 16, v46
    v_and_b32 v245, s68, v46
    ds_read_b128 a[56:59], v3 offset:14336
    ds_read_b128 a[60:63], v3 offset:15360
    v_mfma_f32_32x32x16_bf16 v[184:199], v[252:255], a[28:31], v[184:199]
    v_lshlrev_b32 v246, 16, v47
    v_and_b32 v247, s68, v47
    buffer_load_dwordx4 v[72:75], v2, s[32:35], s48 offen offset:2048
    s_waitcnt lgkmcnt(8)
    v_pk_fma_f32 v[232:233], v[232:233], v[200:201], v[208:209]
    v_pk_fma_f32 v[234:235], v[234:235], v[202:203], v[210:211]
    v_pk_fma_f32 v[236:237], v[236:237], v[204:205], v[212:213]
    v_pk_fma_f32 v[238:239], v[238:239], v[206:207], v[214:215]
    v_pk_fma_f32 v[240:241], v[240:241], v[216:217], v[224:225]
    v_pk_fma_f32 v[242:243], v[242:243], v[218:219], v[226:227]
    v_pk_fma_f32 v[244:245], v[244:245], v[220:221], v[228:229]
    v_pk_fma_f32 v[246:247], v[246:247], v[222:223], v[230:231]
    v_cvt_pk_bf16_f32 v248, v232, v233
    v_cvt_pk_bf16_f32 v249, v234, v235
    v_cvt_pk_bf16_f32 v250, v236, v237
    v_cvt_pk_bf16_f32 v251, v238, v239
    s_waitcnt lgkmcnt(4)
    s_nop 0
    v_mfma_f32_32x32x16_bf16 v[136:151], v[248:251], a[32:35], v[136:151]
    v_cvt_pk_bf16_f32 v252, v240, v241
    v_cvt_pk_bf16_f32 v253, v242, v243
    v_cvt_pk_bf16_f32 v254, v244, v245
    v_cvt_pk_bf16_f32 v255, v246, v247
    ds_read_b128 v[200:203], v5 offset:512
    ds_read_b128 v[204:207], v5 offset:528
    buffer_load_dwordx4 v[76:79], v2, s[32:35], s48 offen offset:3072
    v_mfma_f32_32x32x16_bf16 v[152:167], v[248:251], a[36:39], v[152:167]
    s_waitcnt vmcnt(12)
    ds_read_b128 v[208:211], v5 offset:544
    ds_read_b128 v[212:215], v5 offset:560
    ds_read_b128 v[216:219], v5 offset:640
    s_add_u32 s48, s48, 4096
    s_add_u32 m0, s50, 49152
    s_add_u32 s67, s49, 49152
    buffer_load_dwordx4 v2, s[36:39], s67 offen offset:0 lds
    v_mfma_f32_32x32x16_bf16 v[168:183], v[248:251], a[40:43], v[168:183]
    v_lshlrev_b32 v232, 16, v48
    v_and_b32 v233, s68, v48
    v_lshlrev_b32 v234, 16, v49
    ds_read_b128 v[220:223], v5 offset:656
    ds_read_b128 v[224:227], v5 offset:672
    ds_read_b128 v[228:231], v5 offset:688
    buffer_load_dwordx4 v2, s[36:39], s67 offen offset:1024 lds
    v_mfma_f32_32x32x16_bf16 v[184:199], v[248:251], a[44:47], v[184:199]
    v_and_b32 v235, s68, v49
    v_lshlrev_b32 v236, 16, v50
    v_and_b32 v237, s68, v50
    ds_read_b128 a[0:3], v3 offset:16384
    ds_read_b128 a[4:7], v3 offset:17408
    buffer_load_dwordx4 v2, s[36:39], s67 offen offset:2048 lds
    s_waitcnt lgkmcnt(10)
    v_mfma_f32_32x32x16_bf16 v[136:151], v[252:255], a[48:51], v[136:151]
    v_lshlrev_b32 v238, 16, v51
    v_and_b32 v239, s68, v51
    v_lshlrev_b32 v240, 16, v52
    ds_read_b128 a[8:11], v3 offset:18432
    ds_read_b128 a[12:15], v3 offset:19456
    buffer_load_dwordx4 v2, s[36:39], s67 offen offset:3072 lds
    v_mfma_f32_32x32x16_bf16 v[152:167], v[252:255], a[52:55], v[152:167]
    v_and_b32 v241, s68, v52
    v_lshlrev_b32 v242, 16, v53
    v_and_b32 v243, s68, v53
    ds_read_b128 a[16:19], v3 offset:20480
    ds_read_b128 a[20:23], v3 offset:21504
    s_add_u32 m0, s50, 53248
    s_add_u32 s67, s67, 4096
    buffer_load_dwordx4 v2, s[36:39], s67 offen offset:0 lds
    v_mfma_f32_32x32x16_bf16 v[168:183], v[252:255], a[56:59], v[168:183]
    v_lshlrev_b32 v244, 16, v54
    v_and_b32 v245, s68, v54
    ds_read_b128 a[24:27], v3 offset:22528
    ds_read_b128 a[28:31], v3 offset:23552
    v_mfma_f32_32x32x16_bf16 v[184:199], v[252:255], a[60:63], v[184:199]
    v_lshlrev_b32 v246, 16, v55
    v_and_b32 v247, s68, v55
    buffer_load_dwordx4 v2, s[36:39], s67 offen offset:1024 lds
    s_waitcnt lgkmcnt(8)
    v_pk_fma_f32 v[232:233], v[232:233], v[200:201], v[208:209]
    v_pk_fma_f32 v[234:235], v[234:235], v[202:203], v[210:211]
    v_pk_fma_f32 v[236:237], v[236:237], v[204:205], v[212:213]
    v_pk_fma_f32 v[238:239], v[238:239], v[206:207], v[214:215]
    v_pk_fma_f32 v[240:241], v[240:241], v[216:217], v[224:225]
    v_pk_fma_f32 v[242:243], v[242:243], v[218:219], v[226:227]
    v_pk_fma_f32 v[244:245], v[244:245], v[220:221], v[228:229]
    v_pk_fma_f32 v[246:247], v[246:247], v[222:223], v[230:231]
    v_cvt_pk_bf16_f32 v248, v232, v233
    v_cvt_pk_bf16_f32 v249, v234, v235
    v_cvt_pk_bf16_f32 v250, v236, v237
    v_cvt_pk_bf16_f32 v251, v238, v239
    s_waitcnt lgkmcnt(4)
    s_nop 0
    v_mfma_f32_32x32x16_bf16 v[136:151], v[248:251], a[0:3], v[136:151]
    v_cvt_pk_bf16_f32 v252, v240, v241
    v_cvt_pk_bf16_f32 v253, v242, v243
    v_cvt_pk_bf16_f32 v254, v244, v245
    v_cvt_pk_bf16_f32 v255, v246, v247
    ds_read_b128 v[200:203], v5 offset:768
    ds_read_b128 v[204:207], v5 offset:784
    buffer_load_dwordx4 v[80:83], v2, s[32:35], s48 offen offset:0
    v_mfma_f32_32x32x16_bf16 v[152:167], v[248:251], a[4:7], v[152:167]
    s_waitcnt vmcnt(11)
    ds_read_b128 v[208:211], v5 offset:800
    ds_read_b128 v[212:215], v5 offset:816
    ds_read_b128 v[216:219], v5 offset:896
    buffer_load_dwordx4 v[84:87], v2, s[32:35], s48 offen offset:1024
    v_mfma_f32_32x32x16_bf16 v[168:183], v[248:251], a[8:11], v[168:183]
    v_lshlrev_b32 v232, 16, v56
    v_and_b32 v233, s68, v56
    v_lshlrev_b32 v234, 16, v57
    ds_read_b128 v[220:223], v5 offset:912
    ds_read_b128 v[224:227], v5 offset:928
    ds_read_b128 v[228:231], v5 offset:944
    buffer_load_dwordx4 v[88:91], v2, s[32:35], s48 offen offset:2048
    v_mfma_f32_32x32x16_bf16 v[184:199], v[248:251], a[12:15], v[184:199]
    v_and_b32 v235, s68, v57
    v_lshlrev_b32 v236, 16, v58
    v_and_b32 v237, s68, v58
    s_barrier
    buffer_load_dwordx4 v[92:95], v2, s[32:35], s48 offen offset:3072
    s_waitcnt lgkmcnt(8)
    v_mfma_f32_32x32x16_bf16 v[136:151], v[252:255], a[16:19], v[136:151]
    v_lshlrev_b32 v238, 16, v59
    v_and_b32 v239, s68, v59
    v_lshlrev_b32 v240, 16, v60
    ds_read_b128 a[32:35], v3 offset:24576
    ds_read_b128 a[36:39], v3 offset:25600
    s_add_u32 s48, s48, 4096
    buffer_load_dwordx4 v[96:99], v2, s[32:35], s48 offen offset:0
    v_mfma_f32_32x32x16_bf16 v[152:167], v[252:255], a[20:23], v[152:167]
    v_and_b32 v241, s68, v60
    v_lshlrev_b32 v242, 16, v61
    v_and_b32 v243, s68, v61
    ds_read_b128 a[40:43], v3 offset:26624
    ds_read_b128 a[44:47], v3 offset:27648
    buffer_load_dwordx4 v[100:103], v2, s[32:35], s48 offen offset:1024
    v_mfma_f32_32x32x16_bf16 v[168:183], v[252:255], a[24:27], v[168:183]
    v_lshlrev_b32 v244, 16, v62
    v_and_b32 v245, s68, v62
    ds_read_b128 a[48:51], v3 offset:28672
    ds_read_b128 a[52:55], v3 offset:29696
    v_mfma_f32_32x32x16_bf16 v[184:199], v[252:255], a[28:31], v[184:199]
    v_lshlrev_b32 v246, 16, v63
    v_and_b32 v247, s68, v63
    ds_read_b128 a[56:59], v3 offset:30720
    ds_read_b128 a[60:63], v3 offset:31744
    s_add_u32 m0, s50, 73728
    s_add_u32 s67, s49, 73728
    buffer_load_dwordx4 v2, s[36:39], s67 offen offset:0 lds
    s_waitcnt lgkmcnt(8)
    v_pk_fma_f32 v[232:233], v[232:233], v[200:201], v[208:209]
    v_pk_fma_f32 v[234:235], v[234:235], v[202:203], v[210:211]
    v_pk_fma_f32 v[236:237], v[236:237], v[204:205], v[212:213]
    v_pk_fma_f32 v[238:239], v[238:239], v[206:207], v[214:215]
    v_pk_fma_f32 v[240:241], v[240:241], v[216:217], v[224:225]
    v_pk_fma_f32 v[242:243], v[242:243], v[218:219], v[226:227]
    v_pk_fma_f32 v[244:245], v[244:245], v[220:221], v[228:229]
    v_pk_fma_f32 v[246:247], v[246:247], v[222:223], v[230:231]
    v_cvt_pk_bf16_f32 v248, v232, v233
    v_cvt_pk_bf16_f32 v249, v234, v235
    v_cvt_pk_bf16_f32 v250, v236, v237
    v_cvt_pk_bf16_f32 v251, v238, v239
    s_waitcnt lgkmcnt(4)
    s_nop 0
    v_mfma_f32_32x32x16_bf16 v[136:151], v[248:251], a[32:35], v[136:151]
    v_cvt_pk_bf16_f32 v252, v240, v241
    v_cvt_pk_bf16_f32 v253, v242, v243
    v_cvt_pk_bf16_f32 v254, v244, v245
    v_cvt_pk_bf16_f32 v255, v246, v247
    ds_read_b128 v[200:203], v5 offset:1024
    ds_read_b128 v[204:207], v5 offset:1040
    buffer_load_dwordx4 v2, s[36:39], s67 offen offset:1024 lds
    v_mfma_f32_32x32x16_bf16 v[152:167], v[248:251], a[36:39], v[152:167]
    s_waitcnt vmcnt(16)
    ds_read_b128 v[208:211], v5 offset:1056
    ds_read_b128 v[212:215], v5 offset:1072
    ds_read_b128 v[216:219], v5 offset:1152
    buffer_load_dwordx4 v2, s[36:39], s67 offen offset:2048 lds
    v_mfma_f32_32x32x16_bf16 v[168:183], v[248:251], a[40:43], v[168:183]
    v_lshlrev_b32 v232, 16, v64
    v_and_b32 v233, s68, v64
    v_lshlrev_b32 v234, 16, v65
    ds_read_b128 v[220:223], v5 offset:1168
    ds_read_b128 v[224:227], v5 offset:1184
    ds_read_b128 v[228:231], v5 offset:1200
    buffer_load_dwordx4 v2, s[36:39], s67 offen offset:3072 lds
    v_mfma_f32_32x32x16_bf16 v[184:199], v[248:251], a[44:47], v[184:199]
    v_and_b32 v235, s68, v65
    v_lshlrev_b32 v236, 16, v66
    v_and_b32 v237, s68, v66
    ds_read_b128 a[0:3], v3 offset:32768
    ds_read_b128 a[4:7], v3 offset:33792
    s_add_u32 m0, s50, 77824
    s_add_u32 s67, s67, 4096
    buffer_load_dwordx4 v2, s[36:39], s67 offen offset:0 lds
    s_waitcnt lgkmcnt(10)
    v_mfma_f32_32x32x16_bf16 v[136:151], v[252:255], a[48:51], v[136:151]
    v_lshlrev_b32 v238, 16, v67
    v_and_b32 v239, s68, v67
    v_lshlrev_b32 v240, 16, v68
    ds_read_b128 a[8:11], v3 offset:34816
    ds_read_b128 a[12:15], v3 offset:35840
    buffer_load_dwordx4 v2, s[36:39], s67 offen offset:1024 lds
    v_mfma_f32_32x32x16_bf16 v[152:167], v[252:255], a[52:55], v[152:167]
    v_and_b32 v241, s68, v68
    v_lshlrev_b32 v242, 16, v69
    v_and_b32 v243, s68, v69
    ds_read_b128 a[16:19], v3 offset:36864
    ds_read_b128 a[20:23], v3 offset:37888
    buffer_load_dwordx4 v[104:107], v2, s[32:35], s48 offen offset:2048
    v_mfma_f32_32x32x16_bf16 v[168:183], v[252:255], a[56:59], v[168:183]
    v_lshlrev_b32 v244, 16, v70
    v_and_b32 v245, s68, v70
    ds_read_b128 a[24:27], v3 offset:38912
    ds_read_b128 a[28:31], v3 offset:39936
    v_mfma_f32_32x32x16_bf16 v[184:199], v[252:255], a[60:63], v[184:199]
    v_lshlrev_b32 v246, 16, v71
    v_and_b32 v247, s68, v71
    buffer_load_dwordx4 v[108:111], v2, s[32:35], s48 offen offset:3072
    s_waitcnt lgkmcnt(8)
    v_pk_fma_f32 v[232:233], v[232:233], v[200:201], v[208:209]
    v_pk_fma_f32 v[234:235], v[234:235], v[202:203], v[210:211]
    v_pk_fma_f32 v[236:237], v[236:237], v[204:205], v[212:213]
    v_pk_fma_f32 v[238:239], v[238:239], v[206:207], v[214:215]
    v_pk_fma_f32 v[240:241], v[240:241], v[216:217], v[224:225]
    v_pk_fma_f32 v[242:243], v[242:243], v[218:219], v[226:227]
    v_pk_fma_f32 v[244:245], v[244:245], v[220:221], v[228:229]
    v_pk_fma_f32 v[246:247], v[246:247], v[222:223], v[230:231]
    v_cvt_pk_bf16_f32 v248, v232, v233
    v_cvt_pk_bf16_f32 v249, v234, v235
    v_cvt_pk_bf16_f32 v250, v236, v237
    v_cvt_pk_bf16_f32 v251, v238, v239
    s_waitcnt lgkmcnt(4)
    s_nop 0
    v_mfma_f32_32x32x16_bf16 v[136:151], v[248:251], a[0:3], v[136:151]
    v_cvt_pk_bf16_f32 v252, v240, v241
    v_cvt_pk_bf16_f32 v253, v242, v243
    v_cvt_pk_bf16_f32 v254, v244, v245
    v_cvt_pk_bf16_f32 v255, v246, v247
    ds_read_b128 v[200:203], v5 offset:1280
    ds_read_b128 v[204:207], v5 offset:1296
    v_mfma_f32_32x32x16_bf16 v[152:167], v[248:251], a[4:7], v[152:167]
    s_waitcnt vmcnt(20)
    ds_read_b128 v[208:211], v5 offset:1312
    ds_read_b128 v[212:215], v5 offset:1328
    ds_read_b128 v[216:219], v5 offset:1408
    s_add_u32 s48, s48, 4096
    buffer_load_dwordx4 v[112:115], v2, s[32:35], s48 offen offset:0
    v_mfma_f32_32x32x16_bf16 v[168:183], v[248:251], a[8:11], v[168:183]
    v_lshlrev_b32 v232, 16, v72
    v_and_b32 v233, s68, v72
    v_lshlrev_b32 v234, 16, v73
    ds_read_b128 v[220:223], v5 offset:1424
    ds_read_b128 v[224:227], v5 offset:1440
    ds_read_b128 v[228:231], v5 offset:1456
    v_mfma_f32_32x32x16_bf16 v[184:199], v[248:251], a[12:15], v[184:199]
    v_and_b32 v235, s68, v73
    v_lshlrev_b32 v236, 16, v74
    v_and_b32 v237, s68, v74
    ds_read_b128 a[32:35], v3 offset:40960
    ds_read_b128 a[36:39], v3 offset:41984
    buffer_load_dwordx4 v[116:119], v2, s[32:35], s48 offen offset:1024
    s_waitcnt lgkmcnt(10)
    v_mfma_f32_32x32x16_bf16 v[136:151], v[252:255], a[16:19], v[136:151]
    v_lshlrev_b32 v238, 16, v75
    v_and_b32 v239, s68, v75
    v_lshlrev_b32 v240, 16, v76
    ds_read_b128 a[40:43], v3 offset:43008
    ds_read_b128 a[44:47], v3 offset:44032
    v_mfma_f32_32x32x16_bf16 v[152:167], v[252:255], a[20:23], v[152:167]
    v_and_b32 v241, s68, v76
    v_lshlrev_b32 v242, 16, v77
    v_and_b32 v243, s68, v77
    ds_read_b128 a[48:51], v3 offset:45056
    ds_read_b128 a[52:55], v3 offset:46080
    buffer_load_dwordx4 v[120:123], v2, s[32:35], s48 offen offset:2048
    v_mfma_f32_32x32x16_bf16 v[168:183], v[252:255], a[24:27], v[168:183]
    v_lshlrev_b32 v244, 16, v78
    v_and_b32 v245, s68, v78
    ds_read_b128 a[56:59], v3 offset:47104
    ds_read_b128 a[60:63], v3 offset:48128
    v_mfma_f32_32x32x16_bf16 v[184:199], v[252:255], a[28:31], v[184:199]
    v_lshlrev_b32 v246, 16, v79
    v_and_b32 v247, s68, v79
    buffer_load_dwordx4 v[124:127], v2, s[32:35], s48 offen offset:3072
    s_waitcnt lgkmcnt(8)
    v_pk_fma_f32 v[232:233], v[232:233], v[200:201], v[208:209]
    v_pk_fma_f32 v[234:235], v[234:235], v[202:203], v[210:211]
    v_pk_fma_f32 v[236:237], v[236:237], v[204:205], v[212:213]
    v_pk_fma_f32 v[238:239], v[238:239], v[206:207], v[214:215]
    v_pk_fma_f32 v[240:241], v[240:241], v[216:217], v[224:225]
    v_pk_fma_f32 v[242:243], v[242:243], v[218:219], v[226:227]
    v_pk_fma_f32 v[244:245], v[244:245], v[220:221], v[228:229]
    v_pk_fma_f32 v[246:247], v[246:247], v[222:223], v[230:231]
    v_cvt_pk_bf16_f32 v248, v232, v233
    v_cvt_pk_bf16_f32 v249, v234, v235
    v_cvt_pk_bf16_f32 v250, v236, v237
    v_cvt_pk_bf16_f32 v251, v238, v239
    s_waitcnt lgkmcnt(4)
    s_nop 0
    v_mfma_f32_32x32x16_bf16 v[136:151], v[248:251], a[32:35], v[136:151]
    v_cvt_pk_bf16_f32 v252, v240, v241
    v_cvt_pk_bf16_f32 v253, v242, v243
    v_cvt_pk_bf16_f32 v254, v244, v245
    v_cvt_pk_bf16_f32 v255, v246, v247
    ds_read_b128 v[200:203], v5 offset:1536
    ds_read_b128 v[204:207], v5 offset:1552
    v_mfma_f32_32x32x16_bf16 v[152:167], v[248:251], a[36:39], v[152:167]
    s_waitcnt vmcnt(16)
    ds_read_b128 v[208:211], v5 offset:1568
    ds_read_b128 v[212:215], v5 offset:1584
    ds_read_b128 v[216:219], v5 offset:1664
    s_add_u32 s48, s48, 4096
    s_add_u32 m0, s50, 98304
    s_add_u32 s67, s49, 98304
    buffer_load_dwordx4 v2, s[36:39], s67 offen offset:0 lds
    v_mfma_f32_32x32x16_bf16 v[168:183], v[248:251], a[40:43], v[168:183]
    v_lshlrev_b32 v232, 16, v80
    v_and_b32 v233, s68, v80
    v_lshlrev_b32 v234, 16, v81
    ds_read_b128 v[220:223], v5 offset:1680
    ds_read_b128 v[224:227], v5 offset:1696
    ds_read_b128 v[228:231], v5 offset:1712
    v_mfma_f32_32x32x16_bf16 v[184:199], v[248:251], a[44:47], v[184:199]
    v_and_b32 v235, s68, v81
    v_lshlrev_b32 v236, 16, v82
    v_and_b32 v237, s68, v82
    s_barrier
    buffer_load_dwordx4 v2, s[36:39], s67 offen offset:1024 lds
    s_waitcnt lgkmcnt(8)
    v_mfma_f32_32x32x16_bf16 v[136:151], v[252:255], a[48:51], v[136:151]
    v_lshlrev_b32 v238, 16, v83
    v_and_b32 v239, s68, v83
    v_lshlrev_b32 v240, 16, v84
    ds_read_b128 a[0:3], v3 offset:49152
    ds_read_b128 a[4:7], v3 offset:50176
    v_mfma_f32_32x32x16_bf16 v[152:167], v[252:255], a[52:55], v[152:167]
    v_and_b32 v241, s68, v84
    v_lshlrev_b32 v242, 16, v85
    v_and_b32 v243, s68, v85
    ds_read_b128 a[8:11], v3 offset:51200
    ds_read_b128 a[12:15], v3 offset:52224
    buffer_load_dwordx4 v2, s[36:39], s67 offen offset:2048 lds
    v_mfma_f32_32x32x16_bf16 v[168:183], v[252:255], a[56:59], v[168:183]
    v_lshlrev_b32 v244, 16, v86
    v_and_b32 v245, s68, v86
    ds_read_b128 a[16:19], v3 offset:53248
    ds_read_b128 a[20:23], v3 offset:54272
    v_mfma_f32_32x32x16_bf16 v[184:199], v[252:255], a[60:63], v[184:199]
    v_lshlrev_b32 v246, 16, v87
    v_and_b32 v247, s68, v87
    ds_read_b128 a[24:27], v3 offset:55296
    ds_read_b128 a[28:31], v3 offset:56320
    buffer_load_dwordx4 v2, s[36:39], s67 offen offset:3072 lds
    s_waitcnt lgkmcnt(8)
    v_pk_fma_f32 v[232:233], v[232:233], v[200:201], v[208:209]
    v_pk_fma_f32 v[234:235], v[234:235], v[202:203], v[210:211]
    v_pk_fma_f32 v[236:237], v[236:237], v[204:205], v[212:213]
    v_pk_fma_f32 v[238:239], v[238:239], v[206:207], v[214:215]
    v_pk_fma_f32 v[240:241], v[240:241], v[216:217], v[224:225]
    v_pk_fma_f32 v[242:243], v[242:243], v[218:219], v[226:227]
    v_pk_fma_f32 v[244:245], v[244:245], v[220:221], v[228:229]
    v_pk_fma_f32 v[246:247], v[246:247], v[222:223], v[230:231]
    v_cvt_pk_bf16_f32 v248, v232, v233
    v_cvt_pk_bf16_f32 v249, v234, v235
    v_cvt_pk_bf16_f32 v250, v236, v237
    v_cvt_pk_bf16_f32 v251, v238, v239
    s_waitcnt lgkmcnt(4)
    s_nop 0
    v_mfma_f32_32x32x16_bf16 v[136:151], v[248:251], a[0:3], v[136:151]
    v_cvt_pk_bf16_f32 v252, v240, v241
    v_cvt_pk_bf16_f32 v253, v242, v243
    v_cvt_pk_bf16_f32 v254, v244, v245
    v_cvt_pk_bf16_f32 v255, v246, v247
    ds_read_b128 v[200:203], v5 offset:1792
    ds_read_b128 v[204:207], v5 offset:1808
    v_mfma_f32_32x32x16_bf16 v[152:167], v[248:251], a[4:7], v[152:167]
    s_waitcnt vmcnt(18)
    ds_read_b128 v[208:211], v5 offset:1824
    ds_read_b128 v[212:215], v5 offset:1840
    ds_read_b128 v[216:219], v5 offset:1920
    s_add_u32 m0, s50, 102400
    s_add_u32 s67, s67, 4096
    buffer_load_dwordx4 v2, s[36:39], s67 offen offset:0 lds
    v_mfma_f32_32x32x16_bf16 v[168:183], v[248:251], a[8:11], v[168:183]
    v_lshlrev_b32 v232, 16, v88
    v_and_b32 v233, s68, v88
    v_lshlrev_b32 v234, 16, v89
    ds_read_b128 v[220:223], v5 offset:1936
    ds_read_b128 v[224:227], v5 offset:1952
    ds_read_b128 v[228:231], v5 offset:1968
    v_mfma_f32_32x32x16_bf16 v[184:199], v[248:251], a[12:15], v[184:199]
    v_and_b32 v235, s68, v89
    v_lshlrev_b32 v236, 16, v90
    v_and_b32 v237, s68, v90
    ds_read_b128 a[32:35], v3 offset:57344
    ds_read_b128 a[36:39], v3 offset:58368
    buffer_load_dwordx4 v2, s[36:39], s67 offen offset:1024 lds
    s_waitcnt lgkmcnt(10)
    v_mfma_f32_32x32x16_bf16 v[136:151], v[252:255], a[16:19], v[136:151]
    v_lshlrev_b32 v238, 16, v91
    v_and_b32 v239, s68, v91
    v_lshlrev_b32 v240, 16, v92
    ds_read_b128 a[40:43], v3 offset:59392
    ds_read_b128 a[44:47], v3 offset:60416
    v_mfma_f32_32x32x16_bf16 v[152:167], v[252:255], a[20:23], v[152:167]
    v_and_b32 v241, s68, v92
    v_lshlrev_b32 v242, 16, v93
    v_and_b32 v243, s68, v93
    ds_read_b128 a[48:51], v3 offset:61440
    ds_read_b128 a[52:55], v3 offset:62464
    buffer_load_dwordx4 v[128:131], v2, s[32:35], s48 offen offset:0
    v_mfma_f32_32x32x16_bf16 v[168:183], v[252:255], a[24:27], v[168:183]
    v_lshlrev_b32 v244, 16, v94
    v_and_b32 v245, s68, v94
    ds_read_b128 a[56:59], v3 offset:63488
    ds_read_b128 a[60:63], v3 offset:64512
    v_mfma_f32_32x32x16_bf16 v[184:199], v[252:255], a[28:31], v[184:199]
    v_lshlrev_b32 v246, 16, v95
    v_and_b32 v247, s68, v95
    buffer_load_dwordx4 v[132:135], v2, s[32:35], s48 offen offset:1024
    s_waitcnt lgkmcnt(8)
    v_pk_fma_f32 v[232:233], v[232:233], v[200:201], v[208:209]
    v_pk_fma_f32 v[234:235], v[234:235], v[202:203], v[210:211]
    v_pk_fma_f32 v[236:237], v[236:237], v[204:205], v[212:213]
    v_pk_fma_f32 v[238:239], v[238:239], v[206:207], v[214:215]
    v_pk_fma_f32 v[240:241], v[240:241], v[216:217], v[224:225]
    v_pk_fma_f32 v[242:243], v[242:243], v[218:219], v[226:227]
    v_pk_fma_f32 v[244:245], v[244:245], v[220:221], v[228:229]
    v_pk_fma_f32 v[246:247], v[246:247], v[222:223], v[230:231]
    v_cvt_pk_bf16_f32 v248, v232, v233
    v_cvt_pk_bf16_f32 v249, v234, v235
    v_cvt_pk_bf16_f32 v250, v236, v237
    v_cvt_pk_bf16_f32 v251, v238, v239
    s_waitcnt lgkmcnt(4)
    s_nop 0
    v_mfma_f32_32x32x16_bf16 v[136:151], v[248:251], a[32:35], v[136:151]
    v_cvt_pk_bf16_f32 v252, v240, v241
    v_cvt_pk_bf16_f32 v253, v242, v243
    v_cvt_pk_bf16_f32 v254, v244, v245
    v_cvt_pk_bf16_f32 v255, v246, v247
    ds_read_b128 v[200:203], v5 offset:2048
    ds_read_b128 v[204:207], v5 offset:2064
    v_mfma_f32_32x32x16_bf16 v[152:167], v[248:251], a[36:39], v[152:167]
    s_waitcnt vmcnt(20)
    ds_read_b128 v[208:211], v5 offset:2080
    ds_read_b128 v[212:215], v5 offset:2096
    ds_read_b128 v[216:219], v5 offset:2176
    buffer_load_dwordx4 v[32:35], v2, s[32:35], s48 offen offset:2048
    v_mfma_f32_32x32x16_bf16 v[168:183], v[248:251], a[40:43], v[168:183]
    v_lshlrev_b32 v232, 16, v96
    v_and_b32 v233, s68, v96
    v_lshlrev_b32 v234, 16, v97
    ds_read_b128 v[220:223], v5 offset:2192
    ds_read_b128 v[224:227], v5 offset:2208
    ds_read_b128 v[228:231], v5 offset:2224
    v_mfma_f32_32x32x16_bf16 v[184:199], v[248:251], a[44:47], v[184:199]
    v_and_b32 v235, s68, v97
    v_lshlrev_b32 v236, 16, v98
    v_and_b32 v237, s68, v98
    ds_read_b128 a[0:3], v4 offset:0
    ds_read_b128 a[4:7], v4 offset:1024
    buffer_load_dwordx4 v[36:39], v2, s[32:35], s48 offen offset:3072
    s_waitcnt lgkmcnt(10)
    v_mfma_f32_32x32x16_bf16 v[136:151], v[252:255], a[48:51], v[136:151]
    v_lshlrev_b32 v238, 16, v99
    v_and_b32 v239, s68, v99
    v_lshlrev_b32 v240, 16, v100
    ds_read_b128 a[8:11], v4 offset:2048
    ds_read_b128 a[12:15], v4 offset:3072
    v_mfma_f32_32x32x16_bf16 v[152:167], v[252:255], a[52:55], v[152:167]
    v_and_b32 v241, s68, v100
    v_lshlrev_b32 v242, 16, v101
    v_and_b32 v243, s68, v101
    ds_read_b128 a[16:19], v4 offset:4096
    ds_read_b128 a[20:23], v4 offset:5120
    s_add_u32 s48, s48, 4096
    buffer_load_dwordx4 v[40:43], v2, s[32:35], s48 offen offset:0
    v_mfma_f32_32x32x16_bf16 v[168:183], v[252:255], a[56:59], v[168:183]
    v_lshlrev_b32 v244, 16, v102
    v_and_b32 v245, s68, v102
    ds_read_b128 a[24:27], v4 offset:6144
    ds_read_b128 a[28:31], v4 offset:7168
    v_mfma_f32_32x32x16_bf16 v[184:199], v[252:255], a[60:63], v[184:199]
    v_lshlrev_b32 v246, 16, v103
    v_and_b32 v247, s68, v103
    buffer_load_dwordx4 v[44:47], v2, s[32:35], s48 offen offset:1024
    s_waitcnt lgkmcnt(8)
    v_pk_fma_f32 v[232:233], v[232:233], v[200:201], v[208:209]
    v_pk_fma_f32 v[234:235], v[234:235], v[202:203], v[210:211]
    v_pk_fma_f32 v[236:237], v[236:237], v[204:205], v[212:213]
    v_pk_fma_f32 v[238:239], v[238:239], v[206:207], v[214:215]
    v_pk_fma_f32 v[240:241], v[240:241], v[216:217], v[224:225]
    v_pk_fma_f32 v[242:243], v[242:243], v[218:219], v[226:227]
    v_pk_fma_f32 v[244:245], v[244:245], v[220:221], v[228:229]
    v_pk_fma_f32 v[246:247], v[246:247], v[222:223], v[230:231]
    v_cvt_pk_bf16_f32 v248, v232, v233
    v_cvt_pk_bf16_f32 v249, v234, v235
    v_cvt_pk_bf16_f32 v250, v236, v237
    v_cvt_pk_bf16_f32 v251, v238, v239
    s_waitcnt lgkmcnt(4)
    s_nop 0
    v_mfma_f32_32x32x16_bf16 v[136:151], v[248:251], a[0:3], v[136:151]
    v_cvt_pk_bf16_f32 v252, v240, v241
    v_cvt_pk_bf16_f32 v253, v242, v243
    v_cvt_pk_bf16_f32 v254, v244, v245
    v_cvt_pk_bf16_f32 v255, v246, v247
    ds_read_b128 v[200:203], v5 offset:2304
    ds_read_b128 v[204:207], v5 offset:2320
    v_mfma_f32_32x32x16_bf16 v[152:167], v[248:251], a[4:7], v[152:167]
    s_waitcnt vmcnt(16)
    ds_read_b128 v[208:211], v5 offset:2336
    ds_read_b128 v[212:215], v5 offset:2352
    ds_read_b128 v[216:219], v5 offset:2432
    s_add_u32 m0, s50, 122880
    s_add_u32 s67, s49, 122880
    buffer_load_dwordx4 v2, s[36:39], s67 offen offset:0 lds
    v_mfma_f32_32x32x16_bf16 v[168:183], v[248:251], a[8:11], v[168:183]
    v_lshlrev_b32 v232, 16, v104
    v_and_b32 v233, s68, v104
    v_lshlrev_b32 v234, 16, v105
    ds_read_b128 v[220:223], v5 offset:2448
    ds_read_b128 v[224:227], v5 offset:2464
    ds_read_b128 v[228:231], v5 offset:2480
    v_mfma_f32_32x32x16_bf16 v[184:199], v[248:251], a[12:15], v[184:199]
    v_and_b32 v235, s68, v105
    v_lshlrev_b32 v236, 16, v106
    v_and_b32 v237, s68, v106
    s_barrier
    buffer_load_dwordx4 v2, s[36:39], s67 offen offset:1024 lds
    s_waitcnt lgkmcnt(8)
    v_mfma_f32_32x32x16_bf16 v[136:151], v[252:255], a[16:19], v[136:151]
    v_lshlrev_b32 v238, 16, v107
    v_and_b32 v239, s68, v107
    v_lshlrev_b32 v240, 16, v108
    ds_read_b128 a[32:35], v4 offset:8192
    ds_read_b128 a[36:39], v4 offset:9216
    v_mfma_f32_32x32x16_bf16 v[152:167], v[252:255], a[20:23], v[152:167]
    v_and_b32 v241, s68, v108
    v_lshlrev_b32 v242, 16, v109
    v_and_b32 v243, s68, v109
    ds_read_b128 a[40:43], v4 offset:10240
    ds_read_b128 a[44:47], v4 offset:11264
    buffer_load_dwordx4 v2, s[36:39], s67 offen offset:2048 lds
    v_mfma_f32_32x32x16_bf16 v[168:183], v[252:255], a[24:27], v[168:183]
    v_lshlrev_b32 v244, 16, v110
    v_and_b32 v245, s68, v110
    ds_read_b128 a[48:51], v4 offset:12288
    ds_read_b128 a[52:55], v4 offset:13312
    v_mfma_f32_32x32x16_bf16 v[184:199], v[252:255], a[28:31], v[184:199]
    v_lshlrev_b32 v246, 16, v111
    v_and_b32 v247, s68, v111
    ds_read_b128 a[56:59], v4 offset:14336
    ds_read_b128 a[60:63], v4 offset:15360
    buffer_load_dwordx4 v2, s[36:39], s67 offen offset:3072 lds
    s_waitcnt lgkmcnt(8)
    v_pk_fma_f32 v[232:233], v[232:233], v[200:201], v[208:209]
    v_pk_fma_f32 v[234:235], v[234:235], v[202:203], v[210:211]
    v_pk_fma_f32 v[236:237], v[236:237], v[204:205], v[212:213]
    v_pk_fma_f32 v[238:239], v[238:239], v[206:207], v[214:215]
    v_pk_fma_f32 v[240:241], v[240:241], v[216:217], v[224:225]
    v_pk_fma_f32 v[242:243], v[242:243], v[218:219], v[226:227]
    v_pk_fma_f32 v[244:245], v[244:245], v[220:221], v[228:229]
    v_pk_fma_f32 v[246:247], v[246:247], v[222:223], v[230:231]
    v_cvt_pk_bf16_f32 v248, v232, v233
    v_cvt_pk_bf16_f32 v249, v234, v235
    v_cvt_pk_bf16_f32 v250, v236, v237
    v_cvt_pk_bf16_f32 v251, v238, v239
    s_waitcnt lgkmcnt(4)
    s_nop 0
    v_mfma_f32_32x32x16_bf16 v[136:151], v[248:251], a[32:35], v[136:151]
    v_cvt_pk_bf16_f32 v252, v240, v241
    v_cvt_pk_bf16_f32 v253, v242, v243
    v_cvt_pk_bf16_f32 v254, v244, v245
    v_cvt_pk_bf16_f32 v255, v246, v247
    ds_read_b128 v[200:203], v5 offset:2560
    ds_read_b128 v[204:207], v5 offset:2576
    v_mfma_f32_32x32x16_bf16 v[152:167], v[248:251], a[36:39], v[152:167]
    s_waitcnt vmcnt(18)
    ds_read_b128 v[208:211], v5 offset:2592
    ds_read_b128 v[212:215], v5 offset:2608
    ds_read_b128 v[216:219], v5 offset:2688
    s_add_u32 m0, s50, 126976
    s_add_u32 s67, s67, 4096
    buffer_load_dwordx4 v2, s[36:39], s67 offen offset:0 lds
    v_mfma_f32_32x32x16_bf16 v[168:183], v[248:251], a[40:43], v[168:183]
    v_lshlrev_b32 v232, 16, v112
    v_and_b32 v233, s68, v112
    v_lshlrev_b32 v234, 16, v113
    ds_read_b128 v[220:223], v5 offset:2704
    ds_read_b128 v[224:227], v5 offset:2720
    ds_read_b128 v[228:231], v5 offset:2736
    v_mfma_f32_32x32x16_bf16 v[184:199], v[248:251], a[44:47], v[184:199]
    v_and_b32 v235, s68, v113
    v_lshlrev_b32 v236, 16, v114
    v_and_b32 v237, s68, v114
    ds_read_b128 a[0:3], v4 offset:16384
    ds_read_b128 a[4:7], v4 offset:17408
    buffer_load_dwordx4 v2, s[36:39], s67 offen offset:1024 lds
    s_waitcnt lgkmcnt(10)
    v_mfma_f32_32x32x16_bf16 v[136:151], v[252:255], a[48:51], v[136:151]
    v_lshlrev_b32 v238, 16, v115
    v_and_b32 v239, s68, v115
    v_lshlrev_b32 v240, 16, v116
    ds_read_b128 a[8:11], v4 offset:18432
    ds_read_b128 a[12:15], v4 offset:19456
    v_mfma_f32_32x32x16_bf16 v[152:167], v[252:255], a[52:55], v[152:167]
    v_and_b32 v241, s68, v116
    v_lshlrev_b32 v242, 16, v117
    v_and_b32 v243, s68, v117
    ds_read_b128 a[16:19], v4 offset:20480
    ds_read_b128 a[20:23], v4 offset:21504
    buffer_load_dwordx4 v[48:51], v2, s[32:35], s48 offen offset:2048
    v_mfma_f32_32x32x16_bf16 v[168:183], v[252:255], a[56:59], v[168:183]
    v_lshlrev_b32 v244, 16, v118
    v_and_b32 v245, s68, v118
    ds_read_b128 a[24:27], v4 offset:22528
    ds_read_b128 a[28:31], v4 offset:23552
    v_mfma_f32_32x32x16_bf16 v[184:199], v[252:255], a[60:63], v[184:199]
    v_lshlrev_b32 v246, 16, v119
    v_and_b32 v247, s68, v119
    buffer_load_dwordx4 v[52:55], v2, s[32:35], s48 offen offset:3072
    s_waitcnt lgkmcnt(8)
    v_pk_fma_f32 v[232:233], v[232:233], v[200:201], v[208:209]
    v_pk_fma_f32 v[234:235], v[234:235], v[202:203], v[210:211]
    v_pk_fma_f32 v[236:237], v[236:237], v[204:205], v[212:213]
    v_pk_fma_f32 v[238:239], v[238:239], v[206:207], v[214:215]
    v_pk_fma_f32 v[240:241], v[240:241], v[216:217], v[224:225]
    v_pk_fma_f32 v[242:243], v[242:243], v[218:219], v[226:227]
    v_pk_fma_f32 v[244:245], v[244:245], v[220:221], v[228:229]
    v_pk_fma_f32 v[246:247], v[246:247], v[222:223], v[230:231]
    v_cvt_pk_bf16_f32 v248, v232, v233
    v_cvt_pk_bf16_f32 v249, v234, v235
    v_cvt_pk_bf16_f32 v250, v236, v237
    v_cvt_pk_bf16_f32 v251, v238, v239
    s_waitcnt lgkmcnt(4)
    s_nop 0
    v_mfma_f32_32x32x16_bf16 v[136:151], v[248:251], a[0:3], v[136:151]
    v_cvt_pk_bf16_f32 v252, v240, v241
    v_cvt_pk_bf16_f32 v253, v242, v243
    v_cvt_pk_bf16_f32 v254, v244, v245
    v_cvt_pk_bf16_f32 v255, v246, v247
    ds_read_b128 v[200:203], v5 offset:2816
    ds_read_b128 v[204:207], v5 offset:2832
    v_mfma_f32_32x32x16_bf16 v[152:167], v[248:251], a[4:7], v[152:167]
    s_waitcnt vmcnt(20)
    ds_read_b128 v[208:211], v5 offset:2848
    ds_read_b128 v[212:215], v5 offset:2864
    ds_read_b128 v[216:219], v5 offset:2944
    s_add_u32 s48, s48, 4096
    buffer_load_dwordx4 v[56:59], v2, s[32:35], s48 offen offset:0
    v_mfma_f32_32x32x16_bf16 v[168:183], v[248:251], a[8:11], v[168:183]
    v_lshlrev_b32 v232, 16, v120
    v_and_b32 v233, s68, v120
    v_lshlrev_b32 v234, 16, v121
    ds_read_b128 v[220:223], v5 offset:2960
    ds_read_b128 v[224:227], v5 offset:2976
    ds_read_b128 v[228:231], v5 offset:2992
    v_mfma_f32_32x32x16_bf16 v[184:199], v[248:251], a[12:15], v[184:199]
    v_and_b32 v235, s68, v121
    v_lshlrev_b32 v236, 16, v122
    v_and_b32 v237, s68, v122
    ds_read_b128 a[32:35], v4 offset:24576
    ds_read_b128 a[36:39], v4 offset:25600
    buffer_load_dwordx4 v[60:63], v2, s[32:35], s48 offen offset:1024
    s_waitcnt lgkmcnt(10)
    v_mfma_f32_32x32x16_bf16 v[136:151], v[252:255], a[16:19], v[136:151]
    v_lshlrev_b32 v238, 16, v123
    v_and_b32 v239, s68, v123
    v_lshlrev_b32 v240, 16, v124
    ds_read_b128 a[40:43], v4 offset:26624
    ds_read_b128 a[44:47], v4 offset:27648
    v_mfma_f32_32x32x16_bf16 v[152:167], v[252:255], a[20:23], v[152:167]
    v_and_b32 v241, s68, v124
    v_lshlrev_b32 v242, 16, v125
    v_and_b32 v243, s68, v125
    ds_read_b128 a[48:51], v4 offset:28672
    ds_read_b128 a[52:55], v4 offset:29696
    buffer_load_dwordx4 v[64:67], v2, s[32:35], s48 offen offset:2048
    v_mfma_f32_32x32x16_bf16 v[168:183], v[252:255], a[24:27], v[168:183]
    v_lshlrev_b32 v244, 16, v126
    v_and_b32 v245, s68, v126
    ds_read_b128 a[56:59], v4 offset:30720
    ds_read_b128 a[60:63], v4 offset:31744
    v_mfma_f32_32x32x16_bf16 v[184:199], v[252:255], a[28:31], v[184:199]
    v_lshlrev_b32 v246, 16, v127
    v_and_b32 v247, s68, v127
    buffer_load_dwordx4 v[68:71], v2, s[32:35], s48 offen offset:3072
    s_waitcnt lgkmcnt(8)
    v_pk_fma_f32 v[232:233], v[232:233], v[200:201], v[208:209]
    v_pk_fma_f32 v[234:235], v[234:235], v[202:203], v[210:211]
    v_pk_fma_f32 v[236:237], v[236:237], v[204:205], v[212:213]
    v_pk_fma_f32 v[238:239], v[238:239], v[206:207], v[214:215]
    v_pk_fma_f32 v[240:241], v[240:241], v[216:217], v[224:225]
    v_pk_fma_f32 v[242:243], v[242:243], v[218:219], v[226:227]
    v_pk_fma_f32 v[244:245], v[244:245], v[220:221], v[228:229]
    v_pk_fma_f32 v[246:247], v[246:247], v[222:223], v[230:231]
    v_cvt_pk_bf16_f32 v248, v232, v233
    v_cvt_pk_bf16_f32 v249, v234, v235
    v_cvt_pk_bf16_f32 v250, v236, v237
    v_cvt_pk_bf16_f32 v251, v238, v239
    s_waitcnt lgkmcnt(4)
    s_nop 0
    v_mfma_f32_32x32x16_bf16 v[136:151], v[248:251], a[32:35], v[136:151]
    v_cvt_pk_bf16_f32 v252, v240, v241
    v_cvt_pk_bf16_f32 v253, v242, v243
    v_cvt_pk_bf16_f32 v254, v244, v245
    v_cvt_pk_bf16_f32 v255, v246, v247
    ds_read_b128 v[200:203], v5 offset:3072
    ds_read_b128 v[204:207], v5 offset:3088
    v_mfma_f32_32x32x16_bf16 v[152:167], v[248:251], a[36:39], v[152:167]
    s_waitcnt vmcnt(16)
    ds_read_b128 v[208:211], v5 offset:3104
    ds_read_b128 v[212:215], v5 offset:3120
    ds_read_b128 v[216:219], v5 offset:3200
    v_mfma_f32_32x32x16_bf16 v[168:183], v[248:251], a[40:43], v[168:183]
    v_lshlrev_b32 v232, 16, v128
    v_and_b32 v233, s68, v128
    v_lshlrev_b32 v234, 16, v129
    ds_read_b128 v[220:223], v5 offset:3216
    ds_read_b128 v[224:227], v5 offset:3232
    ds_read_b128 v[228:231], v5 offset:3248
    v_mfma_f32_32x32x16_bf16 v[184:199], v[248:251], a[44:47], v[184:199]
    v_and_b32 v235, s68, v129
    v_lshlrev_b32 v236, 16, v130
    v_and_b32 v237, s68, v130
    s_barrier
    s_waitcnt lgkmcnt(8)
    v_mfma_f32_32x32x16_bf16 v[136:151], v[252:255], a[48:51], v[136:151]
    v_lshlrev_b32 v238, 16, v131
    v_and_b32 v239, s68, v131
    v_lshlrev_b32 v240, 16, v132
    ds_read_b128 a[0:3], v4 offset:32768
    ds_read_b128 a[4:7], v4 offset:33792
    v_mfma_f32_32x32x16_bf16 v[152:167], v[252:255], a[52:55], v[152:167]
    v_and_b32 v241, s68, v132
    v_lshlrev_b32 v242, 16, v133
    v_and_b32 v243, s68, v133
    ds_read_b128 a[8:11], v4 offset:34816
    ds_read_b128 a[12:15], v4 offset:35840
    v_mfma_f32_32x32x16_bf16 v[168:183], v[252:255], a[56:59], v[168:183]
    v_lshlrev_b32 v244, 16, v134
    v_and_b32 v245, s68, v134
    ds_read_b128 a[16:19], v4 offset:36864
    ds_read_b128 a[20:23], v4 offset:37888
    v_mfma_f32_32x32x16_bf16 v[184:199], v[252:255], a[60:63], v[184:199]
    v_lshlrev_b32 v246, 16, v135
    v_and_b32 v247, s68, v135
    ds_read_b128 a[24:27], v4 offset:38912
    ds_read_b128 a[28:31], v4 offset:39936
    s_waitcnt lgkmcnt(8)
    v_pk_fma_f32 v[232:233], v[232:233], v[200:201], v[208:209]
    v_pk_fma_f32 v[234:235], v[234:235], v[202:203], v[210:211]
    v_pk_fma_f32 v[236:237], v[236:237], v[204:205], v[212:213]
    v_pk_fma_f32 v[238:239], v[238:239], v[206:207], v[214:215]
    v_pk_fma_f32 v[240:241], v[240:241], v[216:217], v[224:225]
    v_pk_fma_f32 v[242:243], v[242:243], v[218:219], v[226:227]
    v_pk_fma_f32 v[244:245], v[244:245], v[220:221], v[228:229]
    v_pk_fma_f32 v[246:247], v[246:247], v[222:223], v[230:231]
    v_cvt_pk_bf16_f32 v248, v232, v233
    v_cvt_pk_bf16_f32 v249, v234, v235
    v_cvt_pk_bf16_f32 v250, v236, v237
    v_cvt_pk_bf16_f32 v251, v238, v239
    s_waitcnt lgkmcnt(4)
    s_nop 0
    v_mfma_f32_32x32x16_bf16 v[136:151], v[248:251], a[0:3], v[136:151]
    v_cvt_pk_bf16_f32 v252, v240, v241
    v_cvt_pk_bf16_f32 v253, v242, v243
    v_cvt_pk_bf16_f32 v254, v244, v245
    v_cvt_pk_bf16_f32 v255, v246, v247
    ds_read_b128 v[200:203], v5 offset:3328
    ds_read_b128 v[204:207], v5 offset:3344
    v_mfma_f32_32x32x16_bf16 v[152:167], v[248:251], a[4:7], v[152:167]
    s_waitcnt vmcnt(14)
    ds_read_b128 v[208:211], v5 offset:3360
    ds_read_b128 v[212:215], v5 offset:3376
    ds_read_b128 v[216:219], v5 offset:3456
    v_mfma_f32_32x32x16_bf16 v[168:183], v[248:251], a[8:11], v[168:183]
    v_lshlrev_b32 v232, 16, v32
    v_and_b32 v233, s68, v32
    v_lshlrev_b32 v234, 16, v33
    ds_read_b128 v[220:223], v5 offset:3472
    ds_read_b128 v[224:227], v5 offset:3488
    ds_read_b128 v[228:231], v5 offset:3504
    v_mfma_f32_32x32x16_bf16 v[184:199], v[248:251], a[12:15], v[184:199]
    v_and_b32 v235, s68, v33
    v_lshlrev_b32 v236, 16, v34
    v_and_b32 v237, s68, v34
    ds_read_b128 a[32:35], v4 offset:40960
    ds_read_b128 a[36:39], v4 offset:41984
    s_waitcnt lgkmcnt(10)
    v_mfma_f32_32x32x16_bf16 v[136:151], v[252:255], a[16:19], v[136:151]
    v_lshlrev_b32 v238, 16, v35
    v_and_b32 v239, s68, v35
    v_lshlrev_b32 v240, 16, v36
    ds_read_b128 a[40:43], v4 offset:43008
    ds_read_b128 a[44:47], v4 offset:44032
    v_mfma_f32_32x32x16_bf16 v[152:167], v[252:255], a[20:23], v[152:167]
    v_and_b32 v241, s68, v36
    v_lshlrev_b32 v242, 16, v37
    v_and_b32 v243, s68, v37
    ds_read_b128 a[48:51], v4 offset:45056
    ds_read_b128 a[52:55], v4 offset:46080
    v_mfma_f32_32x32x16_bf16 v[168:183], v[252:255], a[24:27], v[168:183]
    v_lshlrev_b32 v244, 16, v38
    v_and_b32 v245, s68, v38
    ds_read_b128 a[56:59], v4 offset:47104
    ds_read_b128 a[60:63], v4 offset:48128
    v_mfma_f32_32x32x16_bf16 v[184:199], v[252:255], a[28:31], v[184:199]
    v_lshlrev_b32 v246, 16, v39
    v_and_b32 v247, s68, v39
    s_waitcnt lgkmcnt(8)
    v_pk_fma_f32 v[232:233], v[232:233], v[200:201], v[208:209]
    v_pk_fma_f32 v[234:235], v[234:235], v[202:203], v[210:211]
    v_pk_fma_f32 v[236:237], v[236:237], v[204:205], v[212:213]
    v_pk_fma_f32 v[238:239], v[238:239], v[206:207], v[214:215]
    v_pk_fma_f32 v[240:241], v[240:241], v[216:217], v[224:225]
    v_pk_fma_f32 v[242:243], v[242:243], v[218:219], v[226:227]
    v_pk_fma_f32 v[244:245], v[244:245], v[220:221], v[228:229]
    v_pk_fma_f32 v[246:247], v[246:247], v[222:223], v[230:231]
    v_cvt_pk_bf16_f32 v248, v232, v233
    v_cvt_pk_bf16_f32 v249, v234, v235
    v_cvt_pk_bf16_f32 v250, v236, v237
    v_cvt_pk_bf16_f32 v251, v238, v239
    s_waitcnt lgkmcnt(4)
    s_nop 0
    v_mfma_f32_32x32x16_bf16 v[136:151], v[248:251], a[32:35], v[136:151]
    v_cvt_pk_bf16_f32 v252, v240, v241
    v_cvt_pk_bf16_f32 v253, v242, v243
    v_cvt_pk_bf16_f32 v254, v244, v245
    v_cvt_pk_bf16_f32 v255, v246, v247
    ds_read_b128 v[200:203], v5 offset:3584
    ds_read_b128 v[204:207], v5 offset:3600
    v_mfma_f32_32x32x16_bf16 v[152:167], v[248:251], a[36:39], v[152:167]
    s_waitcnt vmcnt(12)
    ds_read_b128 v[208:211], v5 offset:3616
    ds_read_b128 v[212:215], v5 offset:3632
    ds_read_b128 v[216:219], v5 offset:3712
    v_mfma_f32_32x32x16_bf16 v[168:183], v[248:251], a[40:43], v[168:183]
    v_lshlrev_b32 v232, 16, v40
    v_and_b32 v233, s68, v40
    v_lshlrev_b32 v234, 16, v41
    ds_read_b128 v[220:223], v5 offset:3728
    ds_read_b128 v[224:227], v5 offset:3744
    ds_read_b128 v[228:231], v5 offset:3760
    v_mfma_f32_32x32x16_bf16 v[184:199], v[248:251], a[44:47], v[184:199]
    v_and_b32 v235, s68, v41
    v_lshlrev_b32 v236, 16, v42
    v_and_b32 v237, s68, v42
    ds_read_b128 a[0:3], v4 offset:49152
    ds_read_b128 a[4:7], v4 offset:50176
    s_waitcnt lgkmcnt(10)
    v_mfma_f32_32x32x16_bf16 v[136:151], v[252:255], a[48:51], v[136:151]
    v_lshlrev_b32 v238, 16, v43
    v_and_b32 v239, s68, v43
    v_lshlrev_b32 v240, 16, v44
    ds_read_b128 a[8:11], v4 offset:51200
    ds_read_b128 a[12:15], v4 offset:52224
    v_mfma_f32_32x32x16_bf16 v[152:167], v[252:255], a[52:55], v[152:167]
    v_and_b32 v241, s68, v44
    v_lshlrev_b32 v242, 16, v45
    v_and_b32 v243, s68, v45
    ds_read_b128 a[16:19], v4 offset:53248
    ds_read_b128 a[20:23], v4 offset:54272
    v_mfma_f32_32x32x16_bf16 v[168:183], v[252:255], a[56:59], v[168:183]
    v_lshlrev_b32 v244, 16, v46
    v_and_b32 v245, s68, v46
    ds_read_b128 a[24:27], v4 offset:55296
    ds_read_b128 a[28:31], v4 offset:56320
    v_mfma_f32_32x32x16_bf16 v[184:199], v[252:255], a[60:63], v[184:199]
    v_lshlrev_b32 v246, 16, v47
    v_and_b32 v247, s68, v47
    s_waitcnt lgkmcnt(8)
    v_pk_fma_f32 v[232:233], v[232:233], v[200:201], v[208:209]
    v_pk_fma_f32 v[234:235], v[234:235], v[202:203], v[210:211]
    v_pk_fma_f32 v[236:237], v[236:237], v[204:205], v[212:213]
    v_pk_fma_f32 v[238:239], v[238:239], v[206:207], v[214:215]
    v_pk_fma_f32 v[240:241], v[240:241], v[216:217], v[224:225]
    v_pk_fma_f32 v[242:243], v[242:243], v[218:219], v[226:227]
    v_pk_fma_f32 v[244:245], v[244:245], v[220:221], v[228:229]
    v_pk_fma_f32 v[246:247], v[246:247], v[222:223], v[230:231]
    v_cvt_pk_bf16_f32 v248, v232, v233
    v_cvt_pk_bf16_f32 v249, v234, v235
    v_cvt_pk_bf16_f32 v250, v236, v237
    v_cvt_pk_bf16_f32 v251, v238, v239
    s_waitcnt lgkmcnt(4)
    s_nop 0
    v_mfma_f32_32x32x16_bf16 v[136:151], v[248:251], a[0:3], v[136:151]
    v_cvt_pk_bf16_f32 v252, v240, v241
    v_cvt_pk_bf16_f32 v253, v242, v243
    v_cvt_pk_bf16_f32 v254, v244, v245
    v_cvt_pk_bf16_f32 v255, v246, v247
    ds_read_b128 v[200:203], v5 offset:3840
    ds_read_b128 v[204:207], v5 offset:3856
    v_mfma_f32_32x32x16_bf16 v[152:167], v[248:251], a[4:7], v[152:167]
    s_waitcnt vmcnt(4)
    ds_read_b128 v[208:211], v5 offset:3872
    ds_read_b128 v[212:215], v5 offset:3888
    ds_read_b128 v[216:219], v5 offset:3968
    v_mfma_f32_32x32x16_bf16 v[168:183], v[248:251], a[8:11], v[168:183]
    v_lshlrev_b32 v232, 16, v48
    v_and_b32 v233, s68, v48
    v_lshlrev_b32 v234, 16, v49
    ds_read_b128 v[220:223], v5 offset:3984
    ds_read_b128 v[224:227], v5 offset:4000
    ds_read_b128 v[228:231], v5 offset:4016
    v_mfma_f32_32x32x16_bf16 v[184:199], v[248:251], a[12:15], v[184:199]
    v_and_b32 v235, s68, v49
    v_lshlrev_b32 v236, 16, v50
    v_and_b32 v237, s68, v50
    s_barrier
    s_waitcnt lgkmcnt(8)
    v_mfma_f32_32x32x16_bf16 v[136:151], v[252:255], a[16:19], v[136:151]
    v_lshlrev_b32 v238, 16, v51
    v_and_b32 v239, s68, v51
    v_lshlrev_b32 v240, 16, v52
    ds_read_b128 a[32:35], v4 offset:57344
    ds_read_b128 a[36:39], v4 offset:58368
    v_mfma_f32_32x32x16_bf16 v[152:167], v[252:255], a[20:23], v[152:167]
    v_and_b32 v241, s68, v52
    v_lshlrev_b32 v242, 16, v53
    v_and_b32 v243, s68, v53
    ds_read_b128 a[40:43], v4 offset:59392
    ds_read_b128 a[44:47], v4 offset:60416
    v_mfma_f32_32x32x16_bf16 v[168:183], v[252:255], a[24:27], v[168:183]
    v_lshlrev_b32 v244, 16, v54
    v_and_b32 v245, s68, v54
    ds_read_b128 a[48:51], v4 offset:61440
    ds_read_b128 a[52:55], v4 offset:62464
    v_mfma_f32_32x32x16_bf16 v[184:199], v[252:255], a[28:31], v[184:199]
    v_lshlrev_b32 v246, 16, v55
    v_and_b32 v247, s68, v55
    ds_read_b128 a[56:59], v4 offset:63488
    ds_read_b128 a[60:63], v4 offset:64512
    s_waitcnt lgkmcnt(8)
    v_pk_fma_f32 v[232:233], v[232:233], v[200:201], v[208:209]
    v_pk_fma_f32 v[234:235], v[234:235], v[202:203], v[210:211]
    v_pk_fma_f32 v[236:237], v[236:237], v[204:205], v[212:213]
    v_pk_fma_f32 v[238:239], v[238:239], v[206:207], v[214:215]
    v_pk_fma_f32 v[240:241], v[240:241], v[216:217], v[224:225]
    v_pk_fma_f32 v[242:243], v[242:243], v[218:219], v[226:227]
    v_pk_fma_f32 v[244:245], v[244:245], v[220:221], v[228:229]
    v_pk_fma_f32 v[246:247], v[246:247], v[222:223], v[230:231]
    v_cvt_pk_bf16_f32 v248, v232, v233
    v_cvt_pk_bf16_f32 v249, v234, v235
    v_cvt_pk_bf16_f32 v250, v236, v237
    v_cvt_pk_bf16_f32 v251, v238, v239
    s_waitcnt lgkmcnt(4)
    s_nop 0
    v_mfma_f32_32x32x16_bf16 v[136:151], v[248:251], a[32:35], v[136:151]
    v_cvt_pk_bf16_f32 v252, v240, v241
    v_cvt_pk_bf16_f32 v253, v242, v243
    v_cvt_pk_bf16_f32 v254, v244, v245
    v_cvt_pk_bf16_f32 v255, v246, v247
    ds_read_b128 v[200:203], v5 offset:4096
    ds_read_b128 v[204:207], v5 offset:4112
    v_mfma_f32_32x32x16_bf16 v[152:167], v[248:251], a[36:39], v[152:167]
    s_waitcnt vmcnt(2)
    ds_read_b128 v[208:211], v5 offset:4128
    ds_read_b128 v[212:215], v5 offset:4144
    ds_read_b128 v[216:219], v5 offset:4224
    v_mfma_f32_32x32x16_bf16 v[168:183], v[248:251], a[40:43], v[168:183]
    v_lshlrev_b32 v232, 16, v56
    v_and_b32 v233, s68, v56
    v_lshlrev_b32 v234, 16, v57
    ds_read_b128 v[220:223], v5 offset:4240
    ds_read_b128 v[224:227], v5 offset:4256
    ds_read_b128 v[228:231], v5 offset:4272
    v_mfma_f32_32x32x16_bf16 v[184:199], v[248:251], a[44:47], v[184:199]
    v_and_b32 v235, s68, v57
    v_lshlrev_b32 v236, 16, v58
    v_and_b32 v237, s68, v58
    ds_read_b128 a[0:3], v18 offset:0
    ds_read_b128 a[4:7], v18 offset:1024
    s_waitcnt lgkmcnt(10)
    v_mfma_f32_32x32x16_bf16 v[136:151], v[252:255], a[48:51], v[136:151]
    v_lshlrev_b32 v238, 16, v59
    v_and_b32 v239, s68, v59
    v_lshlrev_b32 v240, 16, v60
    ds_read_b128 a[8:11], v18 offset:2048
    ds_read_b128 a[12:15], v18 offset:3072
    v_mfma_f32_32x32x16_bf16 v[152:167], v[252:255], a[52:55], v[152:167]
    v_and_b32 v241, s68, v60
    v_lshlrev_b32 v242, 16, v61
    v_and_b32 v243, s68, v61
    ds_read_b128 a[16:19], v18 offset:4096
    ds_read_b128 a[20:23], v18 offset:5120
    v_mfma_f32_32x32x16_bf16 v[168:183], v[252:255], a[56:59], v[168:183]
    v_lshlrev_b32 v244, 16, v62
    v_and_b32 v245, s68, v62
    ds_read_b128 a[24:27], v18 offset:6144
    ds_read_b128 a[28:31], v18 offset:7168
    v_mfma_f32_32x32x16_bf16 v[184:199], v[252:255], a[60:63], v[184:199]
    v_lshlrev_b32 v246, 16, v63
    v_and_b32 v247, s68, v63
    s_waitcnt lgkmcnt(8)
    v_pk_fma_f32 v[232:233], v[232:233], v[200:201], v[208:209]
    v_pk_fma_f32 v[234:235], v[234:235], v[202:203], v[210:211]
    v_pk_fma_f32 v[236:237], v[236:237], v[204:205], v[212:213]
    v_pk_fma_f32 v[238:239], v[238:239], v[206:207], v[214:215]
    v_pk_fma_f32 v[240:241], v[240:241], v[216:217], v[224:225]
    v_pk_fma_f32 v[242:243], v[242:243], v[218:219], v[226:227]
    v_pk_fma_f32 v[244:245], v[244:245], v[220:221], v[228:229]
    v_pk_fma_f32 v[246:247], v[246:247], v[222:223], v[230:231]
    v_cvt_pk_bf16_f32 v248, v232, v233
    v_cvt_pk_bf16_f32 v249, v234, v235
    v_cvt_pk_bf16_f32 v250, v236, v237
    v_cvt_pk_bf16_f32 v251, v238, v239
    s_waitcnt lgkmcnt(4)
    s_nop 0
    v_mfma_f32_32x32x16_bf16 v[136:151], v[248:251], a[0:3], v[136:151]
    v_cvt_pk_bf16_f32 v252, v240, v241
    v_cvt_pk_bf16_f32 v253, v242, v243
    v_cvt_pk_bf16_f32 v254, v244, v245
    v_cvt_pk_bf16_f32 v255, v246, v247
    ds_read_b128 v[200:203], v5 offset:4352
    ds_read_b128 v[204:207], v5 offset:4368
    v_mfma_f32_32x32x16_bf16 v[152:167], v[248:251], a[4:7], v[152:167]
    s_waitcnt vmcnt(0)
    ds_read_b128 v[208:211], v5 offset:4384
    ds_read_b128 v[212:215], v5 offset:4400
    ds_read_b128 v[216:219], v5 offset:4480
    v_mfma_f32_32x32x16_bf16 v[168:183], v[248:251], a[8:11], v[168:183]
    v_lshlrev_b32 v232, 16, v64
    v_and_b32 v233, s68, v64
    v_lshlrev_b32 v234, 16, v65
    ds_read_b128 v[220:223], v5 offset:4496
    ds_read_b128 v[224:227], v5 offset:4512
    ds_read_b128 v[228:231], v5 offset:4528
    v_mfma_f32_32x32x16_bf16 v[184:199], v[248:251], a[12:15], v[184:199]
    v_and_b32 v235, s68, v65
    v_lshlrev_b32 v236, 16, v66
    v_and_b32 v237, s68, v66
    ds_read_b128 a[32:35], v18 offset:8192
    ds_read_b128 a[36:39], v18 offset:9216
    s_waitcnt lgkmcnt(10)
    v_mfma_f32_32x32x16_bf16 v[136:151], v[252:255], a[16:19], v[136:151]
    v_lshlrev_b32 v238, 16, v67
    v_and_b32 v239, s68, v67
    v_lshlrev_b32 v240, 16, v68
    ds_read_b128 a[40:43], v18 offset:10240
    ds_read_b128 a[44:47], v18 offset:11264
    v_mfma_f32_32x32x16_bf16 v[152:167], v[252:255], a[20:23], v[152:167]
    v_and_b32 v241, s68, v68
    v_lshlrev_b32 v242, 16, v69
    v_and_b32 v243, s68, v69
    ds_read_b128 a[48:51], v18 offset:12288
    ds_read_b128 a[52:55], v18 offset:13312
    v_mfma_f32_32x32x16_bf16 v[168:183], v[252:255], a[24:27], v[168:183]
    v_lshlrev_b32 v244, 16, v70
    v_and_b32 v245, s68, v70
    ds_read_b128 a[56:59], v18 offset:14336
    ds_read_b128 a[60:63], v18 offset:15360
    v_mfma_f32_32x32x16_bf16 v[184:199], v[252:255], a[28:31], v[184:199]
    v_lshlrev_b32 v246, 16, v71
    v_and_b32 v247, s68, v71
    s_waitcnt lgkmcnt(8)
    v_pk_fma_f32 v[232:233], v[232:233], v[200:201], v[208:209]
    v_pk_fma_f32 v[234:235], v[234:235], v[202:203], v[210:211]
    v_pk_fma_f32 v[236:237], v[236:237], v[204:205], v[212:213]
    v_pk_fma_f32 v[238:239], v[238:239], v[206:207], v[214:215]
    v_pk_fma_f32 v[240:241], v[240:241], v[216:217], v[224:225]
    v_pk_fma_f32 v[242:243], v[242:243], v[218:219], v[226:227]
    v_pk_fma_f32 v[244:245], v[244:245], v[220:221], v[228:229]
    v_pk_fma_f32 v[246:247], v[246:247], v[222:223], v[230:231]
    v_cvt_pk_bf16_f32 v248, v232, v233
    v_cvt_pk_bf16_f32 v249, v234, v235
    v_cvt_pk_bf16_f32 v250, v236, v237
    v_cvt_pk_bf16_f32 v251, v238, v239
    s_waitcnt lgkmcnt(4)
    s_nop 0
    v_mfma_f32_32x32x16_bf16 v[136:151], v[248:251], a[32:35], v[136:151]
    v_cvt_pk_bf16_f32 v252, v240, v241
    v_cvt_pk_bf16_f32 v253, v242, v243
    v_cvt_pk_bf16_f32 v254, v244, v245
    v_cvt_pk_bf16_f32 v255, v246, v247
    v_mfma_f32_32x32x16_bf16 v[152:167], v[248:251], a[36:39], v[152:167]
    v_mfma_f32_32x32x16_bf16 v[168:183], v[248:251], a[40:43], v[168:183]
    v_mfma_f32_32x32x16_bf16 v[184:199], v[248:251], a[44:47], v[184:199]
    s_waitcnt lgkmcnt(0)
    v_mfma_f32_32x32x16_bf16 v[136:151], v[252:255], a[48:51], v[136:151]
    v_mfma_f32_32x32x16_bf16 v[152:167], v[252:255], a[52:55], v[152:167]
    v_mfma_f32_32x32x16_bf16 v[168:183], v[252:255], a[56:59], v[168:183]
    v_mfma_f32_32x32x16_bf16 v[184:199], v[252:255], a[60:63], v[184:199]
    s_lshr_b32 s54, s30, 3
    s_mul_i32 s54, s54, 19456
    s_and_b32 s55, s30, 7
    s_mul_i32 s55, s55, 1280
    s_add_u32 s54, s54, s55
    s_add_u32 s54, s54, 3154944
    s_lshl_b32 s52, s51, 7
    v_and_b32 v7, 31, v1
    v_add_u32 v7, s52, v7
    s_mov_b32 s53, 155648
    v_mov_b32 v20, 0x3f803f80
    v_mov_b32 v21, 0x3f803f80
    v_mov_b32 v22, 0x3f803f80
    v_mov_b32 v23, 0x3f803f80
    v_mov_b32 v16, 0
    v_mov_b32 v17, 0
    v_mov_b32 v18, 0
    v_mov_b32 v19, 0
    v_add_u32 v8, 0, v7
    v_mul_u32_u24 v9, 3641, v8
    v_lshrrev_b32 v9, 16, v9
    v_mul_u32_u24 v10, 18, v9
    v_sub_u32 v10, v8, v10
    v_mul_lo_u32 v11, v9, s53
    v_lshl_add_u32 v11, v10, 4, v11
    v_mul_u32_u24 v12, 320, v6
    v_add_u32 v11, v11, v12
    v_cvt_pk_bf16_f32 v32, v136, v137
    v_cvt_pk_bf16_f32 v33, v138, v139
    v_cvt_pk_bf16_f32 v34, v140, v141
    v_cvt_pk_bf16_f32 v35, v142, v143
    buffer_store_dwordx4 v[32:35], v11, s[44:47], s54 offen offset:0
    v_cvt_pk_bf16_f32 v36, v144, v145
    v_cvt_pk_bf16_f32 v37, v146, v147
    v_cvt_pk_bf16_f32 v38, v148, v149
    v_cvt_pk_bf16_f32 v39, v150, v151
    buffer_store_dwordx4 v[36:39], v11, s[44:47], s54 offen offset:640
    v_cmp_eq_u32 vcc, 17, v10
    s_nop 0
    s_and_saveexec_b64 s[56:57], vcc
    buffer_store_dwordx4 v[20:23], v11, s[44:47], s54 offen offset:16
    buffer_store_dwordx4 v[20:23], v11, s[44:47], s54 offen offset:656
    buffer_store_dwordx4 v[16:19], v11, s[44:47], s54 offen offset:32
    buffer_store_dwordx4 v[16:19], v11, s[44:47], s54 offen offset:672
    s_mov_b64 exec, s[56:57]
    v_add_u32 v8, 32, v7
    v_mul_u32_u24 v9, 3641, v8
    v_lshrrev_b32 v9, 16, v9
    v_mul_u32_u24 v10, 18, v9
    v_sub_u32 v10, v8, v10
    v_mul_lo_u32 v11, v9, s53
    v_lshl_add_u32 v11, v10, 4, v11
    v_mul_u32_u24 v12, 320, v6
    v_add_u32 v11, v11, v12
    v_cvt_pk_bf16_f32 v40, v152, v153
    v_cvt_pk_bf16_f32 v41, v154, v155
    v_cvt_pk_bf16_f32 v42, v156, v157
    v_cvt_pk_bf16_f32 v43, v158, v159
    buffer_store_dwordx4 v[40:43], v11, s[44:47], s54 offen offset:0
    v_cvt_pk_bf16_f32 v44, v160, v161
    v_cvt_pk_bf16_f32 v45, v162, v163
    v_cvt_pk_bf16_f32 v46, v164, v165
    v_cvt_pk_bf16_f32 v47, v166, v167
    buffer_store_dwordx4 v[44:47], v11, s[44:47], s54 offen offset:640
    v_cmp_eq_u32 vcc, 17, v10
    s_nop 0
    s_and_saveexec_b64 s[56:57], vcc
    buffer_store_dwordx4 v[20:23], v11, s[44:47], s54 offen offset:16
    buffer_store_dwordx4 v[20:23], v11, s[44:47], s54 offen offset:656
    buffer_store_dwordx4 v[16:19], v11, s[44:47], s54 offen offset:32
    buffer_store_dwordx4 v[16:19], v11, s[44:47], s54 offen offset:672
    s_mov_b64 exec, s[56:57]
    s_cmp_eq_u32 s51, 4
    s_cbranch_scc1 L1_exit
    v_add_u32 v8, 64, v7
    v_mul_u32_u24 v9, 3641, v8
    v_lshrrev_b32 v9, 16, v9
    v_mul_u32_u24 v10, 18, v9
    v_sub_u32 v10, v8, v10
    v_mul_lo_u32 v11, v9, s53
    v_lshl_add_u32 v11, v10, 4, v11
    v_mul_u32_u24 v12, 320, v6
    v_add_u32 v11, v11, v12
    v_cvt_pk_bf16_f32 v48, v168, v169
    v_cvt_pk_bf16_f32 v49, v170, v171
    v_cvt_pk_bf16_f32 v50, v172, v173
    v_cvt_pk_bf16_f32 v51, v174, v175
    buffer_store_dwordx4 v[48:51], v11, s[44:47], s54 offen offset:0
    v_cvt_pk_bf16_f32 v52, v176, v177
    v_cvt_pk_bf16_f32 v53, v178, v179
    v_cvt_pk_bf16_f32 v54, v180, v181
    v_cvt_pk_bf16_f32 v55, v182, v183
    buffer_store_dwordx4 v[52:55], v11, s[44:47], s54 offen offset:640
    v_cmp_eq_u32 vcc, 17, v10
    s_nop 0
    s_and_saveexec_b64 s[56:57], vcc
    buffer_store_dwordx4 v[20:23], v11, s[44:47], s54 offen offset:16
    buffer_store_dwordx4 v[20:23], v11, s[44:47], s54 offen offset:656
    buffer_store_dwordx4 v[16:19], v11, s[44:47], s54 offen offset:32
    buffer_store_dwordx4 v[16:19], v11, s[44:47], s54 offen offset:672
    s_mov_b64 exec, s[56:57]
    v_add_u32 v8, 96, v7
    v_mul_u32_u24 v9, 3641, v8
    v_lshrrev_b32 v9, 16, v9
    v_mul_u32_u24 v10, 18, v9
    v_sub_u32 v10, v8, v10
    v_mul_lo_u32 v11, v9, s53
    v_lshl_add_u32 v11, v10, 4, v11
    v_mul_u32_u24 v12, 320, v6
    v_add_u32 v11, v11, v12
    v_cvt_pk_bf16_f32 v56, v184, v185
    v_cvt_pk_bf16_f32 v57, v186, v187
    v_cvt_pk_bf16_f32 v58, v188, v189
    v_cvt_pk_bf16_f32 v59, v190, v191
    buffer_store_dwordx4 v[56:59], v11, s[44:47], s54 offen offset:0
    v_cvt_pk_bf16_f32 v60, v192, v193
    v_cvt_pk_bf16_f32 v61, v194, v195
    v_cvt_pk_bf16_f32 v62, v196, v197
    v_cvt_pk_bf16_f32 v63, v198, v199
    buffer_store_dwordx4 v[60:63], v11, s[44:47], s54 offen offset:640
    v_cmp_eq_u32 vcc, 17, v10
    s_nop 0
    s_and_saveexec_b64 s[56:57], vcc
    buffer_store_dwordx4 v[20:23], v11, s[44:47], s54 offen offset:16
    buffer_store_dwordx4 v[20:23], v11, s[44:47], s54 offen offset:656
    buffer_store_dwordx4 v[16:19], v11, s[44:47], s54 offen offset:32
    buffer_store_dwordx4 v[16:19], v11, s[44:47], s54 offen offset:672
    s_mov_b64 exec, s[56:57]
    s_endpgm
L1_idle:
    v_and_b32 v1, 63, v0
    v_lshlrev_b32 v2, 4, v1
    s_and_b32 s28, s2, 31
    s_mul_i32 s29, s28, 144
    s_add_u32 s29, s29, 2304
    v_mul_u32_u24 v3, 7282, v1
    v_lshrrev_b32 v3, 16, v3
    v_mul_u32_u24 v4, 9, v3
    v_sub_u32 v4, v1, v4
    s_mul_i32 s30, s3, 144
    v_add_u32 v5, s30, v3
    v_mul_u32_u24 v6, 6912, v5
    v_lshl_add_u32 v6, v4, 4, v6
    v_lshlrev_b32 v7, 1, v5
    v_mov_b32 v8, 0x40000000
    v_cmp_eq_u32 vcc, 63, v1
    s_nop 1
    v_cndmask_b32 v6, v6, v8, vcc
    v_cndmask_b32 v7, v7, v8, vcc
    v_cmp_le_u32 vcc, 4, v3
    s_nop 1
    v_cndmask_b32 v9, v6, v8, vcc
    v_cndmask_b32 v10, v7, v8, vcc
    s_waitcnt lgkmcnt(0)
    s_mov_b32 s32, s20
    s_mov_b32 s33, s21
    s_mov_b32 s34, 0x3cc000
    s_mov_b32 s35, 0x20000
    s_mov_b32 s36, s18
    s_mov_b32 s37, s19
    s_mov_b32 s38, 0x480
    s_mov_b32 s39, 0x20000
    buffer_load_ushort v120, v7, s[36:39], 0 offen offset:0
    buffer_load_ushort v121, v7, s[36:39], 0 offen offset:14
    buffer_load_ushort v122, v7, s[36:39], 0 offen offset:28
    buffer_load_ushort v123, v7, s[36:39], 0 offen offset:42
    buffer_load_ushort v124, v7, s[36:39], 0 offen offset:56
    buffer_load_ushort v125, v7, s[36:39], 0 offen offset:70
    buffer_load_ushort v126, v7, s[36:39], 0 offen offset:84
    buffer_load_ushort v127, v7, s[36:39], 0 offen offset:98
    buffer_load_ushort v128, v7, s[36:39], 0 offen offset:112
    buffer_load_ushort v129, v7, s[36:39], 0 offen offset:126
    buffer_load_ushort v130, v7, s[36:39], 0 offen offset:140
    buffer_load_ushort v131, v7, s[36:39], 0 offen offset:154
    buffer_load_ushort v132, v7, s[36:39], 0 offen offset:168
    buffer_load_ushort v133, v7, s[36:39], 0 offen offset:182
    buffer_load_ushort v134, v7, s[36:39], 0 offen offset:196
    buffer_load_ushort v135, v7, s[36:39], 0 offen offset:210
    buffer_load_ushort v136, v7, s[36:39], 0 offen offset:224
    buffer_load_ushort v137, v7, s[36:39], 0 offen offset:238
    buffer_load_ushort v138, v7, s[36:39], 0 offen offset:252
    buffer_load_ushort v139, v7, s[36:39], 0 offen offset:266
    buffer_load_ushort v140, v10, s[36:39], 0 offen offset:280
    buffer_load_dwordx4 v[32:35], v6, s[32:35], s29 offen
    s_add_u32 s29, s29, 48384
    buffer_load_dwordx4 v[36:39], v6, s[32:35], s29 offen
    s_add_u32 s29, s29, 48384
    buffer_load_dwordx4 v[40:43], v6, s[32:35], s29 offen
    s_add_u32 s29, s29, 48384
    buffer_load_dwordx4 v[44:47], v6, s[32:35], s29 offen
    s_add_u32 s29, s29, 48384
    buffer_load_dwordx4 v[48:51], v6, s[32:35], s29 offen
    s_add_u32 s29, s29, 48384
    buffer_load_dwordx4 v[52:55], v6, s[32:35], s29 offen
    s_add_u32 s29, s29, 48384
    buffer_load_dwordx4 v[56:59], v6, s[32:35], s29 offen
    s_add_u32 s29, s29, 48384
    buffer_load_dwordx4 v[60:63], v6, s[32:35], s29 offen
    s_add_u32 s29, s29, 48384
    buffer_load_dwordx4 v[64:67], v6, s[32:35], s29 offen
    s_add_u32 s29, s29, 48384
    buffer_load_dwordx4 v[68:71], v6, s[32:35], s29 offen
    s_add_u32 s29, s29, 48384
    buffer_load_dwordx4 v[72:75], v6, s[32:35], s29 offen
    s_add_u32 s29, s29, 48384
    buffer_load_dwordx4 v[76:79], v6, s[32:35], s29 offen
    s_add_u32 s29, s29, 48384
    buffer_load_dwordx4 v[80:83], v6, s[32:35], s29 offen
    s_add_u32 s29, s29, 48384
    buffer_load_dwordx4 v[84:87], v6, s[32:35], s29 offen
    s_add_u32 s29, s29, 48384
    buffer_load_dwordx4 v[88:91], v6, s[32:35], s29 offen
    s_add_u32 s29, s29, 48384
    buffer_load_dwordx4 v[92:95], v6, s[32:35], s29 offen
    s_add_u32 s29, s29, 48384
    buffer_load_dwordx4 v[96:99], v6, s[32:35], s29 offen
    s_add_u32 s29, s29, 48384
    buffer_load_dwordx4 v[100:103], v6, s[32:35], s29 offen
    s_add_u32 s29, s29, 48384
    buffer_load_dwordx4 v[104:107], v6, s[32:35], s29 offen
    s_add_u32 s29, s29, 48384
    buffer_load_dwordx4 v[108:111], v6, s[32:35], s29 offen
    s_add_u32 s29, s29, 48384
    buffer_load_dwordx4 v[112:115], v9, s[32:35], s29 offen
    s_mov_b32 s40, s26
    s_mov_b32 s41, s27
    s_mov_b32 s42, 0x3600
    s_mov_b32 s43, 0x20000
    s_add_u32 s44, s26, 0x8000
    s_addc_u32 s45, s27, 0
    s_mov_b32 s46, 0x900
    s_mov_b32 s47, 0x20000
    s_getpc_b64 s[52:53]
Lpc1:
    s_add_u32 s52, s52, k2_kernel-Lpc1
    s_addc_u32 s53, s53, 0
    s_mul_i32 s54, s3, 3072
    v_add_u32 v210, s54, v2
    v_min_u32 v211, L2_exit-k2_kernel-16, v210
    global_load_dwordx4 v[212:215], v211, s[52:53]
    v_add_u32 v210, 1024, v210
    v_min_u32 v211, L2_exit-k2_kernel-16, v210
    global_load_dwordx4 v[212:215], v211, s[52:53]
    v_add_u32 v210, 1024, v210
    v_min_u32 v211, L2_exit-k2_kernel-16, v210
    global_load_dwordx4 v[212:215], v211, s[52:53]
    s_mov_b32 s48, 0x3fb8aa3b
    s_mov_b32 s49, 0xffff0000
    s_mul_i32 s30, s3, 7
    v_add_u32 v11, s30, v3
    v_mul_u32_u24 v11, 288, v11
    v_lshl_add_u32 v11, v4, 5, v11
    s_waitcnt vmcnt(24)
    v_lshlrev_b32 v120, 16, v120
    v_mul_f32 v144, s48, v120
    v_lshlrev_b32 v121, 16, v121
    v_mul_f32 v146, s48, v121
    v_lshlrev_b32 v122, 16, v122
    v_mul_f32 v148, s48, v122
    v_lshlrev_b32 v123, 16, v123
    v_mul_f32 v150, s48, v123
    v_lshlrev_b32 v124, 16, v124
    v_mul_f32 v152, s48, v124
    v_lshlrev_b32 v125, 16, v125
    v_mul_f32 v154, s48, v125
    v_lshlrev_b32 v126, 16, v126
    v_mul_f32 v156, s48, v126
    v_lshlrev_b32 v127, 16, v127
    v_mul_f32 v158, s48, v127
    v_lshlrev_b32 v128, 16, v128
    v_mul_f32 v160, s48, v128
    v_lshlrev_b32 v129, 16, v129
    v_mul_f32 v162, s48, v129
    v_lshlrev_b32 v130, 16, v130
    v_mul_f32 v164, s48, v130
    v_lshlrev_b32 v131, 16, v131
    v_mul_f32 v166, s48, v131
    v_lshlrev_b32 v132, 16, v132
    v_mul_f32 v168, s48, v132
    v_lshlrev_b32 v133, 16, v133
    v_mul_f32 v170, s48, v133
    v_lshlrev_b32 v134, 16, v134
    v_mul_f32 v172, s48, v134
    v_lshlrev_b32 v135, 16, v135
    v_mul_f32 v174, s48, v135
    v_lshlrev_b32 v136, 16, v136
    v_mul_f32 v176, s48, v136
    v_lshlrev_b32 v137, 16, v137
    v_mul_f32 v178, s48, v137
    v_lshlrev_b32 v138, 16, v138
    v_mul_f32 v180, s48, v138
    v_lshlrev_b32 v139, 16, v139
    v_mul_f32 v182, s48, v139
    v_lshlrev_b32 v140, 16, v140
    v_mul_f32 v184, s48, v140
    v_exp_f32 v144, -v144
    v_exp_f32 v146, -v146
    v_exp_f32 v148, -v148
    v_exp_f32 v150, -v150
    v_exp_f32 v152, -v152
    v_exp_f32 v154, -v154
    v_exp_f32 v156, -v156
    v_exp_f32 v158, -v158
    v_exp_f32 v160, -v160
    v_exp_f32 v162, -v162
    v_exp_f32 v164, -v164
    v_exp_f32 v166, -v166
    v_exp_f32 v168, -v168
    v_exp_f32 v170, -v170
    v_exp_f32 v172, -v172
    v_exp_f32 v174, -v174
    v_exp_f32 v176, -v176
    v_exp_f32 v178, -v178
    v_exp_f32 v180, -v180
    v_exp_f32 v182, -v182
    v_exp_f32 v184, -v184
    v_add_f32 v144, 1.0, v144
    v_add_f32 v146, 1.0, v146
    v_add_f32 v148, 1.0, v148
    v_add_f32 v150, 1.0, v150
    v_add_f32 v152, 1.0, v152
    v_add_f32 v154, 1.0, v154
    v_add_f32 v156, 1.0, v156
    v_add_f32 v158, 1.0, v158
    v_add_f32 v160, 1.0, v160
    v_add_f32 v162, 1.0, v162
    v_add_f32 v164, 1.0, v164
    v_add_f32 v166, 1.0, v166
    v_add_f32 v168, 1.0, v168
    v_add_f32 v170, 1.0, v170
    v_add_f32 v172, 1.0, v172
    v_add_f32 v174, 1.0, v174
    v_add_f32 v176, 1.0, v176
    v_add_f32 v178, 1.0, v178
    v_add_f32 v180, 1.0, v180
    v_add_f32 v182, 1.0, v182
    v_add_f32 v184, 1.0, v184
    v_rcp_f32 v144, v144
    v_rcp_f32 v146, v146
    v_rcp_f32 v148, v148
    v_rcp_f32 v150, v150
    v_rcp_f32 v152, v152
    v_rcp_f32 v154, v154
    v_rcp_f32 v156, v156
    v_rcp_f32 v158, v158
    v_rcp_f32 v160, v160
    v_rcp_f32 v162, v162
    v_rcp_f32 v164, v164
    v_rcp_f32 v166, v166
    v_rcp_f32 v168, v168
    v_rcp_f32 v170, v170
    v_rcp_f32 v172, v172
    v_rcp_f32 v174, v174
    v_rcp_f32 v176, v176
    v_rcp_f32 v178, v178
    v_rcp_f32 v180, v180
    v_rcp_f32 v182, v182
    v_rcp_f32 v184, v184
    v_mul_f32 v120, v120, v144
    v_mul_f32 v121, v121, v146
    v_mul_f32 v122, v122, v148
    v_mul_f32 v123, v123, v150
    v_mul_f32 v124, v124, v152
    v_mul_f32 v125, v125, v154
    v_mul_f32 v126, v126, v156
    v_mul_f32 v127, v127, v158
    v_mul_f32 v128, v128, v160
    v_mul_f32 v129, v129, v162
    v_mul_f32 v130, v130, v164
    v_mul_f32 v131, v131, v166
    v_mul_f32 v132, v132, v168
    v_mul_f32 v133, v133, v170
    v_mul_f32 v134, v134, v172
    v_mul_f32 v135, v135, v174
    v_mul_f32 v136, v136, v176
    v_mul_f32 v137, v137, v178
    v_mul_f32 v138, v138, v180
    v_mul_f32 v139, v139, v182
    v_mul_f32 v140, v140, v184
    v_cvt_pk_bf16_f32 v120, v120, v120
    v_cvt_pk_bf16_f32 v121, v121, v121
    v_cvt_pk_bf16_f32 v122, v122, v122
    v_cvt_pk_bf16_f32 v123, v123, v123
    v_cvt_pk_bf16_f32 v124, v124, v124
    v_cvt_pk_bf16_f32 v125, v125, v125
    v_cvt_pk_bf16_f32 v126, v126, v126
    v_cvt_pk_bf16_f32 v127, v127, v127
    v_cvt_pk_bf16_f32 v128, v128, v128
    v_cvt_pk_bf16_f32 v129, v129, v129
    v_cvt_pk_bf16_f32 v130, v130, v130
    v_cvt_pk_bf16_f32 v131, v131, v131
    v_cvt_pk_bf16_f32 v132, v132, v132
    v_cvt_pk_bf16_f32 v133, v133, v133
    v_cvt_pk_bf16_f32 v134, v134, v134
    v_cvt_pk_bf16_f32 v135, v135, v135
    v_cvt_pk_bf16_f32 v136, v136, v136
    v_cvt_pk_bf16_f32 v137, v137, v137
    v_cvt_pk_bf16_f32 v138, v138, v138
    v_cvt_pk_bf16_f32 v139, v139, v139
    v_cvt_pk_bf16_f32 v140, v140, v140
    v_and_b32 v144, s49, v120
    v_and_b32 v146, s49, v121
    v_and_b32 v148, s49, v122
    v_and_b32 v150, s49, v123
    v_and_b32 v152, s49, v124
    v_and_b32 v154, s49, v125
    v_and_b32 v156, s49, v126
    v_and_b32 v158, s49, v127
    v_and_b32 v160, s49, v128
    v_and_b32 v162, s49, v129
    v_and_b32 v164, s49, v130
    v_and_b32 v166, s49, v131
    v_and_b32 v168, s49, v132
    v_and_b32 v170, s49, v133
    v_and_b32 v172, s49, v134
    v_and_b32 v174, s49, v135
    v_and_b32 v176, s49, v136
    v_and_b32 v178, s49, v137
    v_and_b32 v180, s49, v138
    v_and_b32 v182, s49, v139
    v_and_b32 v184, s49, v140
    s_waitcnt vmcnt(23)
    v_lshlrev_b32 v190, 16, v32
    v_and_b32 v191, s49, v32
    v_lshlrev_b32 v192, 16, v33
    v_and_b32 v193, s49, v33
    v_lshlrev_b32 v194, 16, v34
    v_and_b32 v195, s49, v34
    v_lshlrev_b32 v196, 16, v35
    v_and_b32 v197, s49, v35
    v_pk_mul_f32 v[200:201], v[190:191], v[144:145] op_sel_hi:[1,0]
    v_pk_mul_f32 v[202:203], v[192:193], v[144:145] op_sel_hi:[1,0]
    v_pk_mul_f32 v[204:205], v[194:195], v[144:145] op_sel_hi:[1,0]
    v_pk_mul_f32 v[206:207], v[196:197], v[144:145] op_sel_hi:[1,0]
    s_waitcnt vmcnt(22)
    v_lshlrev_b32 v190, 16, v36
    v_and_b32 v191, s49, v36
    v_lshlrev_b32 v192, 16, v37
    v_and_b32 v193, s49, v37
    v_lshlrev_b32 v194, 16, v38
    v_and_b32 v195, s49, v38
    v_lshlrev_b32 v196, 16, v39
    v_and_b32 v197, s49, v39
    v_pk_fma_f32 v[200:201], v[190:191], v[146:147], v[200:201] op_sel_hi:[1,0,1]
    v_pk_fma_f32 v[202:203], v[192:193], v[146:147], v[202:203] op_sel_hi:[1,0,1]
    v_pk_fma_f32 v[204:205], v[194:195], v[146:147], v[204:205] op_sel_hi:[1,0,1]
    v_pk_fma_f32 v[206:207], v[196:197], v[146:147], v[206:207] op_sel_hi:[1,0,1]
    s_waitcnt vmcnt(21)
    v_lshlrev_b32 v190, 16, v40
    v_and_b32 v191, s49, v40
    v_lshlrev_b32 v192, 16, v41
    v_and_b32 v193, s49, v41
    v_lshlrev_b32 v194, 16, v42
    v_and_b32 v195, s49, v42
    v_lshlrev_b32 v196, 16, v43
    v_and_b32 v197, s49, v43
    v_pk_fma_f32 v[200:201], v[190:191], v[148:149], v[200:201] op_sel_hi:[1,0,1]
    v_pk_fma_f32 v[202:203], v[192:193], v[148:149], v[202:203] op_sel_hi:[1,0,1]
    v_pk_fma_f32 v[204:205], v[194:195], v[148:149], v[204:205] op_sel_hi:[1,0,1]
    v_pk_fma_f32 v[206:207], v[196:197], v[148:149], v[206:207] op_sel_hi:[1,0,1]
    s_waitcnt vmcnt(20)
    v_lshlrev_b32 v190, 16, v44
    v_and_b32 v191, s49, v44
    v_lshlrev_b32 v192, 16, v45
    v_and_b32 v193, s49, v45
    v_lshlrev_b32 v194, 16, v46
    v_and_b32 v195, s49, v46
    v_lshlrev_b32 v196, 16, v47
    v_and_b32 v197, s49, v47
    v_pk_fma_f32 v[200:201], v[190:191], v[150:151], v[200:201] op_sel_hi:[1,0,1]
    v_pk_fma_f32 v[202:203], v[192:193], v[150:151], v[202:203] op_sel_hi:[1,0,1]
    v_pk_fma_f32 v[204:205], v[194:195], v[150:151], v[204:205] op_sel_hi:[1,0,1]
    v_pk_fma_f32 v[206:207], v[196:197], v[150:151], v[206:207] op_sel_hi:[1,0,1]
    s_waitcnt vmcnt(19)
    v_lshlrev_b32 v190, 16, v48
    v_and_b32 v191, s49, v48
    v_lshlrev_b32 v192, 16, v49
    v_and_b32 v193, s49, v49
    v_lshlrev_b32 v194, 16, v50
    v_and_b32 v195, s49, v50
    v_lshlrev_b32 v196, 16, v51
    v_and_b32 v197, s49, v51
    v_pk_fma_f32 v[200:201], v[190:191], v[152:153], v[200:201] op_sel_hi:[1,0,1]
    v_pk_fma_f32 v[202:203], v[192:193], v[152:153], v[202:203] op_sel_hi:[1,0,1]
    v_pk_fma_f32 v[204:205], v[194:195], v[152:153], v[204:205] op_sel_hi:[1,0,1]
    v_pk_fma_f32 v[206:207], v[196:197], v[152:153], v[206:207] op_sel_hi:[1,0,1]
    s_waitcnt vmcnt(18)
    v_lshlrev_b32 v190, 16, v52
    v_and_b32 v191, s49, v52
    v_lshlrev_b32 v192, 16, v53
    v_and_b32 v193, s49, v53
    v_lshlrev_b32 v194, 16, v54
    v_and_b32 v195, s49, v54
    v_lshlrev_b32 v196, 16, v55
    v_and_b32 v197, s49, v55
    v_pk_fma_f32 v[200:201], v[190:191], v[154:155], v[200:201] op_sel_hi:[1,0,1]
    v_pk_fma_f32 v[202:203], v[192:193], v[154:155], v[202:203] op_sel_hi:[1,0,1]
    v_pk_fma_f32 v[204:205], v[194:195], v[154:155], v[204:205] op_sel_hi:[1,0,1]
    v_pk_fma_f32 v[206:207], v[196:197], v[154:155], v[206:207] op_sel_hi:[1,0,1]
    s_waitcnt vmcnt(17)
    v_lshlrev_b32 v190, 16, v56
    v_and_b32 v191, s49, v56
    v_lshlrev_b32 v192, 16, v57
    v_and_b32 v193, s49, v57
    v_lshlrev_b32 v194, 16, v58
    v_and_b32 v195, s49, v58
    v_lshlrev_b32 v196, 16, v59
    v_and_b32 v197, s49, v59
    v_pk_fma_f32 v[200:201], v[190:191], v[156:157], v[200:201] op_sel_hi:[1,0,1]
    v_pk_fma_f32 v[202:203], v[192:193], v[156:157], v[202:203] op_sel_hi:[1,0,1]
    v_pk_fma_f32 v[204:205], v[194:195], v[156:157], v[204:205] op_sel_hi:[1,0,1]
    v_pk_fma_f32 v[206:207], v[196:197], v[156:157], v[206:207] op_sel_hi:[1,0,1]
    s_waitcnt vmcnt(16)
    v_lshlrev_b32 v190, 16, v60
    v_and_b32 v191, s49, v60
    v_lshlrev_b32 v192, 16, v61
    v_and_b32 v193, s49, v61
    v_lshlrev_b32 v194, 16, v62
    v_and_b32 v195, s49, v62
    v_lshlrev_b32 v196, 16, v63
    v_and_b32 v197, s49, v63
    v_pk_fma_f32 v[200:201], v[190:191], v[158:159], v[200:201] op_sel_hi:[1,0,1]
    v_pk_fma_f32 v[202:203], v[192:193], v[158:159], v[202:203] op_sel_hi:[1,0,1]
    v_pk_fma_f32 v[204:205], v[194:195], v[158:159], v[204:205] op_sel_hi:[1,0,1]
    v_pk_fma_f32 v[206:207], v[196:197], v[158:159], v[206:207] op_sel_hi:[1,0,1]
    s_waitcnt vmcnt(15)
    v_lshlrev_b32 v190, 16, v64
    v_and_b32 v191, s49, v64
    v_lshlrev_b32 v192, 16, v65
    v_and_b32 v193, s49, v65
    v_lshlrev_b32 v194, 16, v66
    v_and_b32 v195, s49, v66
    v_lshlrev_b32 v196, 16, v67
    v_and_b32 v197, s49, v67
    v_pk_fma_f32 v[200:201], v[190:191], v[160:161], v[200:201] op_sel_hi:[1,0,1]
    v_pk_fma_f32 v[202:203], v[192:193], v[160:161], v[202:203] op_sel_hi:[1,0,1]
    v_pk_fma_f32 v[204:205], v[194:195], v[160:161], v[204:205] op_sel_hi:[1,0,1]
    v_pk_fma_f32 v[206:207], v[196:197], v[160:161], v[206:207] op_sel_hi:[1,0,1]
    s_waitcnt vmcnt(14)
    v_lshlrev_b32 v190, 16, v68
    v_and_b32 v191, s49, v68
    v_lshlrev_b32 v192, 16, v69
    v_and_b32 v193, s49, v69
    v_lshlrev_b32 v194, 16, v70
    v_and_b32 v195, s49, v70
    v_lshlrev_b32 v196, 16, v71
    v_and_b32 v197, s49, v71
    v_pk_fma_f32 v[200:201], v[190:191], v[162:163], v[200:201] op_sel_hi:[1,0,1]
    v_pk_fma_f32 v[202:203], v[192:193], v[162:163], v[202:203] op_sel_hi:[1,0,1]
    v_pk_fma_f32 v[204:205], v[194:195], v[162:163], v[204:205] op_sel_hi:[1,0,1]
    v_pk_fma_f32 v[206:207], v[196:197], v[162:163], v[206:207] op_sel_hi:[1,0,1]
    s_waitcnt vmcnt(13)
    v_lshlrev_b32 v190, 16, v72
    v_and_b32 v191, s49, v72
    v_lshlrev_b32 v192, 16, v73
    v_and_b32 v193, s49, v73
    v_lshlrev_b32 v194, 16, v74
    v_and_b32 v195, s49, v74
    v_lshlrev_b32 v196, 16, v75
    v_and_b32 v197, s49, v75
    v_pk_fma_f32 v[200:201], v[190:191], v[164:165], v[200:201] op_sel_hi:[1,0,1]
    v_pk_fma_f32 v[202:203], v[192:193], v[164:165], v[202:203] op_sel_hi:[1,0,1]
    v_pk_fma_f32 v[204:205], v[194:195], v[164:165], v[204:205] op_sel_hi:[1,0,1]
    v_pk_fma_f32 v[206:207], v[196:197], v[164:165], v[206:207] op_sel_hi:[1,0,1]
    s_waitcnt vmcnt(12)
    v_lshlrev_b32 v190, 16, v76
    v_and_b32 v191, s49, v76
    v_lshlrev_b32 v192, 16, v77
    v_and_b32 v193, s49, v77
    v_lshlrev_b32 v194, 16, v78
    v_and_b32 v195, s49, v78
    v_lshlrev_b32 v196, 16, v79
    v_and_b32 v197, s49, v79
    v_pk_fma_f32 v[200:201], v[190:191], v[166:167], v[200:201] op_sel_hi:[1,0,1]
    v_pk_fma_f32 v[202:203], v[192:193], v[166:167], v[202:203] op_sel_hi:[1,0,1]
    v_pk_fma_f32 v[204:205], v[194:195], v[166:167], v[204:205] op_sel_hi:[1,0,1]
    v_pk_fma_f32 v[206:207], v[196:197], v[166:167], v[206:207] op_sel_hi:[1,0,1]
    s_waitcnt vmcnt(11)
    v_lshlrev_b32 v190, 16, v80
    v_and_b32 v191, s49, v80
    v_lshlrev_b32 v192, 16, v81
    v_and_b32 v193, s49, v81
    v_lshlrev_b32 v194, 16, v82
    v_and_b32 v195, s49, v82
    v_lshlrev_b32 v196, 16, v83
    v_and_b32 v197, s49, v83
    v_pk_fma_f32 v[200:201], v[190:191], v[168:169], v[200:201] op_sel_hi:[1,0,1]
    v_pk_fma_f32 v[202:203], v[192:193], v[168:169], v[202:203] op_sel_hi:[1,0,1]
    v_pk_fma_f32 v[204:205], v[194:195], v[168:169], v[204:205] op_sel_hi:[1,0,1]
    v_pk_fma_f32 v[206:207], v[196:197], v[168:169], v[206:207] op_sel_hi:[1,0,1]
    s_waitcnt vmcnt(10)
    v_lshlrev_b32 v190, 16, v84
    v_and_b32 v191, s49, v84
    v_lshlrev_b32 v192, 16, v85
    v_and_b32 v193, s49, v85
    v_lshlrev_b32 v194, 16, v86
    v_and_b32 v195, s49, v86
    v_lshlrev_b32 v196, 16, v87
    v_and_b32 v197, s49, v87
    v_pk_fma_f32 v[200:201], v[190:191], v[170:171], v[200:201] op_sel_hi:[1,0,1]
    v_pk_fma_f32 v[202:203], v[192:193], v[170:171], v[202:203] op_sel_hi:[1,0,1]
    v_pk_fma_f32 v[204:205], v[194:195], v[170:171], v[204:205] op_sel_hi:[1,0,1]
    v_pk_fma_f32 v[206:207], v[196:197], v[170:171], v[206:207] op_sel_hi:[1,0,1]
    s_waitcnt vmcnt(9)
    v_lshlrev_b32 v190, 16, v88
    v_and_b32 v191, s49, v88
    v_lshlrev_b32 v192, 16, v89
    v_and_b32 v193, s49, v89
    v_lshlrev_b32 v194, 16, v90
    v_and_b32 v195, s49, v90
    v_lshlrev_b32 v196, 16, v91
    v_and_b32 v197, s49, v91
    v_pk_fma_f32 v[200:201], v[190:191], v[172:173], v[200:201] op_sel_hi:[1,0,1]
    v_pk_fma_f32 v[202:203], v[192:193], v[172:173], v[202:203] op_sel_hi:[1,0,1]
    v_pk_fma_f32 v[204:205], v[194:195], v[172:173], v[204:205] op_sel_hi:[1,0,1]
    v_pk_fma_f32 v[206:207], v[196:197], v[172:173], v[206:207] op_sel_hi:[1,0,1]
    s_waitcnt vmcnt(8)
    v_lshlrev_b32 v190, 16, v92
    v_and_b32 v191, s49, v92
    v_lshlrev_b32 v192, 16, v93
    v_and_b32 v193, s49, v93
    v_lshlrev_b32 v194, 16, v94
    v_and_b32 v195, s49, v94
    v_lshlrev_b32 v196, 16, v95
    v_and_b32 v197, s49, v95
    v_pk_fma_f32 v[200:201], v[190:191], v[174:175], v[200:201] op_sel_hi:[1,0,1]
    v_pk_fma_f32 v[202:203], v[192:193], v[174:175], v[202:203] op_sel_hi:[1,0,1]
    v_pk_fma_f32 v[204:205], v[194:195], v[174:175], v[204:205] op_sel_hi:[1,0,1]
    v_pk_fma_f32 v[206:207], v[196:197], v[174:175], v[206:207] op_sel_hi:[1,0,1]
    s_waitcnt vmcnt(7)
    v_lshlrev_b32 v190, 16, v96
    v_and_b32 v191, s49, v96
    v_lshlrev_b32 v192, 16, v97
    v_and_b32 v193, s49, v97
    v_lshlrev_b32 v194, 16, v98
    v_and_b32 v195, s49, v98
    v_lshlrev_b32 v196, 16, v99
    v_and_b32 v197, s49, v99
    v_pk_fma_f32 v[200:201], v[190:191], v[176:177], v[200:201] op_sel_hi:[1,0,1]
    v_pk_fma_f32 v[202:203], v[192:193], v[176:177], v[202:203] op_sel_hi:[1,0,1]
    v_pk_fma_f32 v[204:205], v[194:195], v[176:177], v[204:205] op_sel_hi:[1,0,1]
    v_pk_fma_f32 v[206:207], v[196:197], v[176:177], v[206:207] op_sel_hi:[1,0,1]
    s_waitcnt vmcnt(6)
    v_lshlrev_b32 v190, 16, v100
    v_and_b32 v191, s49, v100
    v_lshlrev_b32 v192, 16, v101
    v_and_b32 v193, s49, v101
    v_lshlrev_b32 v194, 16, v102
    v_and_b32 v195, s49, v102
    v_lshlrev_b32 v196, 16, v103
    v_and_b32 v197, s49, v103
    v_pk_fma_f32 v[200:201], v[190:191], v[178:179], v[200:201] op_sel_hi:[1,0,1]
    v_pk_fma_f32 v[202:203], v[192:193], v[178:179], v[202:203] op_sel_hi:[1,0,1]
    v_pk_fma_f32 v[204:205], v[194:195], v[178:179], v[204:205] op_sel_hi:[1,0,1]
    v_pk_fma_f32 v[206:207], v[196:197], v[178:179], v[206:207] op_sel_hi:[1,0,1]
    s_waitcnt vmcnt(5)
    v_lshlrev_b32 v190, 16, v104
    v_and_b32 v191, s49, v104
    v_lshlrev_b32 v192, 16, v105
    v_and_b32 v193, s49, v105
    v_lshlrev_b32 v194, 16, v106
    v_and_b32 v195, s49, v106
    v_lshlrev_b32 v196, 16, v107
    v_and_b32 v197, s49, v107
    v_pk_fma_f32 v[200:201], v[190:191], v[180:181], v[200:201] op_sel_hi:[1,0,1]
    v_pk_fma_f32 v[202:203], v[192:193], v[180:181], v[202:203] op_sel_hi:[1,0,1]
    v_pk_fma_f32 v[204:205], v[194:195], v[180:181], v[204:205] op_sel_hi:[1,0,1]
    v_pk_fma_f32 v[206:207], v[196:197], v[180:181], v[206:207] op_sel_hi:[1,0,1]
    s_waitcnt vmcnt(4)
    v_lshlrev_b32 v190, 16, v108
    v_and_b32 v191, s49, v108
    v_lshlrev_b32 v192, 16, v109
    v_and_b32 v193, s49, v109
    v_lshlrev_b32 v194, 16, v110
    v_and_b32 v195, s49, v110
    v_lshlrev_b32 v196, 16, v111
    v_and_b32 v197, s49, v111
    v_pk_fma_f32 v[200:201], v[190:191], v[182:183], v[200:201] op_sel_hi:[1,0,1]
    v_pk_fma_f32 v[202:203], v[192:193], v[182:183], v[202:203] op_sel_hi:[1,0,1]
    v_pk_fma_f32 v[204:205], v[194:195], v[182:183], v[204:205] op_sel_hi:[1,0,1]
    v_pk_fma_f32 v[206:207], v[196:197], v[182:183], v[206:207] op_sel_hi:[1,0,1]
    s_waitcnt vmcnt(3)
    v_lshlrev_b32 v190, 16, v112
    v_and_b32 v191, s49, v112
    v_lshlrev_b32 v192, 16, v113
    v_and_b32 v193, s49, v113
    v_lshlrev_b32 v194, 16, v114
    v_and_b32 v195, s49, v114
    v_lshlrev_b32 v196, 16, v115
    v_and_b32 v197, s49, v115
    v_pk_fma_f32 v[200:201], v[190:191], v[184:185], v[200:201] op_sel_hi:[1,0,1]
    v_pk_fma_f32 v[202:203], v[192:193], v[184:185], v[202:203] op_sel_hi:[1,0,1]
    v_pk_fma_f32 v[204:205], v[194:195], v[184:185], v[204:205] op_sel_hi:[1,0,1]
    v_pk_fma_f32 v[206:207], v[196:197], v[184:185], v[206:207] op_sel_hi:[1,0,1]
    s_mov_b32 exec_hi, 0x7fffffff
    ds_write_b128 v11, v[200:203]
    ds_write_b128 v11, v[204:207] offset:16
    s_mov_b32 exec_hi, -1
    s_waitcnt lgkmcnt(0)
    s_barrier
    s_cmp_ge_u32 s3, 2
    s_cbranch_scc1 L1_exit
    v_lshlrev_b32 v4, 2, v0
    ds_read_b32 v32, v4 offset:0
    ds_read_b32 v33, v4 offset:288
    ds_read_b32 v34, v4 offset:576
    ds_read_b32 v35, v4 offset:864
    ds_read_b32 v36, v4 offset:1152
    ds_read_b32 v37, v4 offset:1440
    ds_read_b32 v38, v4 offset:1728
    ds_read_b32 v39, v4 offset:2016
    ds_read_b32 v40, v4 offset:2304
    ds_read_b32 v41, v4 offset:2592
    ds_read_b32 v42, v4 offset:2880
    ds_read_b32 v43, v4 offset:3168
    ds_read_b32 v44, v4 offset:3456
    ds_read_b32 v45, v4 offset:3744
    s_waitcnt lgkmcnt(0)
    ds_read_b32 v46, v4 offset:4032
    ds_read_b32 v47, v4 offset:4320
    ds_read_b32 v48, v4 offset:4608
    ds_read_b32 v49, v4 offset:4896
    ds_read_b32 v50, v4 offset:5184
    ds_read_b32 v51, v4 offset:5472
    ds_read_b32 v52, v4 offset:5760
    ds_read_b32 v53, v4 offset:6048
    ds_read_b32 v54, v4 offset:6336
    ds_read_b32 v55, v4 offset:6624
    ds_read_b32 v56, v4 offset:6912
    ds_read_b32 v57, v4 offset:7200
    ds_read_b32 v58, v4 offset:7488
    ds_read_b32 v59, v4 offset:7776
    s_mul_i32 s28, s28, 72
    s_add_u32 s28, s28, 1152
    v_add_u32 v3, s28, v0
    v_lshrrev_b32 v5, 6, v3
    v_mul_u32_u24 v5, 7282, v5
    v_lshrrev_b32 v5, 16, v5
    v_cmp_eq_u32 s[30:31], 4, v5
    v_subrev_u32 v6, 2304, v3
    v_subrev_u32 v7, 1152, v3
    v_cndmask_b32 v6, v7, v6, s[30:31]
    v_lshlrev_b32 v6, 1, v6
    v_cmp_eq_u32 vcc, 3, v5
    s_nop 0
    s_or_b64 vcc, vcc, s[30:31]
    v_cndmask_b32 v6, v8, v6, vcc
    v_lshlrev_b32 v4, 2, v3
    v_cmp_gt_u32 vcc, 72, v0
    s_nop 1
    v_cndmask_b32 v6, v8, v6, vcc
    v_cndmask_b32 v4, v8, v4, vcc
    s_waitcnt lgkmcnt(0)
    v_pk_add_f32 v[32:33], v[32:33], v[46:47]
    v_pk_add_f32 v[34:35], v[34:35], v[48:49]
    v_pk_add_f32 v[36:37], v[36:37], v[50:51]
    v_pk_add_f32 v[38:39], v[38:39], v[52:53]
    v_pk_add_f32 v[40:41], v[40:41], v[54:55]
    v_pk_add_f32 v[42:43], v[42:43], v[56:57]
    v_pk_add_f32 v[44:45], v[44:45], v[58:59]
    v_pk_add_f32 v[32:33], v[32:33], v[34:35]
    v_pk_add_f32 v[32:33], v[32:33], v[36:37]
    v_pk_add_f32 v[32:33], v[32:33], v[38:39]
    v_pk_add_f32 v[32:33], v[32:33], v[40:41]
    v_pk_add_f32 v[32:33], v[32:33], v[42:43]
    v_pk_add_f32 v[32:33], v[32:33], v[44:45]
    v_add_f32 v12, v32, v33
    v_cvt_pk_bf16_f32 v12, v12, v12
    v_and_b32 v12, s49, v12
    v_add_f32 v13, 1.0, v12
    v_cvt_pk_bf16_f32 v13, v13, v13
    v_and_b32 v13, s49, v13
    v_cndmask_b32 v12, v12, v13, s[30:31]
    buffer_store_dword v12, v4, s[40:43], 0 offen
    v_lshrrev_b32 v13, 16, v12
    buffer_store_short v13, v6, s[44:47], 0 offen
L1_exit:
    s_endpgm
.text
.globl k2_kernel
.p2align 8
.type k2_kernel,@function
k2_kernel:
    s_cmp_ge_u32 s2, 256
    s_cbranch_scc1 L2_exit
    s_load_dwordx16 s[4:19], s[0:1], 0
    s_load_dwordx8 s[20:27], s[0:1], 64
    v_lshrrev_b32 v1, 6, v0
    s_nop 0
    v_readfirstlane_b32 s3, v1
    s_and_b32 s28, s2, 7
    s_lshl_b32 s28, s28, 2
    s_bfe_u32 s29, s2, 0x20003
    s_add_u32 s28, s28, s29
    s_lshr_b32 s29, s2, 5
    s_lshl_b32 s29, s29, 3
    s_and_b32 s30, s3, 3
    s_lshl_b32 s30, s30, 1
    s_add_u32 s29, s29, s30
    s_lshr_b32 s30, s3, 2
    v_and_b32 v1, 63, v0
    v_lshlrev_b32 v2, 4, v1
    v_lshlrev_b32 v3, 2, v1
    s_mul_i32 s48, s28, 155648
    s_add_u32 s48, s48, 13631488
    s_waitcnt lgkmcnt(0)
    s_add_u32 s40, s26, s48
    s_addc_u32 s41, s27, 0
    s_mov_b32 s42, 155648
    s_mov_b32 s43, 0x20000
    s_lshl_b32 m0, s3, 10
    s_movk_i32 s25, 8192
    buffer_load_dwordx4 v2, s[40:43], m0 offen lds
    s_add_u32 m0, m0, s25
    s_nop 0
    buffer_load_dwordx4 v2, s[40:43], m0 offen lds
    s_add_u32 m0, m0, s25
    s_nop 0
    buffer_load_dwordx4 v2, s[40:43], m0 offen lds
    s_add_u32 m0, m0, s25
    s_add_u32 s32, s26, 0xa00000
    s_addc_u32 s33, s27, 0
    s_mov_b32 s34, 0x200000
    s_mov_b32 s35, 0x20000
    s_add_u32 s36, s26, 0xc00000
    s_addc_u32 s37, s27, 0
    s_mov_b32 s38, 0x40000
    s_mov_b32 s39, 0x20000
    s_add_u32 s44, s26, 0x1200000
    s_addc_u32 s45, s27, 0
    s_mov_b32 s46, 0x240000
    s_mov_b32 s47, 0x20000
    s_lshl_b32 s48, s28, 16
    s_lshl_b32 s50, s29, 10
    s_add_u32 s48, s48, s50
    buffer_load_dwordx4 v[16:19], v2, s[32:35], s48 offen
    buffer_load_dwordx4 v[20:23], v2, s[32:35], s48 offen offset:1024
    s_lshl_b32 s48, s28, 13
    s_lshl_b32 s50, s29, 7
    s_add_u32 s48, s48, s50
    buffer_load_dword v24, v3, s[36:39], s48 offen
    buffer_load_dwordx4 v2, s[40:43], m0 offen lds
    s_add_u32 m0, m0, s25
    s_nop 0
    buffer_load_dwordx4 v2, s[40:43], m0 offen lds
    s_add_u32 m0, m0, s25
    v_mov_b32 v228, 0
    v_mov_b32 v229, 0
    v_mov_b32 v230, 0
    v_mov_b32 v231, 0
    s_lshl_b32 s50, s30, 12
    v_add_u32 v7, s50, v2
    v_and_b32 v12, 31, v1
    v_lshlrev_b32 v13, 2, v12
    s_lshl_b32 s50, s30, 9
    s_add_u32 s50, s50, 8192
    v_add_u32 v8, s50, v13
    v_cmp_eq_u32 vcc, 22, v12
    v_min_u32 v12, 19, v12
    v_mov_b32 v14, 18
    v_cndmask_b32 v12, v12, v14, vcc
    v_lshlrev_b32 v12, 4, v12
    v_lshrrev_b32 v14, 5, v1
    v_mul_u32_u24 v14, 320, v14
    v_add_u32 v12, v12, v14
    s_mul_i32 s50, s30, 5120
    s_add_u32 s50, s50, 9216
    v_add_u32 v9, s50, v12
    v_mov_b32 v25, 0
    v_mov_b32 v27, 0
    v_mov_b32 v29, 0
    v_mov_b32 v14, 155648
    v_mov_b32 v15, 0
    ds_write_b32 v14, v15
    s_mov_b32 s51, 0
    v_mov_b32 v168, 0
    v_mov_b32 v169, 0
    v_mov_b32 v170, 0
    v_mov_b32 v171, 0
    v_mov_b32 v172, 0
    v_mov_b32 v173, 0
    v_mov_b32 v174, 0
    v_mov_b32 v175, 0
    v_mov_b32 v176, 0
    v_mov_b32 v177, 0
    v_mov_b32 v178, 0
    v_mov_b32 v179, 0
    v_mov_b32 v180, 0
    v_mov_b32 v181, 0
    v_mov_b32 v182, 0
    v_mov_b32 v183, 0
    v_mov_b32 v184, 0
    v_mov_b32 v185, 0
    v_mov_b32 v186, 0
    v_mov_b32 v187, 0
    v_mov_b32 v188, 0
    v_mov_b32 v189, 0
    v_mov_b32 v190, 0
    v_mov_b32 v191, 0
    v_mov_b32 v192, 0
    v_mov_b32 v193, 0
    v_mov_b32 v194, 0
    v_mov_b32 v195, 0
    v_mov_b32 v196, 0
    v_mov_b32 v197, 0
    v_mov_b32 v198, 0
    v_mov_b32 v199, 0
    v_mov_b32 v68, 0
    v_mov_b32 v52, 0
    v_mov_b32 v69, 0
    v_mov_b32 v53, 0
    v_mov_b32 v70, 0
    v_mov_b32 v54, 0
    v_mov_b32 v71, 0
    v_mov_b32 v55, 0
    v_mov_b32 v4, v7
    v_mov_b32 v5, v8
    v_mov_b32 v6, v9
    s_waitcnt vmcnt(2)
    s_waitcnt lgkmcnt(0)
    s_barrier
    ds_read_b128 v[36:39], v2
    ds_read_b32 v28, v13 offset:8192
    s_waitcnt lgkmcnt(0)
    v_mfma_f32_32x32x4_2b_bf16 v[104:135], v[28:29], v[24:25], 0
    s_add_u32 s60, s26, 0x400000
    s_addc_u32 s61, s27, 0
    s_mov_b32 s62, 0x5048000
    s_mov_b32 s63, 0x20000
    s_add_u32 s96, s26, 0x8000
    s_addc_u32 s97, s27, 0
    s_mov_b32 s98, 0x900
    s_mov_b32 s99, 0x20000
    v_and_b32 v12, 15, v1
    v_lshrrev_b32 v13, 4, v1
    v_mov_b32 v235, 0x40000000
    v_mov_b32 v236, 0x40000000
    s_mov_b32 s6, 2359296
    s_mov_b32 s7, 0x20000
    s_and_b32 s52, s3, 3
    s_mov_b32 s22, 0x40608080
    s_mov_b32 s23, 0x80e1828
    s_lshl_b32 s58, s30, 8
    s_add_u32 s58, s58, s2
    s_cmp_ge_u32 s58, 288
    s_cbranch_scc1 L2_jb
    s_and_b32 s53, s58, 1
    s_bfe_u32 s59, s58, 0x10001
    s_and_b32 s54, s58, 0xfffffffc
    s_add_u32 s54, s54, s52
    s_cmp_eq_u32 s53, 0
    s_cselect_b32 s64, s12, s14
    s_cselect_b32 s65, s13, s15
    s_mov_b32 s66, 5308416
    s_mov_b32 s67, 0x20000
    s_mov_b32 s8, 0
    s_mov_b32 s9, 9216
    s_mov_b32 s10, 18432
    s_mov_b32 s11, 27648
    s_mov_b32 s12, 36864
    s_mov_b32 s13, 46080
    s_mov_b32 s14, 55296
    s_mov_b32 s15, 64512
    v_mul_u32_u24 v232, 73728, v13
    v_lshl_add_u32 v232, v12, 1, v232
    v_mov_b32 v233, v232
    s_mul_i32 s16, s59, 2654208
    s_lshl_b32 s55, s54, 5
    s_add_u32 s18, s16, s55
    s_mov_b32 s17, 294912
    s_mul_i32 s19, s54, 36864
    s_mul_i32 s55, s53, 18432
    s_add_u32 s19, s19, s55
    s_mul_i32 s55, s59, 9216
    s_add_u32 s19, s19, s55
    s_add_u32 s19, s19, 20971520
    s_mul_i32 s20, s59, 576
    s_lshl_b32 s21, s54, 10
    s_lshl_b32 s55, s53, 9
    s_add_u32 s21, s21, s55
    s_lshl_b32 s55, s59, 8
    s_add_u32 s21, s21, s55
    s_add_u32 s21, s21, 83886080
    v_mul_u32_u24 v14, 1152, v12
    v_lshl_add_u32 v14, v13, 4, v14
    v_cmp_gt_u32 vcc, 2, v12
    s_nop 1
    v_cndmask_b32 v235, v235, v14, vcc
    s_mov_b32 s31, 0
    s_branch L2_jdone
L2_jb:
    s_cmp_ge_u32 s2, 176
    s_cbranch_scc1 L2_jd
    s_mov_b32 s64, s16
    s_mov_b32 s65, s17
    s_mov_b32 s66, 0x510000
    s_mov_b32 s67, 0x20000
    s_sub_u32 s53, s2, 32
    s_mul_i32 s54, s53, 1821
    s_lshr_b32 s54, s54, 16
    s_mul_i32 s55, s54, 36
    s_sub_u32 s55, s53, s55
    s_lshl_b32 s54, s54, 2
    s_sub_u32 s56, s55, 4
    s_mul_i32 s57, s56, 0x5556
    s_lshr_b32 s57, s57, 16
    s_mul_i32 s58, s57, 3
    s_sub_u32 s58, s56, s58
    s_sub_u32 s59, s55, 28
    s_cmp_ge_u32 s55, 28
    s_cselect_b32 s57, s59, s57
    s_cselect_b32 s58, 3, s58
    s_mul_i32 s57, s57, 144
    s_lshl_b32 s58, s58, 5
    s_add_u32 s56, s57, s58
    s_add_u32 s56, s56, 16
    s_mul_i32 s59, s55, 288
    s_cmp_lt_u32 s55, 4
    s_cselect_b32 s56, s59, s56
    s_cselect_b32 s57, 9, 1
    s_mul_i32 s57, s57, 18432
    s_mul_i32 s54, s54, 288
    s_add_u32 s54, s54, s56
    s_mul_i32 s16, s54, 1152
    s_mul_i32 s55, s52, 288
    s_add_u32 s18, s16, s55
    s_mov_b32 s8, 0
    s_add_u32 s12, s57, 0
    s_mov_b32 s9, 1152
    s_add_u32 s13, s57, 1152
    s_mov_b32 s10, 2304
    s_add_u32 s14, s57, 2304
    s_mov_b32 s11, 3456
    s_add_u32 s15, s57, 3456
    v_mul_u32_u24 v14, 4608, v13
    v_lshl_add_u32 v233, v12, 1, v14
    v_lshrrev_b32 v15, 2, v12
    v_lshlrev_b32 v15, 3, v15
    v_and_b32 v12, 3, v12
    v_add_u32 v15, v15, v12
    v_lshl_add_u32 v232, v15, 1, v14
    s_mov_b32 s17, 8
    s_cmp_eq_u32 s52, 0
    s_cselect_b32 s22, 0x1220080, s22
    s_cselect_b32 s23, 0x20326089, s23
    s_cmp_eq_u32 s52, 1
    s_cselect_b32 s22, 0xc3a70080, s22
    s_cselect_b32 s23, 0x82a5068, s23
    s_cmp_eq_u32 s52, 2
    s_cselect_b32 s22, 0x83260080, s22
    s_cselect_b32 s23, 0x20224048, s23
    s_cmp_eq_u32 s52, 3
    s_cselect_b32 s22, 0x43a70a94, s22
    s_cselect_b32 s23, 0x1a3028, s23
    s_mul_i32 s19, s52, 1327104
    s_mul_i32 s55, s53, 9216
    s_add_u32 s19, s19, s55
    s_add_u32 s19, s19, 32505856
    s_mov_b32 s20, 0
    s_mov_b32 s21, 0
    s_mov_b32 s31, 1
    s_branch L2_jdone
L2_jd:
    s_mov_b32 s64, s4
    s_mov_b32 s65, s5
    s_mov_b32 s66, 0x0
    s_mov_b32 s67, 0x20000
    s_mov_b32 s8, 0
    s_mov_b32 s9, 0
    s_mov_b32 s10, 0
    s_mov_b32 s11, 0
    s_mov_b32 s12, 0
    s_mov_b32 s13, 0
    s_mov_b32 s14, 0
    s_mov_b32 s15, 0
    s_sub_u32 s53, s2, 176
    v_and_b32 v12, 31, v1
    v_mul_u32_u24 v12, 1152, v12
    v_lshrrev_b32 v13, 5, v1
    v_lshl_add_u32 v236, v13, 4, v12
    v_mov_b32 v232, 0
    v_mov_b32 v233, 0
    s_mul_i32 s16, s53, 36864
    s_mul_i32 s55, s52, 288
    s_add_u32 s18, s16, s55
    s_mov_b32 s17, 32
    s_mul_i32 s19, s53, 36864
    s_mul_i32 s55, s52, 9216
    s_add_u32 s19, s19, s55
    s_mov_b32 s20, 0
    s_mov_b32 s21, 0
    s_mov_b32 s31, 2
    s_cmp_ge_u32 s2, 240
    s_cselect_b32 s19, 0x40000000, s19
    s_cselect_b32 s6, 0, s6
L2_jdone:
    v_mfma_f32_32x32x16_bf16 v[104:119], v[36:39], v[16:19], v[104:119]
    v_mfma_f32_32x32x16_bf16 v[120:135], v[36:39], v[20:23], v[120:135]
    s_and_b32 s16, s22, 127
    s_mul_i32 s16, s16, s17
    s_add_u32 s16, s16, s18
    v_add_u32 v234, s16, v232
    buffer_load_short_d16 v208, v234, s[64:67], s8 offen
    buffer_load_short_d16_hi v209, v234, s[64:67], s9 offen
    buffer_load_short_d16 v210, v234, s[64:67], s10 offen
    s_nop 3
    v_max3_f32 v10, v104, v105, v106
    v_max_f32 v10, v10, v119
    v_max3_f32 v10, v10, v107, v108
    v_max3_f32 v10, v10, v109, v110
    v_max3_f32 v10, v10, v111, v112
    v_max3_f32 v10, v10, v113, v114
    v_max3_f32 v10, v10, v115, v116
    v_max3_f32 v10, v10, v117, v118
    buffer_load_short_d16_hi v211, v234, s[64:67], s11 offen
    buffer_load_short_d16 v212, v234, s[64:67], s12 offen
    v_max3_f32 v11, v120, v121, v122
    v_max_f32 v11, v11, v135
    v_max3_f32 v11, v11, v123, v124
    v_max3_f32 v11, v11, v125, v126
    v_max3_f32 v11, v11, v127, v128
    v_max3_f32 v11, v11, v129, v130
    v_max3_f32 v11, v11, v131, v132
    v_max3_f32 v11, v11, v133, v134
    buffer_load_short_d16_hi v213, v234, s[64:67], s13 offen
    buffer_load_short_d16 v214, v234, s[64:67], s14 offen
    v_mov_b32 v200, v10
    s_nop 1
    v_permlane32_swap_b32 v200, v10
    v_max_f32 v10, v10, v200
    buffer_load_short_d16_hi v215, v234, s[64:67], s15 offen
    v_mov_b32 v200, v11
    s_nop 1
    v_permlane32_swap_b32 v200, v11
    v_max_f32 v11, v11, v200
    buffer_load_dwordx4 v[216:219], v235, s[96:99], s20 offen
    s_add_u32 s20, s20, 64
    buffer_load_dwordx4 v[220:223], v236, s[4:7], s16 offen
    s_lshr_b64 s[22:23], s[22:23], 7
    s_mov_b64 vcc, -1
L2_start:
    ds_read_b32 v26, v5 offset:0
    ds_read_b128 v[32:35], v4 offset:0
    ds_read_b32 v28, v5 offset:128
    ds_read_b128 v[36:39], v4 offset:1024
    ds_read_b128 v[40:43], v6 offset:0
    ds_read_b128 v[44:47], v6 offset:640
    v_sub_f32 v72, 0, v10
    v_sub_f32 v88, 0, v11
    v_sub_f32 v73, 0, v10
    v_sub_f32 v89, 0, v11
    v_sub_f32 v74, 0, v10
    v_sub_f32 v90, 0, v11
    v_sub_f32 v75, 0, v10
    v_sub_f32 v91, 0, v11
    v_sub_f32 v76, 0, v10
    v_sub_f32 v92, 0, v11
    v_sub_f32 v77, 0, v10
    v_sub_f32 v93, 0, v11
    v_sub_f32 v78, 0, v10
    v_sub_f32 v94, 0, v11
    v_sub_f32 v79, 0, v10
    v_sub_f32 v95, 0, v11
    v_sub_f32 v80, 0, v10
    v_sub_f32 v96, 0, v11
    v_sub_f32 v81, 0, v10
    v_sub_f32 v97, 0, v11
    v_sub_f32 v82, 0, v10
    v_sub_f32 v98, 0, v11
    v_sub_f32 v83, 0, v10
    v_sub_f32 v99, 0, v11
    v_sub_f32 v84, 0, v10
    v_sub_f32 v100, 0, v11
    v_sub_f32 v85, 0, v10
    v_sub_f32 v101, 0, v11
    v_sub_f32 v86, 0, v10
    v_sub_f32 v102, 0, v11
    v_sub_f32 v87, 0, v10
    v_sub_f32 v103, 0, v11
    s_waitcnt lgkmcnt(0)
    s_nop 0
    v_mfma_f32_32x32x4_2b_bf16 v[104:135], v[26:27], v[24:25], v[72:103]
    s_nop 15
    s_nop 1
    v_mfma_f32_32x32x16_bf16 v[104:119], v[32:35], v[16:19], v[104:119]
    v_mfma_f32_32x32x16_bf16 v[120:135], v[32:35], v[20:23], v[120:135]
    s_mov_b32 s52, 0
    s_setprio 2
    s_nop 8
.p2align 3
L2_loop:
    s_waitcnt lgkmcnt(0)
    v_mfma_f32_32x32x4_2b_bf16 v[136:167], v[28:29], v[24:25], v[72:103]
    v_exp_f32 v104, v104
    v_exp_f32 v105, v105
    v_exp_f32 v106, v106
    v_exp_f32 v107, v107
    v_cvt_pk_bf16_f32 v56, v104, v105
    v_cvt_pk_bf16_f32 v57, v106, v107
    v_exp_f32 v108, v108
    v_exp_f32 v109, v109
    v_exp_f32 v110, v110
    v_exp_f32 v111, v111
    v_cvt_pk_bf16_f32 v58, v108, v109
    v_cvt_pk_bf16_f32 v59, v110, v111
    s_setprio 1
    s_cbranch_vccnz L2_nofin
    s_waitcnt vmcnt(13)
    v_or3_b32 v224, v240, v241, v252
    v_or3_b32 v225, v242, v243, v253
    v_or3_b32 v226, v244, v245, v254
    v_or3_b32 v227, v246, v247, v255
    buffer_store_dwordx4 v[224:227], v2, s[60:63], s19 offen sc1
    s_add_u32 s19, s19, 1024
    v_mfma_f32_16x16x32_bf16 v[228:231], v[248:251], v[224:227], v[228:231]
L2_nofin:
    v_mfma_f32_32x32x16_bf16 v[184:199], v[52:55], v[68:71], v[184:199]
    s_and_b32 s16, s22, 127
    s_mul_i32 s16, s16, s17
    s_add_u32 s16, s16, s18
    v_add_u32 v234, s16, v232
    buffer_load_short_d16 v240, v234, s[64:67], s8 offen
    v_exp_f32 v112, v112
    v_exp_f32 v113, v113
    v_exp_f32 v114, v114
    v_exp_f32 v115, v115
    v_cvt_pk_bf16_f32 v60, v112, v113
    v_cvt_pk_bf16_f32 v61, v114, v115
    v_mfma_f32_32x32x16_bf16 v[168:183], v[40:43], v[56:59], v[168:183]
    buffer_load_short_d16_hi v241, v234, s[64:67], s9 offen
    ds_read_b128 v[48:51], v6 offset:1280
    v_exp_f32 v116, v116
    v_exp_f32 v117, v117
    v_exp_f32 v118, v118
    v_exp_f32 v119, v119
    v_cvt_pk_bf16_f32 v62, v116, v117
    v_cvt_pk_bf16_f32 v63, v118, v119
    v_mfma_f32_32x32x16_bf16 v[136:151], v[36:39], v[16:19], v[136:151]
    buffer_load_short_d16 v242, v234, s[64:67], s10 offen
    ds_read_b128 v[52:55], v6 offset:1920
    v_exp_f32 v120, v120
    v_exp_f32 v121, v121
    v_exp_f32 v122, v122
    v_exp_f32 v123, v123
    v_cvt_pk_bf16_f32 v64, v120, v121
    v_cvt_pk_bf16_f32 v65, v122, v123
    v_mfma_f32_32x32x16_bf16 v[168:183], v[44:47], v[60:63], v[168:183]
    buffer_load_short_d16_hi v243, v234, s[64:67], s11 offen
    ds_read_b32 v26, v5 offset:256
    v_exp_f32 v124, v124
    v_exp_f32 v125, v125
    v_exp_f32 v126, v126
    v_exp_f32 v127, v127
    v_cvt_pk_bf16_f32 v66, v124, v125
    v_cvt_pk_bf16_f32 v67, v126, v127
    v_mfma_f32_32x32x16_bf16 v[152:167], v[36:39], v[20:23], v[152:167]
    buffer_load_short_d16 v244, v234, s[64:67], s12 offen
    ds_read_b128 v[32:35], v4 offset:2048
    v_exp_f32 v128, v128
    v_exp_f32 v129, v129
    v_exp_f32 v130, v130
    v_exp_f32 v131, v131
    v_cvt_pk_bf16_f32 v68, v128, v129
    v_cvt_pk_bf16_f32 v69, v130, v131
    v_mfma_f32_32x32x16_bf16 v[184:199], v[40:43], v[64:67], v[184:199]
    buffer_load_short_d16_hi v245, v234, s[64:67], s13 offen
    v_exp_f32 v132, v132
    v_exp_f32 v133, v133
    v_exp_f32 v134, v134
    v_exp_f32 v135, v135
    v_cvt_pk_bf16_f32 v70, v132, v133
    v_cvt_pk_bf16_f32 v71, v134, v135
    s_waitcnt lgkmcnt(0)
    v_mfma_f32_32x32x4_2b_bf16 v[104:135], v[26:27], v[24:25], v[72:103]
    v_exp_f32 v136, v136
    v_exp_f32 v137, v137
    v_exp_f32 v138, v138
    v_exp_f32 v139, v139
    v_cvt_pk_bf16_f32 v56, v136, v137
    v_cvt_pk_bf16_f32 v57, v138, v139
    v_exp_f32 v140, v140
    v_exp_f32 v141, v141
    v_exp_f32 v142, v142
    v_exp_f32 v143, v143
    v_cvt_pk_bf16_f32 v58, v140, v141
    v_cvt_pk_bf16_f32 v59, v142, v143
    s_setprio 0
    v_mfma_f32_32x32x16_bf16 v[184:199], v[44:47], v[68:71], v[184:199]
    buffer_load_short_d16 v246, v234, s[64:67], s14 offen
    v_exp_f32 v144, v144
    v_exp_f32 v145, v145
    v_exp_f32 v146, v146
    v_exp_f32 v147, v147
    v_cvt_pk_bf16_f32 v60, v144, v145
    v_cvt_pk_bf16_f32 v61, v146, v147
    v_mfma_f32_32x32x16_bf16 v[168:183], v[48:51], v[56:59], v[168:183]
    buffer_load_short_d16_hi v247, v234, s[64:67], s15 offen
    ds_read_b128 v[40:43], v6 offset:2560
    v_exp_f32 v148, v148
    v_exp_f32 v149, v149
    v_exp_f32 v150, v150
    v_exp_f32 v151, v151
    v_cvt_pk_bf16_f32 v62, v148, v149
    v_cvt_pk_bf16_f32 v63, v150, v151
    v_mfma_f32_32x32x16_bf16 v[104:119], v[32:35], v[16:19], v[104:119]
    buffer_load_dwordx4 v[248:251], v235, s[96:99], s20 offen
    s_add_u32 s20, s20, 64
    ds_read_b128 v[44:47], v6 offset:3200
    v_exp_f32 v152, v152
    v_exp_f32 v153, v153
    v_exp_f32 v154, v154
    v_exp_f32 v155, v155
    v_cvt_pk_bf16_f32 v64, v152, v153
    v_cvt_pk_bf16_f32 v65, v154, v155
    v_mfma_f32_32x32x16_bf16 v[168:183], v[52:55], v[60:63], v[168:183]
    buffer_load_dwordx4 v[252:255], v236, s[4:7], s16 offen
    s_lshr_b64 s[22:23], s[22:23], 7
    ds_read_b32 v28, v5 offset:384
    v_exp_f32 v156, v156
    v_exp_f32 v157, v157
    v_exp_f32 v158, v158
    v_exp_f32 v159, v159
    v_cvt_pk_bf16_f32 v66, v156, v157
    v_cvt_pk_bf16_f32 v67, v158, v159
    v_mfma_f32_32x32x16_bf16 v[120:135], v[32:35], v[20:23], v[120:135]
    ds_read_b128 v[36:39], v4 offset:3072
    v_exp_f32 v160, v160
    v_exp_f32 v161, v161
    v_exp_f32 v162, v162
    v_exp_f32 v163, v163
    v_cvt_pk_bf16_f32 v68, v160, v161
    v_cvt_pk_bf16_f32 v69, v162, v163
    v_mfma_f32_32x32x16_bf16 v[184:199], v[48:51], v[64:67], v[184:199]
    v_exp_f32 v164, v164
    v_exp_f32 v165, v165
    v_exp_f32 v166, v166
    v_exp_f32 v167, v167
    v_cvt_pk_bf16_f32 v70, v164, v165
    v_cvt_pk_bf16_f32 v71, v166, v167
    s_waitcnt lgkmcnt(0)
    v_mfma_f32_32x32x4_2b_bf16 v[136:167], v[28:29], v[24:25], v[72:103]
    v_exp_f32 v104, v104
    v_exp_f32 v105, v105
    v_exp_f32 v106, v106
    v_exp_f32 v107, v107
    v_cvt_pk_bf16_f32 v56, v104, v105
    v_cvt_pk_bf16_f32 v57, v106, v107
    v_exp_f32 v108, v108
    v_exp_f32 v109, v109
    v_exp_f32 v110, v110
    v_exp_f32 v111, v111
    v_cvt_pk_bf16_f32 v58, v108, v109
    v_cvt_pk_bf16_f32 v59, v110, v111
    s_cbranch_vccnz L2_w20
    s_waitcnt vmcnt(11)
L2_w20:
    s_waitcnt vmcnt(20)
    s_mov_b64 vcc, 0
    s_barrier
    s_setprio 3
    v_mfma_f32_32x32x16_bf16 v[184:199], v[52:55], v[68:71], v[184:199]
    buffer_load_dwordx4 v2, s[40:43], m0 offen lds
    s_add_u32 m0, m0, s25
    v_exp_f32 v112, v112
    v_exp_f32 v113, v113
    v_exp_f32 v114, v114
    v_exp_f32 v115, v115
    v_cvt_pk_bf16_f32 v60, v112, v113
    v_cvt_pk_bf16_f32 v61, v114, v115
    v_mfma_f32_32x32x16_bf16 v[168:183], v[40:43], v[56:59], v[168:183]
    buffer_load_dwordx4 v2, s[40:43], m0 offen lds
    s_add_u32 m0, m0, s25
    ds_read_b128 v[48:51], v6 offset:3840
    v_exp_f32 v116, v116
    v_exp_f32 v117, v117
    v_exp_f32 v118, v118
    v_exp_f32 v119, v119
    v_cvt_pk_bf16_f32 v62, v116, v117
    v_cvt_pk_bf16_f32 v63, v118, v119
    v_mfma_f32_32x32x16_bf16 v[136:151], v[36:39], v[16:19], v[136:151]
    buffer_load_dwordx4 v2, s[40:43], m0 offen lds
    s_add_u32 m0, m0, s25
    ds_read_b128 v[52:55], v6 offset:4480
    v_exp_f32 v120, v120
    v_exp_f32 v121, v121
    v_exp_f32 v122, v122
    v_exp_f32 v123, v123
    v_cvt_pk_bf16_f32 v64, v120, v121
    v_cvt_pk_bf16_f32 v65, v122, v123
    v_mfma_f32_32x32x16_bf16 v[168:183], v[44:47], v[60:63], v[168:183]
    ds_read_b32 v26, v5 offset:19456
    v_exp_f32 v124, v124
    v_exp_f32 v125, v125
    v_exp_f32 v126, v126
    v_exp_f32 v127, v127
    v_cvt_pk_bf16_f32 v66, v124, v125
    v_cvt_pk_bf16_f32 v67, v126, v127
    v_mfma_f32_32x32x16_bf16 v[152:167], v[36:39], v[20:23], v[152:167]
    ds_read_b128 v[32:35], v4 offset:19456
    v_exp_f32 v128, v128
    v_exp_f32 v129, v129
    v_exp_f32 v130, v130
    v_exp_f32 v131, v131
    v_cvt_pk_bf16_f32 v68, v128, v129
    v_cvt_pk_bf16_f32 v69, v130, v131
    v_mfma_f32_32x32x16_bf16 v[184:199], v[40:43], v[64:67], v[184:199]
    v_exp_f32 v132, v132
    v_exp_f32 v133, v133
    v_exp_f32 v134, v134
    v_exp_f32 v135, v135
    v_cvt_pk_bf16_f32 v70, v132, v133
    v_cvt_pk_bf16_f32 v71, v134, v135
    s_waitcnt lgkmcnt(0)
    v_mfma_f32_32x32x4_2b_bf16 v[104:135], v[26:27], v[24:25], v[72:103]
    v_exp_f32 v136, v136
    v_exp_f32 v137, v137
    v_exp_f32 v138, v138
    v_exp_f32 v139, v139
    v_cvt_pk_bf16_f32 v56, v136, v137
    v_cvt_pk_bf16_f32 v57, v138, v139
    v_exp_f32 v140, v140
    v_exp_f32 v141, v141
    v_exp_f32 v142, v142
    v_exp_f32 v143, v143
    v_cvt_pk_bf16_f32 v58, v140, v141
    v_cvt_pk_bf16_f32 v59, v142, v143
    s_setprio 2
    v_mfma_f32_32x32x16_bf16 v[184:199], v[44:47], v[68:71], v[184:199]
    v_exp_f32 v144, v144
    v_exp_f32 v145, v145
    v_exp_f32 v146, v146
    v_exp_f32 v147, v147
    v_cvt_pk_bf16_f32 v60, v144, v145
    v_cvt_pk_bf16_f32 v61, v146, v147
    v_mfma_f32_32x32x16_bf16 v[168:183], v[48:51], v[56:59], v[168:183]
    ds_read_b128 v[40:43], v6 offset:19456
    v_exp_f32 v148, v148
    v_exp_f32 v149, v149
    v_exp_f32 v150, v150
    v_exp_f32 v151, v151
    v_cvt_pk_bf16_f32 v62, v148, v149
    v_cvt_pk_bf16_f32 v63, v150, v151
    v_mfma_f32_32x32x16_bf16 v[104:119], v[32:35], v[16:19], v[104:119]
    ds_read_b128 v[44:47], v6 offset:20096
    v_exp_f32 v152, v152
    v_exp_f32 v153, v153
    v_exp_f32 v154, v154
    v_exp_f32 v155, v155
    v_cvt_pk_bf16_f32 v64, v152, v153
    v_cvt_pk_bf16_f32 v65, v154, v155
    v_mfma_f32_32x32x16_bf16 v[168:183], v[52:55], v[60:63], v[168:183]
    ds_read_b32 v28, v5 offset:19584
    v_exp_f32 v156, v156
    v_exp_f32 v157, v157
    v_exp_f32 v158, v158
    v_exp_f32 v159, v159
    v_cvt_pk_bf16_f32 v66, v156, v157
    v_cvt_pk_bf16_f32 v67, v158, v159
    v_mfma_f32_32x32x16_bf16 v[120:135], v[32:35], v[20:23], v[120:135]
    ds_read_b128 v[36:39], v4 offset:20480
    v_exp_f32 v160, v160
    v_exp_f32 v161, v161
    v_exp_f32 v162, v162
    v_exp_f32 v163, v163
    v_cvt_pk_bf16_f32 v68, v160, v161
    v_cvt_pk_bf16_f32 v69, v162, v163
    v_mfma_f32_32x32x16_bf16 v[184:199], v[48:51], v[64:67], v[184:199]
    v_exp_f32 v164, v164
    v_exp_f32 v165, v165
    v_exp_f32 v166, v166
    v_exp_f32 v167, v167
    v_cvt_pk_bf16_f32 v70, v164, v165
    v_cvt_pk_bf16_f32 v71, v166, v167
    s_waitcnt lgkmcnt(0)
    v_mfma_f32_32x32x4_2b_bf16 v[136:167], v[28:29], v[24:25], v[72:103]
    v_exp_f32 v104, v104
    v_exp_f32 v105, v105
    v_exp_f32 v106, v106
    v_exp_f32 v107, v107
    v_cvt_pk_bf16_f32 v56, v104, v105
    v_cvt_pk_bf16_f32 v57, v106, v107
    v_exp_f32 v108, v108
    v_exp_f32 v109, v109
    v_exp_f32 v110, v110
    v_exp_f32 v111, v111
    v_cvt_pk_bf16_f32 v58, v108, v109
    v_cvt_pk_bf16_f32 v59, v110, v111
    s_setprio 1
    s_waitcnt vmcnt(13)
    v_or3_b32 v224, v208, v209, v220
    v_or3_b32 v225, v210, v211, v221
    v_or3_b32 v226, v212, v213, v222
    v_or3_b32 v227, v214, v215, v223
    buffer_store_dwordx4 v[224:227], v2, s[60:63], s19 offen sc1
    s_add_u32 s19, s19, 1024
    v_mfma_f32_16x16x32_bf16 v[228:231], v[216:219], v[224:227], v[228:231]
    s_cmp_lg_u32 s52, 3
    s_cbranch_scc1 L2_nosw
    v_mov_b32 v232, v233
L2_nosw:
    v_mfma_f32_32x32x16_bf16 v[184:199], v[52:55], v[68:71], v[184:199]
    s_and_b32 s16, s22, 127
    s_mul_i32 s16, s16, s17
    s_add_u32 s16, s16, s18
    v_add_u32 v234, s16, v232
    buffer_load_short_d16 v208, v234, s[64:67], s8 offen
    v_exp_f32 v112, v112
    v_exp_f32 v113, v113
    v_exp_f32 v114, v114
    v_exp_f32 v115, v115
    v_cvt_pk_bf16_f32 v60, v112, v113
    v_cvt_pk_bf16_f32 v61, v114, v115
    v_mfma_f32_32x32x16_bf16 v[168:183], v[40:43], v[56:59], v[168:183]
    buffer_load_short_d16_hi v209, v234, s[64:67], s9 offen
    ds_read_b128 v[48:51], v6 offset:20736
    v_exp_f32 v116, v116
    v_exp_f32 v117, v117
    v_exp_f32 v118, v118
    v_exp_f32 v119, v119
    v_cvt_pk_bf16_f32 v62, v116, v117
    v_cvt_pk_bf16_f32 v63, v118, v119
    v_mfma_f32_32x32x16_bf16 v[136:151], v[36:39], v[16:19], v[136:151]
    buffer_load_short_d16 v210, v234, s[64:67], s10 offen
    ds_read_b128 v[52:55], v6 offset:21376
    v_exp_f32 v120, v120
    v_exp_f32 v121, v121
    v_exp_f32 v122, v122
    v_exp_f32 v123, v123
    v_cvt_pk_bf16_f32 v64, v120, v121
    v_cvt_pk_bf16_f32 v65, v122, v123
    v_mfma_f32_32x32x16_bf16 v[168:183], v[44:47], v[60:63], v[168:183]
    buffer_load_short_d16_hi v211, v234, s[64:67], s11 offen
    ds_read_b32 v26, v5 offset:19712
    v_exp_f32 v124, v124
    v_exp_f32 v125, v125
    v_exp_f32 v126, v126
    v_exp_f32 v127, v127
    v_cvt_pk_bf16_f32 v66, v124, v125
    v_cvt_pk_bf16_f32 v67, v126, v127
    v_mfma_f32_32x32x16_bf16 v[152:167], v[36:39], v[20:23], v[152:167]
    buffer_load_short_d16 v212, v234, s[64:67], s12 offen
    ds_read_b128 v[32:35], v4 offset:21504
    v_exp_f32 v128, v128
    v_exp_f32 v129, v129
    v_exp_f32 v130, v130
    v_exp_f32 v131, v131
    v_cvt_pk_bf16_f32 v68, v128, v129
    v_cvt_pk_bf16_f32 v69, v130, v131
    v_mfma_f32_32x32x16_bf16 v[184:199], v[40:43], v[64:67], v[184:199]
    buffer_load_short_d16_hi v213, v234, s[64:67], s13 offen
    v_exp_f32 v132, v132
    v_exp_f32 v133, v133
    v_exp_f32 v134, v134
    v_exp_f32 v135, v135
    v_cvt_pk_bf16_f32 v70, v132, v133
    v_cvt_pk_bf16_f32 v71, v134, v135
    s_waitcnt lgkmcnt(0)
    v_mfma_f32_32x32x4_2b_bf16 v[104:135], v[26:27], v[24:25], v[72:103]
    v_exp_f32 v136, v136
    v_exp_f32 v137, v137
    v_exp_f32 v138, v138
    v_exp_f32 v139, v139
    v_cvt_pk_bf16_f32 v56, v136, v137
    v_cvt_pk_bf16_f32 v57, v138, v139
    v_exp_f32 v140, v140
    v_exp_f32 v141, v141
    v_exp_f32 v142, v142
    v_exp_f32 v143, v143
    v_cvt_pk_bf16_f32 v58, v140, v141
    v_cvt_pk_bf16_f32 v59, v142, v143
    s_setprio 0
    v_mfma_f32_32x32x16_bf16 v[184:199], v[44:47], v[68:71], v[184:199]
    buffer_load_short_d16 v214, v234, s[64:67], s14 offen
    v_exp_f32 v144, v144
    v_exp_f32 v145, v145
    v_exp_f32 v146, v146
    v_exp_f32 v147, v147
    v_cvt_pk_bf16_f32 v60, v144, v145
    v_cvt_pk_bf16_f32 v61, v146, v147
    v_mfma_f32_32x32x16_bf16 v[168:183], v[48:51], v[56:59], v[168:183]
    buffer_load_short_d16_hi v215, v234, s[64:67], s15 offen
    ds_read_b128 v[40:43], v6 offset:22016
    v_exp_f32 v148, v148
    v_exp_f32 v149, v149
    v_exp_f32 v150, v150
    v_exp_f32 v151, v151
    v_cvt_pk_bf16_f32 v62, v148, v149
    v_cvt_pk_bf16_f32 v63, v150, v151
    v_mfma_f32_32x32x16_bf16 v[104:119], v[32:35], v[16:19], v[104:119]
    buffer_load_dwordx4 v[216:219], v235, s[96:99], s20 offen
    s_add_u32 s20, s20, 64
    ds_read_b128 v[44:47], v6 offset:22656
    v_exp_f32 v152, v152
    v_exp_f32 v153, v153
    v_exp_f32 v154, v154
    v_exp_f32 v155, v155
    v_cvt_pk_bf16_f32 v64, v152, v153
    v_cvt_pk_bf16_f32 v65, v154, v155
    v_mfma_f32_32x32x16_bf16 v[168:183], v[52:55], v[60:63], v[168:183]
    buffer_load_dwordx4 v[220:223], v236, s[4:7], s16 offen
    s_lshr_b64 s[22:23], s[22:23], 7
    ds_read_b32 v28, v5 offset:19840
    v_exp_f32 v156, v156
    v_exp_f32 v157, v157
    v_exp_f32 v158, v158
    v_exp_f32 v159, v159
    v_cvt_pk_bf16_f32 v66, v156, v157
    v_cvt_pk_bf16_f32 v67, v158, v159
    v_mfma_f32_32x32x16_bf16 v[120:135], v[32:35], v[20:23], v[120:135]
    ds_read_b128 v[36:39], v4 offset:22528
    v_exp_f32 v160, v160
    v_exp_f32 v161, v161
    v_exp_f32 v162, v162
    v_exp_f32 v163, v163
    v_cvt_pk_bf16_f32 v68, v160, v161
    v_cvt_pk_bf16_f32 v69, v162, v163
    v_mfma_f32_32x32x16_bf16 v[184:199], v[48:51], v[64:67], v[184:199]
    v_exp_f32 v164, v164
    v_exp_f32 v165, v165
    v_exp_f32 v166, v166
    v_exp_f32 v167, v167
    v_cvt_pk_bf16_f32 v70, v164, v165
    v_cvt_pk_bf16_f32 v71, v166, v167
    s_waitcnt lgkmcnt(0)
    v_mfma_f32_32x32x4_2b_bf16 v[136:167], v[28:29], v[24:25], v[72:103]
    v_exp_f32 v104, v104
    v_exp_f32 v105, v105
    v_exp_f32 v106, v106
    v_exp_f32 v107, v107
    v_cvt_pk_bf16_f32 v56, v104, v105
    v_cvt_pk_bf16_f32 v57, v106, v107
    v_exp_f32 v108, v108
    v_exp_f32 v109, v109
    v_exp_f32 v110, v110
    v_exp_f32 v111, v111
    v_cvt_pk_bf16_f32 v58, v108, v109
    v_cvt_pk_bf16_f32 v59, v110, v111
    s_waitcnt vmcnt(11)
    s_barrier
    s_setprio 3
    v_mfma_f32_32x32x16_bf16 v[184:199], v[52:55], v[68:71], v[184:199]
    buffer_load_dwordx4 v2, s[40:43], m0 offen lds
    s_add_u32 m0, m0, s25
    v_exp_f32 v112, v112
    v_exp_f32 v113, v113
    v_exp_f32 v114, v114
    v_exp_f32 v115, v115
    v_cvt_pk_bf16_f32 v60, v112, v113
    v_cvt_pk_bf16_f32 v61, v114, v115
    v_mfma_f32_32x32x16_bf16 v[168:183], v[40:43], v[56:59], v[168:183]
    buffer_load_dwordx4 v2, s[40:43], m0 offen lds
    s_add_u32 m0, m0, s25
    ds_read_b128 v[48:51], v6 offset:23296
    v_exp_f32 v116, v116
    v_exp_f32 v117, v117
    v_exp_f32 v118, v118
    v_exp_f32 v119, v119
    v_cvt_pk_bf16_f32 v62, v116, v117
    v_cvt_pk_bf16_f32 v63, v118, v119
    v_mfma_f32_32x32x16_bf16 v[136:151], v[36:39], v[16:19], v[136:151]
    buffer_load_dwordx4 v2, s[40:43], m0 offen lds
    s_add_u32 m0, m0, s25
    ds_read_b128 v[52:55], v6 offset:23936
    v_exp_f32 v120, v120
    v_exp_f32 v121, v121
    v_exp_f32 v122, v122
    v_exp_f32 v123, v123
    v_cvt_pk_bf16_f32 v64, v120, v121
    v_cvt_pk_bf16_f32 v65, v122, v123
    v_mfma_f32_32x32x16_bf16 v[168:183], v[44:47], v[60:63], v[168:183]
    ds_read_b32 v26, v5 offset:38912
    v_exp_f32 v124, v124
    v_exp_f32 v125, v125
    v_exp_f32 v126, v126
    v_exp_f32 v127, v127
    v_cvt_pk_bf16_f32 v66, v124, v125
    v_cvt_pk_bf16_f32 v67, v126, v127
    v_mfma_f32_32x32x16_bf16 v[152:167], v[36:39], v[20:23], v[152:167]
    ds_read_b128 v[32:35], v4 offset:38912
    v_exp_f32 v128, v128
    v_exp_f32 v129, v129
    v_exp_f32 v130, v130
    v_exp_f32 v131, v131
    v_cvt_pk_bf16_f32 v68, v128, v129
    v_cvt_pk_bf16_f32 v69, v130, v131
    v_mfma_f32_32x32x16_bf16 v[184:199], v[40:43], v[64:67], v[184:199]
    v_exp_f32 v132, v132
    v_exp_f32 v133, v133
    v_exp_f32 v134, v134
    v_exp_f32 v135, v135
    v_cvt_pk_bf16_f32 v70, v132, v133
    v_cvt_pk_bf16_f32 v71, v134, v135
    s_waitcnt lgkmcnt(0)
    v_mfma_f32_32x32x4_2b_bf16 v[104:135], v[26:27], v[24:25], v[72:103]
    v_exp_f32 v136, v136
    v_exp_f32 v137, v137
    v_exp_f32 v138, v138
    v_exp_f32 v139, v139
    v_cvt_pk_bf16_f32 v56, v136, v137
    v_cvt_pk_bf16_f32 v57, v138, v139
    v_exp_f32 v140, v140
    v_exp_f32 v141, v141
    v_exp_f32 v142, v142
    v_exp_f32 v143, v143
    v_cvt_pk_bf16_f32 v58, v140, v141
    v_cvt_pk_bf16_f32 v59, v142, v143
    s_setprio 2
    v_mfma_f32_32x32x16_bf16 v[184:199], v[44:47], v[68:71], v[184:199]
    v_exp_f32 v144, v144
    v_exp_f32 v145, v145
    v_exp_f32 v146, v146
    v_exp_f32 v147, v147
    v_cvt_pk_bf16_f32 v60, v144, v145
    v_cvt_pk_bf16_f32 v61, v146, v147
    v_mfma_f32_32x32x16_bf16 v[168:183], v[48:51], v[56:59], v[168:183]
    ds_read_b128 v[40:43], v6 offset:38912
    v_exp_f32 v148, v148
    v_exp_f32 v149, v149
    v_exp_f32 v150, v150
    v_exp_f32 v151, v151
    v_cvt_pk_bf16_f32 v62, v148, v149
    v_cvt_pk_bf16_f32 v63, v150, v151
    v_mfma_f32_32x32x16_bf16 v[104:119], v[32:35], v[16:19], v[104:119]
    ds_read_b128 v[44:47], v6 offset:39552
    v_exp_f32 v152, v152
    v_exp_f32 v153, v153
    v_exp_f32 v154, v154
    v_exp_f32 v155, v155
    v_cvt_pk_bf16_f32 v64, v152, v153
    v_cvt_pk_bf16_f32 v65, v154, v155
    v_mfma_f32_32x32x16_bf16 v[168:183], v[52:55], v[60:63], v[168:183]
    ds_read_b32 v28, v5 offset:39040
    v_exp_f32 v156, v156
    v_exp_f32 v157, v157
    v_exp_f32 v158, v158
    v_exp_f32 v159, v159
    v_cvt_pk_bf16_f32 v66, v156, v157
    v_cvt_pk_bf16_f32 v67, v158, v159
    v_mfma_f32_32x32x16_bf16 v[120:135], v[32:35], v[20:23], v[120:135]
    ds_read_b128 v[36:39], v4 offset:39936
    v_exp_f32 v160, v160
    v_exp_f32 v161, v161
    v_exp_f32 v162, v162
    v_exp_f32 v163, v163
    v_cvt_pk_bf16_f32 v68, v160, v161
    v_cvt_pk_bf16_f32 v69, v162, v163
    v_add_u32 v4, 38912, v4
    v_add_u32 v5, 38912, v5
    v_add_u32 v6, 38912, v6
    s_add_u32 s52, s52, 1
    s_cmp_lt_u32 s52, 4
    v_mfma_f32_32x32x16_bf16 v[184:199], v[48:51], v[64:67], v[184:199]
    v_exp_f32 v164, v164
    v_exp_f32 v165, v165
    v_exp_f32 v166, v166
    v_exp_f32 v167, v167
    v_cvt_pk_bf16_f32 v70, v164, v165
    v_cvt_pk_bf16_f32 v71, v166, v167
    s_cbranch_scc1 L2_loop
    s_nop 0
    v_mfma_f32_32x32x16_bf16 v[184:199], v[52:55], v[68:71], v[184:199]
    s_waitcnt vmcnt(13)
    v_or3_b32 v224, v240, v241, v252
    v_or3_b32 v225, v242, v243, v253
    v_or3_b32 v226, v244, v245, v254
    v_or3_b32 v227, v246, v247, v255
    buffer_store_dwordx4 v[224:227], v2, s[60:63], s19 offen sc1
    s_add_u32 s19, s19, 1024
    v_mfma_f32_16x16x32_bf16 v[228:231], v[248:251], v[224:227], v[228:231]
    s_getpc_b64 s[48:49]
Lpc2:
    s_add_u32 s48, s48, kf_kernel-Lpc2
    s_addc_u32 s49, s49, 0
    s_mul_i32 s50, s3, 4096
    v_add_u32 v202, s50, v2
    v_min_u32 v203, LF_exit-kf_kernel-16, v202
    global_load_dwordx4 v[204:207], v203, s[48:49]
    v_add_u32 v202, 1024, v202
    v_min_u32 v203, LF_exit-kf_kernel-16, v202
    global_load_dwordx4 v[204:207], v203, s[48:49]
    v_add_u32 v202, 1024, v202
    v_min_u32 v203, LF_exit-kf_kernel-16, v202
    global_load_dwordx4 v[204:207], v203, s[48:49]
    v_add_u32 v202, 1024, v202
    v_min_u32 v203, LF_exit-kf_kernel-16, v202
    global_load_dwordx4 v[204:207], v203, s[48:49]
    s_waitcnt lgkmcnt(0)
    s_nop 4
    v_add_f32 v200, abs(v168), abs(v169)
    v_add_f32 v200, v200, abs(v170)
    v_add_f32 v200, v200, abs(v171)
    v_add_f32 v200, v200, abs(v172)
    v_add_f32 v200, v200, abs(v173)
    v_add_f32 v200, v200, abs(v174)
    v_add_f32 v200, v200, abs(v175)
    v_add_f32 v200, v200, abs(v176)
    v_add_f32 v200, v200, abs(v177)
    v_add_f32 v200, v200, abs(v184)
    v_add_f32 v200, v200, abs(v185)
    v_add_f32 v200, v200, abs(v186)
    v_add_f32 v200, v200, abs(v187)
    v_add_f32 v200, v200, abs(v188)
    v_add_f32 v200, v200, abs(v189)
    v_add_f32 v200, v200, abs(v190)
    v_add_f32 v200, v200, abs(v191)
    v_add_f32 v200, v200, abs(v192)
    v_add_f32 v200, v200, abs(v193)
    v_add_f32 v201, abs(v178), abs(v194)
    s_mov_b32 s53, 0x7e800000
    s_mov_b32 s54, 0x5f800000
    v_cmp_nge_f32 vcc, s53, v200
    v_cmp_nge_f32 s[56:57], s54, v201
    s_nop 0
    s_or_b64 vcc, vcc, s[56:57]
    v_mov_b32 v14, 155648
    v_mov_b32 v15, 1
    s_cbranch_vccz L2_good
    ds_write_b32 v14, v15
L2_good:
    s_waitcnt lgkmcnt(0)
    s_barrier
    ds_read_b32 v15, v14
    s_waitcnt lgkmcnt(0)
    v_readfirstlane_b32 s53, v15
    s_nop 0
    s_andn2_b32 s53, s53, s51
    s_cmp_lg_u32 s53, 0
    s_cbranch_scc1 L2_slow
    s_cmp_eq_u32 s30, 0
    s_cbranch_scc1 L2_noswap
    v_swap_b32 v168, v184
    v_swap_b32 v169, v185
    v_swap_b32 v170, v186
    v_swap_b32 v171, v187
    v_swap_b32 v172, v188
    v_swap_b32 v173, v189
    v_swap_b32 v174, v190
    v_swap_b32 v175, v191
    v_swap_b32 v176, v192
    v_swap_b32 v177, v193
    v_swap_b32 v178, v194
    v_swap_b32 v179, v195
L2_noswap:
    s_mul_i32 s53, s3, 3072
    v_add_u32 v14, s53, v2
    s_xor_b32 s54, s3, 4
    s_mul_i32 s54, s54, 3072
    v_add_u32 v15, s54, v2
    ds_write_b128 v14, v[184:187] offset:0
    ds_write_b128 v14, v[188:191] offset:1024
    ds_write_b128 v14, v[192:195] offset:2048
    s_waitcnt lgkmcnt(0)
    s_barrier
    ds_read_b128 v[184:187], v15 offset:0
    ds_read_b128 v[188:191], v15 offset:1024
    ds_read_b128 v[192:195], v15 offset:2048
    s_add_u32 s53, s29, s30
    s_mul_i32 s53, s53, 36864
    s_lshl_b32 s54, s28, 10
    s_add_u32 s54, s54, s53
    s_lshr_b32 s55, s28, 3
    s_add_u32 s55, s55, 32
    s_lshl_b32 s55, s55, 10
    s_add_u32 s55, s55, s53
    s_bfe_u32 s56, s28, 0x10002
    s_lshl_b32 s56, s56, 9
    s_add_u32 s55, s55, s56
    s_and_b32 s56, s28, 3
    s_lshl_b32 s56, s56, 2
    s_add_u32 s55, s55, s56
    s_waitcnt lgkmcnt(0)
    v_add_f32 v168, v168, v184
    v_add_f32 v169, v169, v185
    v_add_f32 v170, v170, v186
    v_add_f32 v171, v171, v187
    v_add_f32 v172, v172, v188
    v_add_f32 v173, v173, v189
    v_add_f32 v174, v174, v190
    v_add_f32 v175, v175, v191
    v_add_f32 v176, v176, v192
    v_add_f32 v177, v177, v193
    v_add_f32 v178, v178, v194
    v_rcp_f32 v178, v178
    s_nop 0
    v_mul_f32 v168, v168, v178
    v_mul_f32 v169, v169, v178
    v_mul_f32 v170, v170, v178
    v_mul_f32 v171, v171, v178
    v_mul_f32 v172, v172, v178
    v_mul_f32 v173, v173, v178
    v_mul_f32 v174, v174, v178
    v_mul_f32 v175, v175, v178
    v_mul_f32 v176, v176, v178
    v_mul_f32 v177, v177, v178
    v_cvt_pk_bf16_f32 v56, v168, v169
    v_cvt_pk_bf16_f32 v57, v170, v171
    v_cvt_pk_bf16_f32 v58, v172, v173
    v_cvt_pk_bf16_f32 v59, v174, v175
    v_cvt_pk_bf16_f32 v60, v176, v177
    buffer_store_dwordx4 v[56:59], v2, s[44:47], s54 offen sc1
    s_mov_b32 exec_hi, 0
    buffer_store_dword v60, v2, s[44:47], s55 offen
    s_mov_b32 exec_hi, -1
    s_waitcnt vmcnt(7)
    v_or3_b32 v224, v208, v209, v220
    v_or3_b32 v225, v210, v211, v221
    v_or3_b32 v226, v212, v213, v222
    v_or3_b32 v227, v214, v215, v223
    buffer_store_dwordx4 v[224:227], v2, s[60:63], s19 offen sc1
    s_add_u32 s19, s19, 1024
    v_mfma_f32_16x16x32_bf16 v[228:231], v[216:219], v[224:227], v[228:231]
    s_cmp_lg_u32 s31, 0
    s_cbranch_scc1 L2_noext0
    s_nop 7
    v_cvt_pk_bf16_f32 v208, v228, v229
    v_lshlrev_b32 v209, 16, v208
    v_and_b32 v210, 0xffff0000, v208
    v_sub_f32 v228, v228, v209
    v_sub_f32 v229, v229, v210
    v_cvt_pk_bf16_f32 v224, v209, v228
    v_mov_b32 v225, v208
    v_cvt_pk_bf16_f32 v226, v229, v210
    v_mov_b32 v227, 0
    s_mov_b64 s[56:57], exec
    s_mov_b64 exec, 0xffff
    buffer_store_dwordx4 v[224:227], v2, s[60:63], s21 offen
    s_mov_b64 exec, s[56:57]
L2_noext0:
    s_mov_b32 s31, 3
    s_mov_b32 s19, 0x40000000
    s_mov_b32 s66, 0
    s_mov_b32 s6, 0
    s_endpgm
L2_slow:
    s_waitcnt vmcnt(0)
    v_or3_b32 v224, v208, v209, v220
    v_or3_b32 v225, v210, v211, v221
    v_or3_b32 v226, v212, v213, v222
    v_or3_b32 v227, v214, v215, v223
    buffer_store_dwordx4 v[224:227], v2, s[60:63], s19 offen sc1
    s_add_u32 s19, s19, 1024
    v_mfma_f32_16x16x32_bf16 v[228:231], v[216:219], v[224:227], v[228:231]
    s_cmp_lg_u32 s31, 0
    s_cbranch_scc1 L2_noext1
    s_nop 7
    v_cvt_pk_bf16_f32 v208, v228, v229
    v_lshlrev_b32 v209, 16, v208
    v_and_b32 v210, 0xffff0000, v208
    v_sub_f32 v228, v228, v209
    v_sub_f32 v229, v229, v210
    v_cvt_pk_bf16_f32 v224, v209, v228
    v_mov_b32 v225, v208
    v_cvt_pk_bf16_f32 v226, v229, v210
    v_mov_b32 v227, 0
    s_mov_b64 s[56:57], exec
    s_mov_b64 exec, 0xffff
    buffer_store_dwordx4 v[224:227], v2, s[60:63], s21 offen
    s_mov_b64 exec, s[56:57]
L2_noext1:
    s_mov_b32 s31, 3
    s_mov_b32 s19, 0x40000000
    s_mov_b32 s66, 0
    s_mov_b32 s6, 0
    v_mov_b32 v4, v7
    v_mov_b32 v5, v8
    v_mov_b32 v10, 0xff800000
    v_mov_b32 v11, 0xff800000
    s_mov_b32 s52, 0
L2_slow_loop:
    ds_read_b32 v26, v5 offset:0
    ds_read_b128 v[32:35], v4 offset:0
    s_waitcnt lgkmcnt(0)
    v_mfma_f32_32x32x4_2b_bf16 v[104:135], v[26:27], v[24:25], 0
    s_nop 15
    s_nop 1
    v_mfma_f32_32x32x16_bf16 v[104:119], v[32:35], v[16:19], v[104:119]
    v_mfma_f32_32x32x16_bf16 v[120:135], v[32:35], v[20:23], v[120:135]
    s_nop 10
    v_max3_f32 v10, v10, v104, v105
    v_max3_f32 v10, v10, v106, v107
    v_max3_f32 v10, v10, v108, v109
    v_max3_f32 v10, v10, v110, v111
    v_max3_f32 v10, v10, v112, v113
    v_max3_f32 v10, v10, v114, v115
    v_max3_f32 v10, v10, v116, v117
    v_max3_f32 v10, v10, v118, v119
    v_max3_f32 v11, v11, v120, v121
    v_max3_f32 v11, v11, v122, v123
    v_max3_f32 v11, v11, v124, v125
    v_max3_f32 v11, v11, v126, v127
    v_max3_f32 v11, v11, v128, v129
    v_max3_f32 v11, v11, v130, v131
    v_max3_f32 v11, v11, v132, v133
    v_max3_f32 v11, v11, v134, v135
    ds_read_b32 v26, v5 offset:128
    ds_read_b128 v[32:35], v4 offset:1024
    s_waitcnt lgkmcnt(0)
    v_mfma_f32_32x32x4_2b_bf16 v[104:135], v[26:27], v[24:25], 0
    s_nop 15
    s_nop 1
    v_mfma_f32_32x32x16_bf16 v[104:119], v[32:35], v[16:19], v[104:119]
    v_mfma_f32_32x32x16_bf16 v[120:135], v[32:35], v[20:23], v[120:135]
    s_nop 10
    v_max3_f32 v10, v10, v104, v105
    v_max3_f32 v10, v10, v106, v107
    v_max3_f32 v10, v10, v108, v109
    v_max3_f32 v10, v10, v110, v111
    v_max3_f32 v10, v10, v112, v113
    v_max3_f32 v10, v10, v114, v115
    v_max3_f32 v10, v10, v116, v117
    v_max3_f32 v10, v10, v118, v119
    v_max3_f32 v11, v11, v120, v121
    v_max3_f32 v11, v11, v122, v123
    v_max3_f32 v11, v11, v124, v125
    v_max3_f32 v11, v11, v126, v127
    v_max3_f32 v11, v11, v128, v129
    v_max3_f32 v11, v11, v130, v131
    v_max3_f32 v11, v11, v132, v133
    v_max3_f32 v11, v11, v134, v135
    ds_read_b32 v26, v5 offset:256
    ds_read_b128 v[32:35], v4 offset:2048
    s_waitcnt lgkmcnt(0)
    v_mfma_f32_32x32x4_2b_bf16 v[104:135], v[26:27], v[24:25], 0
    s_nop 15
    s_nop 1
    v_mfma_f32_32x32x16_bf16 v[104:119], v[32:35], v[16:19], v[104:119]
    v_mfma_f32_32x32x16_bf16 v[120:135], v[32:35], v[20:23], v[120:135]
    s_nop 10
    v_max3_f32 v10, v10, v104, v105
    v_max3_f32 v10, v10, v106, v107
    v_max3_f32 v10, v10, v108, v109
    v_max3_f32 v10, v10, v110, v111
    v_max3_f32 v10, v10, v112, v113
    v_max3_f32 v10, v10, v114, v115
    v_max3_f32 v10, v10, v116, v117
    v_max3_f32 v10, v10, v118, v119
    v_max3_f32 v11, v11, v120, v121
    v_max3_f32 v11, v11, v122, v123
    v_max3_f32 v11, v11, v124, v125
    v_max3_f32 v11, v11, v126, v127
    v_max3_f32 v11, v11, v128, v129
    v_max3_f32 v11, v11, v130, v131
    v_max3_f32 v11, v11, v132, v133
    v_max3_f32 v11, v11, v134, v135
    ds_read_b32 v26, v5 offset:384
    ds_read_b128 v[32:35], v4 offset:3072
    s_waitcnt lgkmcnt(0)
    v_mfma_f32_32x32x4_2b_bf16 v[104:135], v[26:27], v[24:25], 0
    s_nop 15
    s_nop 1
    v_mfma_f32_32x32x16_bf16 v[104:119], v[32:35], v[16:19], v[104:119]
    v_mfma_f32_32x32x16_bf16 v[120:135], v[32:35], v[20:23], v[120:135]
    s_nop 10
    v_max3_f32 v10, v10, v104, v105
    v_max3_f32 v10, v10, v106, v107
    v_max3_f32 v10, v10, v108, v109
    v_max3_f32 v10, v10, v110, v111
    v_max3_f32 v10, v10, v112, v113
    v_max3_f32 v10, v10, v114, v115
    v_max3_f32 v10, v10, v116, v117
    v_max3_f32 v10, v10, v118, v119
    v_max3_f32 v11, v11, v120, v121
    v_max3_f32 v11, v11, v122, v123
    v_max3_f32 v11, v11, v124, v125
    v_max3_f32 v11, v11, v126, v127
    v_max3_f32 v11, v11, v128, v129
    v_max3_f32 v11, v11, v130, v131
    v_max3_f32 v11, v11, v132, v133
    v_max3_f32 v11, v11, v134, v135
    v_add_u32 v4, 19456, v4
    v_add_u32 v5, 19456, v5
    s_add_u32 s52, s52, 1
    s_cmp_lt_u32 s52, 8
    s_cbranch_scc1 L2_slow_loop
    v_mov_b32 v200, v10
    s_nop 1
    v_permlane32_swap_b32 v200, v10
    v_max_f32 v10, v10, v200
    v_mov_b32 v200, v11
    s_nop 1
    v_permlane32_swap_b32 v200, v11
    v_max_f32 v11, v11, v200
    s_lshl_b32 s53, s3, 9
    s_add_u32 s53, s53, 155712
    v_lshlrev_b32 v14, 3, v1
    v_add_u32 v15, s53, v14
    ds_write_b64 v15, v[10:11]
    s_xor_b32 s53, s3, 4
    s_lshl_b32 s53, s53, 9
    s_add_u32 s53, s53, 155712
    v_add_u32 v15, s53, v14
    s_waitcnt lgkmcnt(0)
    s_barrier
    ds_read_b64 v[200:201], v15
    s_waitcnt lgkmcnt(0)
    v_max_f32 v10, v10, v200
    v_max_f32 v11, v11, v201
    v_mov_b32 v168, 0
    v_mov_b32 v169, 0
    v_mov_b32 v170, 0
    v_mov_b32 v171, 0
    v_mov_b32 v172, 0
    v_mov_b32 v173, 0
    v_mov_b32 v174, 0
    v_mov_b32 v175, 0
    v_mov_b32 v176, 0
    v_mov_b32 v177, 0
    v_mov_b32 v178, 0
    v_mov_b32 v179, 0
    v_mov_b32 v180, 0
    v_mov_b32 v181, 0
    v_mov_b32 v182, 0
    v_mov_b32 v183, 0
    v_mov_b32 v184, 0
    v_mov_b32 v185, 0
    v_mov_b32 v186, 0
    v_mov_b32 v187, 0
    v_mov_b32 v188, 0
    v_mov_b32 v189, 0
    v_mov_b32 v190, 0
    v_mov_b32 v191, 0
    v_mov_b32 v192, 0
    v_mov_b32 v193, 0
    v_mov_b32 v194, 0
    v_mov_b32 v195, 0
    v_mov_b32 v196, 0
    v_mov_b32 v197, 0
    v_mov_b32 v198, 0
    v_mov_b32 v199, 0
    v_mov_b32 v68, 0
    v_mov_b32 v52, 0
    v_mov_b32 v69, 0
    v_mov_b32 v53, 0
    v_mov_b32 v70, 0
    v_mov_b32 v54, 0
    v_mov_b32 v71, 0
    v_mov_b32 v55, 0
    v_mov_b32 v4, v7
    v_mov_b32 v5, v8
    v_mov_b32 v6, v9
    s_mov_b64 vcc, 0
    s_mov_b32 s51, 1
    s_mov_b32 s25, 0
    s_mov_b32 m0, 0x28000
    s_branch L2_start
L2_exit:
    s_endpgm
.text
.globl kf_kernel
.p2align 8
.type kf_kernel,@function
kf_kernel:
    s_cmp_ge_u32 s2, 256
    s_cbranch_scc1 LF_exit
    s_load_dwordx16 s[4:19], s[0:1], 0
    s_load_dwordx8 s[20:27], s[0:1], 64
    v_lshrrev_b32 v1, 6, v0
    s_nop 0
    v_readfirstlane_b32 s3, v1
    v_and_b32 v1, 63, v0
    v_lshlrev_b32 v2, 4, v1
    v_mov_b32 v14, 1
    v_lshlrev_b32 v15, 24, v1
    s_bfe_u32 s29, s2, 0x20001
    s_lshl_b32 s29, s29, 3
    s_lshr_b32 s30, s2, 5
    s_add_u32 s31, s29, s30
    s_mul_i32 s48, s31, 331776
    s_add_u32 s48, s48, 25165824
    s_mul_i32 s50, s3, 9216
    s_mov_b32 s51, s50
    s_add_u32 s52, s50, 73728
    s_lshr_b32 s29, s2, 3
    s_cmp_ge_u32 s29, 9
    s_cselect_b32 s30, 1, 0
    s_cselect_b32 s28, 9, 0
    s_sub_u32 s29, s29, s28
    s_and_b32 s28, s2, 7
    s_lshl_b32 s28, s28, 1
    s_add_u32 s28, s28, s30
    s_waitcnt lgkmcnt(0)
    s_add_u32 s36, s26, s48
    s_addc_u32 s37, s27, 0
    s_mov_b32 s38, 331776
    s_mov_b32 s39, 0x20000
    s_add_u32 s12, s26, 0x40000
    s_addc_u32 s13, s27, 0
    s_mov_b32 s14, 0x20000
    s_mov_b32 s15, 0x20000
    s_cmp_lt_u32 s2, 144
    s_cbranch_scc1 LF_p3
    s_add_u32 m0, s52, 0
    s_nop 0
    buffer_load_dwordx4 v2, s[36:39], s51 offen offset:0 lds
    buffer_load_dwordx4 v2, s[36:39], s51 offen offset:1024 lds
    buffer_load_dwordx4 v2, s[36:39], s51 offen offset:2048 lds
    buffer_load_dwordx4 v2, s[36:39], s51 offen offset:3072 lds
    s_add_u32 m0, s52, 4096
    s_add_u32 s53, s51, 4096
    buffer_load_dwordx4 v2, s[36:39], s53 offen offset:0 lds
    buffer_load_dwordx4 v2, s[36:39], s53 offen offset:1024 lds
    buffer_load_dwordx4 v2, s[36:39], s53 offen offset:2048 lds
    buffer_load_dwordx4 v2, s[36:39], s53 offen offset:3072 lds
    s_add_u32 m0, s52, 8192
    s_add_u32 s53, s51, 8192
    buffer_load_dwordx4 v2, s[36:39], s53 offen offset:0 lds
    s_add_u32 s51, s51, 36864
    s_add_u32 s52, s52, 36864
    s_cmp_ge_u32 s52, 147456
    s_cselect_b32 s52, s50, s52
    s_add_u32 m0, s52, 0
    s_nop 0
    buffer_load_dwordx4 v2, s[36:39], s51 offen offset:0 lds
    buffer_load_dwordx4 v2, s[36:39], s51 offen offset:1024 lds
    buffer_load_dwordx4 v2, s[36:39], s51 offen offset:2048 lds
    buffer_load_dwordx4 v2, s[36:39], s51 offen offset:3072 lds
    s_add_u32 m0, s52, 4096
    s_add_u32 s53, s51, 4096
    buffer_load_dwordx4 v2, s[36:39], s53 offen offset:0 lds
    buffer_load_dwordx4 v2, s[36:39], s53 offen offset:1024 lds
    buffer_load_dwordx4 v2, s[36:39], s53 offen offset:2048 lds
    buffer_load_dwordx4 v2, s[36:39], s53 offen offset:3072 lds
    s_add_u32 m0, s52, 8192
    s_add_u32 s53, s51, 8192
    buffer_load_dwordx4 v2, s[36:39], s53 offen offset:0 lds
    s_add_u32 s51, s51, 36864
    s_add_u32 s52, s52, 36864
    s_cmp_ge_u32 s52, 147456
    s_cselect_b32 s52, s50, s52
    s_waitcnt vmcnt(0)
    s_branch LF_p4
LF_p3:
    s_lshl_b32 s30, s28, 2
    s_add_u32 s30, s30, s3
    v_and_b32 v8, 15, v1
    v_lshlrev_b32 v8, 4, v8
    v_bfe_u32 v9, v1, 4, 1
    v_mul_u32_u24 v9, 4608, v9
    v_add_u32 v8, v8, v9
    s_mul_i32 s48, s30, 36864
    s_mul_i32 s49, s29, 73728
    s_mul_i32 s54, s3, 3072
    s_add_u32 s49, s49, s54
    s_lshl_b32 s17, s29, 12
    s_add_u32 s17, s17, s48
    s_lshl_b32 s19, s29, 8
    s_add_u32 s19, s19, 4608
    s_add_u32 s64, s26, 0x920000
    s_addc_u32 s65, s27, 0
    s_mov_b32 s66, 0xa2000
    s_mov_b32 s67, 0x20000
    s_add_u32 s32, s26, 0x1200000
    s_addc_u32 s33, s27, 0
    s_mov_b32 s34, 0x240000
    s_mov_b32 s35, 0x20000
    s_mov_b32 s40, s26
    s_mov_b32 s41, s27
    s_mov_b32 s42, 0x3600
    s_mov_b32 s43, 0x20000
    s_add_u32 s44, s26, 0x400000
    s_addc_u32 s45, s27, 0
    s_mov_b32 s46, 0x240000
    s_mov_b32 s47, 0x20000
    buffer_load_dwordx4 v[208:211], v8, s[40:43], s19 offen
    s_add_u32 m0, s54, 0
    s_add_u32 s55, s49, 0
    buffer_load_dwordx4 v2, s[64:67], s55 offen offset:0 lds
    buffer_load_dwordx4 v2, s[64:67], s55 offen offset:1024 lds
    buffer_load_dwordx4 v2, s[64:67], s55 offen offset:2048 lds
    buffer_load_dwordx4 v[16:19], v2, s[32:35], s48 offen offset:0
    buffer_load_dwordx4 v[20:23], v2, s[32:35], s48 offen offset:1024
    s_add_u32 s56, s26, 0x1500000
    s_addc_u32 s57, s27, 0
    s_mov_b32 s58, 0x240000
    s_mov_b32 s59, 0x20000
    buffer_load_dwordx4 v[24:27], v2, s[32:35], s48 offen offset:2048
    buffer_load_dwordx4 v[28:31], v2, s[32:35], s48 offen offset:3072
    s_add_u32 s60, s26, 0x10000
    s_addc_u32 s61, s27, 0
    s_mov_b32 s62, 0x24000
    s_mov_b32 s63, 0x20000
    s_add_u32 s48, s48, 4096
    buffer_load_dwordx4 v[32:35], v2, s[32:35], s48 offen offset:0
    buffer_load_dwordx4 v[36:39], v2, s[32:35], s48 offen offset:1024
    s_add_u32 s8, s26, 0x5000000
    s_addc_u32 s9, s27, 0
    s_mov_b32 s10, 0x240000
    s_mov_b32 s11, 0x20000
    s_add_u32 m0, s54, 12288
    s_add_u32 s55, s49, 12288
    buffer_load_dwordx4 v2, s[64:67], s55 offen offset:0 lds
    buffer_load_dwordx4 v2, s[64:67], s55 offen offset:1024 lds
    v_lshrrev_b32 v6, 5, v1
    v_lshlrev_b32 v7, 5, v6
    v_add_u32 v7, 147456, v7
    v_add_u32 v5, 147456, v2
    v_bfe_u32 v12, v1, 4, 1
    v_mul_u32_u24 v12, 18432, v12
    v_lshl_add_u32 v12, v6, 8, v12
    v_and_b32 v13, 15, v1
    v_lshl_add_u32 v12, v13, 4, v12
    buffer_load_dwordx4 v2, s[64:67], s55 offen offset:2048 lds
    buffer_load_dwordx4 v[40:43], v2, s[32:35], s48 offen offset:2048
    s_mul_i32 s16, s30, 36864
    s_lshl_b32 s18, s29, 11
    s_add_u32 s16, s16, s18
    s_mov_b32 s20, 0xffff0000
    s_lshl_b32 s18, s29, 14
    s_lshl_b32 s21, s30, 8
    s_add_u32 s18, s18, s21
    v_lshlrev_b32 v13, 3, v1
    s_lshr_b32 s21, s30, 1
    s_lshl_b32 s21, s21, 10
    s_add_u32 s21, s21, 32768
    buffer_load_dwordx4 v[44:47], v2, s[32:35], s48 offen offset:3072
    s_add_u32 s48, s48, 4096
    buffer_load_dwordx4 v[48:51], v2, s[32:35], s48 offen offset:0
    buffer_load_dwordx4 v[52:55], v2, s[32:35], s48 offen offset:1024
    buffer_load_dwordx4 v[56:59], v2, s[32:35], s48 offen offset:2048
    buffer_load_dwordx4 v[60:63], v2, s[32:35], s48 offen offset:3072
    s_add_u32 s48, s48, 4096
    s_add_u32 m0, s54, 24576
    s_add_u32 s55, s49, 24576
    buffer_load_dwordx4 v2, s[64:67], s55 offen offset:0 lds
    buffer_load_dwordx4 v2, s[64:67], s55 offen offset:1024 lds
    buffer_load_dwordx4 v2, s[64:67], s55 offen offset:2048 lds
    buffer_load_dwordx4 v[64:67], v2, s[32:35], s48 offen offset:0
    buffer_load_dwordx4 v[68:71], v2, s[32:35], s48 offen offset:1024
    s_waitcnt vmcnt(23)
    ds_write_b128 v5, v[208:211]
    v_mov_b32 v3, v2
    v_add_u32 v4, 0x10000, v2
    s_waitcnt vmcnt(20) lgkmcnt(0)
    s_barrier
    ds_read_b128 a[0:3], v3 offset:0
    ds_read_b128 a[4:7], v3 offset:1024
    ds_read_b128 a[8:11], v3 offset:2048
    ds_read_b128 a[12:15], v3 offset:3072
    s_waitcnt vmcnt(19) lgkmcnt(2)
    v_mfma_f32_32x32x16_bf16 v[160:175], a[0:3], v[16:19], 0
    ds_read_b128 a[16:19], v3 offset:4096
    ds_read_b128 a[20:23], v3 offset:5120
    buffer_load_dwordx4 v[72:75], v2, s[32:35], s48 offen offset:2048
    v_mfma_f32_32x32x16_bf16 v[176:191], a[4:7], v[16:19], 0
    s_waitcnt vmcnt(19) lgkmcnt(2)
    v_mfma_f32_32x32x16_bf16 v[160:175], a[8:11], v[20:23], v[160:175]
    ds_read_b128 a[0:3], v3 offset:6144
    ds_read_b128 a[4:7], v3 offset:7168
    buffer_load_dwordx4 v[76:79], v2, s[32:35], s48 offen offset:3072
    v_mfma_f32_32x32x16_bf16 v[176:191], a[12:15], v[20:23], v[176:191]
    s_add_u32 s48, s48, 4096
    buffer_load_dwordx4 v[80:83], v2, s[32:35], s48 offen offset:0
    s_waitcnt vmcnt(20) lgkmcnt(2)
    v_mfma_f32_32x32x16_bf16 v[160:175], a[16:19], v[24:27], v[160:175]
    ds_read_b128 a[8:11], v3 offset:8192
    ds_read_b128 a[12:15], v3 offset:9216
    buffer_load_dwordx4 v[84:87], v2, s[32:35], s48 offen offset:1024
    v_mfma_f32_32x32x16_bf16 v[176:191], a[20:23], v[24:27], v[176:191]
    s_waitcnt vmcnt(20) lgkmcnt(2)
    v_mfma_f32_32x32x16_bf16 v[160:175], a[0:3], v[28:31], v[160:175]
    ds_read_b128 a[16:19], v3 offset:10240
    ds_read_b128 a[20:23], v3 offset:11264
    s_add_u32 m0, s54, 36864
    s_add_u32 s55, s49, 36864
    buffer_load_dwordx4 v2, s[64:67], s55 offen offset:0 lds
    v_mfma_f32_32x32x16_bf16 v[176:191], a[4:7], v[28:31], v[176:191]
    buffer_load_dwordx4 v2, s[64:67], s55 offen offset:1024 lds
    s_waitcnt vmcnt(21) lgkmcnt(2)
    v_mfma_f32_32x32x16_bf16 v[160:175], a[8:11], v[32:35], v[160:175]
    s_waitcnt vmcnt(17)
    s_barrier
    ds_read_b128 a[0:3], v3 offset:12288
    ds_read_b128 a[4:7], v3 offset:13312
    buffer_load_dwordx4 v2, s[64:67], s55 offen offset:2048 lds
    v_mfma_f32_32x32x16_bf16 v[176:191], a[12:15], v[32:35], v[176:191]
    s_waitcnt lgkmcnt(2)
    v_mfma_f32_32x32x16_bf16 v[160:175], a[16:19], v[36:39], v[160:175]
    ds_read_b128 a[8:11], v3 offset:14336
    ds_read_b128 a[12:15], v3 offset:15360
    buffer_load_dwordx4 v[88:91], v2, s[32:35], s48 offen offset:2048
    v_mfma_f32_32x32x16_bf16 v[176:191], a[20:23], v[36:39], v[176:191]
    buffer_load_dwordx4 v[92:95], v2, s[32:35], s48 offen offset:3072
    s_waitcnt vmcnt(19) lgkmcnt(2)
    v_mfma_f32_32x32x16_bf16 v[160:175], a[0:3], v[40:43], v[160:175]
    ds_read_b128 a[16:19], v3 offset:16384
    ds_read_b128 a[20:23], v3 offset:17408
    s_add_u32 s48, s48, 4096
    buffer_load_dwordx4 v[96:99], v2, s[32:35], s48 offen offset:0
    v_mfma_f32_32x32x16_bf16 v[176:191], a[4:7], v[40:43], v[176:191]
    s_waitcnt vmcnt(19) lgkmcnt(2)
    v_mfma_f32_32x32x16_bf16 v[160:175], a[8:11], v[44:47], v[160:175]
    ds_read_b128 a[0:3], v3 offset:18432
    ds_read_b128 a[4:7], v3 offset:19456
    buffer_load_dwordx4 v[100:103], v2, s[32:35], s48 offen offset:1024
    v_mfma_f32_32x32x16_bf16 v[176:191], a[12:15], v[44:47], v[176:191]
    buffer_load_dwordx4 v[104:107], v2, s[32:35], s48 offen offset:2048
    s_waitcnt vmcnt(20) lgkmcnt(2)
    v_mfma_f32_32x32x16_bf16 v[160:175], a[16:19], v[48:51], v[160:175]
    ds_read_b128 a[8:11], v3 offset:20480
    ds_read_b128 a[12:15], v3 offset:21504
    buffer_load_dwordx4 v[108:111], v2, s[32:35], s48 offen offset:3072
    v_mfma_f32_32x32x16_bf16 v[176:191], a[20:23], v[48:51], v[176:191]
    s_waitcnt vmcnt(20) lgkmcnt(2)
    v_mfma_f32_32x32x16_bf16 v[160:175], a[0:3], v[52:55], v[160:175]
    ds_read_b128 a[16:19], v3 offset:22528
    ds_read_b128 a[20:23], v3 offset:23552
    s_add_u32 s48, s48, 4096
    s_add_u32 m0, s54, 49152
    s_add_u32 s55, s49, 49152
    buffer_load_dwordx4 v2, s[64:67], s55 offen offset:0 lds
    v_mfma_f32_32x32x16_bf16 v[176:191], a[4:7], v[52:55], v[176:191]
    buffer_load_dwordx4 v2, s[64:67], s55 offen offset:1024 lds
    s_waitcnt vmcnt(21) lgkmcnt(2)
    v_mfma_f32_32x32x16_bf16 v[160:175], a[8:11], v[56:59], v[160:175]
    s_waitcnt vmcnt(17)
    s_barrier
    ds_read_b128 a[0:3], v3 offset:24576
    ds_read_b128 a[4:7], v3 offset:25600
    buffer_load_dwordx4 v2, s[64:67], s55 offen offset:2048 lds
    v_mfma_f32_32x32x16_bf16 v[176:191], a[12:15], v[56:59], v[176:191]
    s_waitcnt lgkmcnt(2)
    v_mfma_f32_32x32x16_bf16 v[160:175], a[16:19], v[60:63], v[160:175]
    ds_read_b128 a[8:11], v3 offset:26624
    ds_read_b128 a[12:15], v3 offset:27648
    buffer_load_dwordx4 v[112:115], v2, s[32:35], s48 offen offset:0
    v_mfma_f32_32x32x16_bf16 v[176:191], a[20:23], v[60:63], v[176:191]
    buffer_load_dwordx4 v[116:119], v2, s[32:35], s48 offen offset:1024
    s_waitcnt vmcnt(19) lgkmcnt(2)
    v_mfma_f32_32x32x16_bf16 v[160:175], a[0:3], v[64:67], v[160:175]
    ds_read_b128 a[16:19], v3 offset:28672
    ds_read_b128 a[20:23], v3 offset:29696
    buffer_load_dwordx4 v[120:123], v2, s[32:35], s48 offen offset:2048
    v_mfma_f32_32x32x16_bf16 v[176:191], a[4:7], v[64:67], v[176:191]
    s_waitcnt vmcnt(19) lgkmcnt(2)
    v_mfma_f32_32x32x16_bf16 v[160:175], a[8:11], v[68:71], v[160:175]
    ds_read_b128 a[0:3], v3 offset:30720
    ds_read_b128 a[4:7], v3 offset:31744
    buffer_load_dwordx4 v[124:127], v2, s[32:35], s48 offen offset:3072
    v_mfma_f32_32x32x16_bf16 v[176:191], a[12:15], v[68:71], v[176:191]
    s_add_u32 s48, s48, 4096
    buffer_load_dwordx4 v[128:131], v2, s[32:35], s48 offen offset:0
    s_waitcnt vmcnt(20) lgkmcnt(2)
    v_mfma_f32_32x32x16_bf16 v[160:175], a[16:19], v[72:75], v[160:175]
    ds_read_b128 a[8:11], v3 offset:32768
    ds_read_b128 a[12:15], v3 offset:33792
    buffer_load_dwordx4 v[132:135], v2, s[32:35], s48 offen offset:1024
    v_mfma_f32_32x32x16_bf16 v[176:191], a[20:23], v[72:75], v[176:191]
    s_waitcnt vmcnt(20) lgkmcnt(2)
    v_mfma_f32_32x32x16_bf16 v[160:175], a[0:3], v[76:79], v[160:175]
    ds_read_b128 a[16:19], v3 offset:34816
    ds_read_b128 a[20:23], v3 offset:35840
    s_add_u32 m0, s54, 61440
    s_add_u32 s55, s49, 61440
    buffer_load_dwordx4 v2, s[64:67], s55 offen offset:0 lds
    v_mfma_f32_32x32x16_bf16 v[176:191], a[4:7], v[76:79], v[176:191]
    buffer_load_dwordx4 v2, s[64:67], s55 offen offset:1024 lds
    s_waitcnt vmcnt(21) lgkmcnt(2)
    v_mfma_f32_32x32x16_bf16 v[160:175], a[8:11], v[80:83], v[160:175]
    s_waitcnt vmcnt(17)
    s_barrier
    ds_read_b128 a[0:3], v3 offset:36864
    ds_read_b128 a[4:7], v3 offset:37888
    buffer_load_dwordx4 v2, s[64:67], s55 offen offset:2048 lds
    v_mfma_f32_32x32x16_bf16 v[176:191], a[12:15], v[80:83], v[176:191]
    s_waitcnt lgkmcnt(2)
    v_mfma_f32_32x32x16_bf16 v[160:175], a[16:19], v[84:87], v[160:175]
    ds_read_b128 a[8:11], v3 offset:38912
    ds_read_b128 a[12:15], v3 offset:39936
    buffer_load_dwordx4 v[136:139], v2, s[32:35], s48 offen offset:2048
    v_mfma_f32_32x32x16_bf16 v[176:191], a[20:23], v[84:87], v[176:191]
    buffer_load_dwordx4 v[140:143], v2, s[32:35], s48 offen offset:3072
    s_waitcnt vmcnt(19) lgkmcnt(2)
    v_mfma_f32_32x32x16_bf16 v[160:175], a[0:3], v[88:91], v[160:175]
    ds_read_b128 a[16:19], v3 offset:40960
    ds_read_b128 a[20:23], v3 offset:41984
    s_add_u32 s48, s48, 4096
    buffer_load_dwordx4 v[144:147], v2, s[32:35], s48 offen offset:0
    v_mfma_f32_32x32x16_bf16 v[176:191], a[4:7], v[88:91], v[176:191]
    s_waitcnt vmcnt(19) lgkmcnt(2)
    v_mfma_f32_32x32x16_bf16 v[160:175], a[8:11], v[92:95], v[160:175]
    ds_read_b128 a[0:3], v3 offset:43008
    ds_read_b128 a[4:7], v3 offset:44032
    buffer_load_dwordx4 v[148:151], v2, s[32:35], s48 offen offset:1024
    v_mfma_f32_32x32x16_bf16 v[176:191], a[12:15], v[92:95], v[176:191]
    buffer_load_dwordx4 v[152:155], v2, s[32:35], s48 offen offset:2048
    s_waitcnt vmcnt(20) lgkmcnt(2)
    v_mfma_f32_32x32x16_bf16 v[160:175], a[16:19], v[96:99], v[160:175]
    ds_read_b128 a[8:11], v3 offset:45056
    ds_read_b128 a[12:15], v3 offset:46080
    buffer_load_dwordx4 v[156:159], v2, s[32:35], s48 offen offset:3072
    v_mfma_f32_32x32x16_bf16 v[176:191], a[20:23], v[96:99], v[176:191]
    s_waitcnt vmcnt(20) lgkmcnt(2)
    v_mfma_f32_32x32x16_bf16 v[160:175], a[0:3], v[100:103], v[160:175]
    ds_read_b128 a[16:19], v3 offset:47104
    ds_read_b128 a[20:23], v3 offset:48128
    s_add_u32 s48, s48, 4096
    buffer_load_dwordx4 v[192:195], v2, s[44:47], s17 offen offset:0
    v_mfma_f32_32x32x16_bf16 v[176:191], a[4:7], v[100:103], v[176:191]
    buffer_load_dwordx4 v[196:199], v2, s[44:47], s17 offen offset:1024
    s_waitcnt vmcnt(21) lgkmcnt(2)
    v_mfma_f32_32x32x16_bf16 v[160:175], a[8:11], v[104:107], v[160:175]
    s_waitcnt vmcnt(17)
    s_barrier
    ds_read_b128 a[0:3], v3 offset:49152
    ds_read_b128 a[4:7], v3 offset:50176
    buffer_load_dwordx4 v[200:203], v2, s[44:47], s17 offen offset:2048
    v_mfma_f32_32x32x16_bf16 v[176:191], a[12:15], v[104:107], v[176:191]
    s_waitcnt lgkmcnt(2)
    v_mfma_f32_32x32x16_bf16 v[160:175], a[16:19], v[108:111], v[160:175]
    ds_read_b128 a[8:11], v3 offset:51200
    ds_read_b128 a[12:15], v3 offset:52224
    buffer_load_dwordx4 v[204:207], v2, s[44:47], s17 offen offset:3072
    v_mfma_f32_32x32x16_bf16 v[176:191], a[20:23], v[108:111], v[176:191]
    s_waitcnt vmcnt(18) lgkmcnt(2)
    v_mfma_f32_32x32x16_bf16 v[160:175], a[0:3], v[112:115], v[160:175]
    ds_read_b128 a[16:19], v3 offset:53248
    ds_read_b128 a[20:23], v3 offset:54272
    s_add_u32 m0, s52, 0
    s_nop 0
    buffer_load_dwordx4 v2, s[36:39], s51 offen offset:0 lds
    v_mfma_f32_32x32x16_bf16 v[176:191], a[4:7], v[112:115], v[176:191]
    s_waitcnt vmcnt(18) lgkmcnt(2)
    v_mfma_f32_32x32x16_bf16 v[160:175], a[8:11], v[116:119], v[160:175]
    ds_read_b128 a[0:3], v3 offset:55296
    ds_read_b128 a[4:7], v3 offset:56320
    buffer_load_dwordx4 v2, s[36:39], s51 offen offset:1024 lds
    v_mfma_f32_32x32x16_bf16 v[176:191], a[12:15], v[116:119], v[176:191]
    s_waitcnt vmcnt(18) lgkmcnt(2)
    v_mfma_f32_32x32x16_bf16 v[160:175], a[16:19], v[120:123], v[160:175]
    ds_read_b128 a[8:11], v3 offset:57344
    ds_read_b128 a[12:15], v3 offset:58368
    buffer_load_dwordx4 v2, s[36:39], s51 offen offset:2048 lds
    v_mfma_f32_32x32x16_bf16 v[176:191], a[20:23], v[120:123], v[176:191]
    s_waitcnt vmcnt(18) lgkmcnt(2)
    v_mfma_f32_32x32x16_bf16 v[160:175], a[0:3], v[124:127], v[160:175]
    ds_read_b128 a[16:19], v3 offset:59392
    ds_read_b128 a[20:23], v3 offset:60416
    buffer_load_dwordx4 v2, s[36:39], s51 offen offset:3072 lds
    v_mfma_f32_32x32x16_bf16 v[176:191], a[4:7], v[124:127], v[176:191]
    s_waitcnt vmcnt(18) lgkmcnt(2)
    v_mfma_f32_32x32x16_bf16 v[160:175], a[8:11], v[128:131], v[160:175]
    s_waitcnt vmcnt(14)
    s_barrier
    ds_read_b128 a[0:3], v3 offset:61440
    ds_read_b128 a[4:7], v3 offset:62464
    s_add_u32 m0, s52, 4096
    s_add_u32 s53, s51, 4096
    buffer_load_dwordx4 v2, s[36:39], s53 offen offset:0 lds
    v_mfma_f32_32x32x16_bf16 v[176:191], a[12:15], v[128:131], v[176:191]
    s_waitcnt lgkmcnt(2)
    v_mfma_f32_32x32x16_bf16 v[160:175], a[16:19], v[132:135], v[160:175]
    ds_read_b128 a[8:11], v3 offset:63488
    ds_read_b128 a[12:15], v3 offset:64512
    buffer_load_dwordx4 v2, s[36:39], s53 offen offset:1024 lds
    v_mfma_f32_32x32x16_bf16 v[176:191], a[20:23], v[132:135], v[176:191]
    s_waitcnt vmcnt(15) lgkmcnt(2)
    v_mfma_f32_32x32x16_bf16 v[160:175], a[0:3], v[136:139], v[160:175]
    ds_read_b128 a[16:19], v4 offset:0
    ds_read_b128 a[20:23], v4 offset:1024
    buffer_load_dwordx4 v2, s[36:39], s53 offen offset:2048 lds
    v_mfma_f32_32x32x16_bf16 v[176:191], a[4:7], v[136:139], v[176:191]
    ds_read_b128 v[208:211], v7 offset:0
    ds_read_b128 v[212:215], v7 offset:16
    ds_read_b128 v[216:219], v7 offset:64
    ds_read_b128 v[220:223], v7 offset:80
    ds_read_b128 v[224:227], v7 offset:128
    ds_read_b128 v[228:231], v7 offset:144
    ds_read_b128 v[232:235], v7 offset:192
    ds_read_b128 v[236:239], v7 offset:208
    s_waitcnt vmcnt(15) lgkmcnt(10)
    v_mfma_f32_32x32x16_bf16 v[160:175], a[8:11], v[140:143], v[160:175]
    ds_read_b128 a[0:3], v4 offset:2048
    ds_read_b128 a[4:7], v4 offset:3072
    buffer_load_dwordx4 v2, s[36:39], s53 offen offset:3072 lds
    v_mfma_f32_32x32x16_bf16 v[176:191], a[12:15], v[140:143], v[176:191]
    s_waitcnt vmcnt(15) lgkmcnt(10)
    v_mfma_f32_32x32x16_bf16 v[160:175], a[16:19], v[144:147], v[160:175]
    ds_read_b128 a[8:11], v4 offset:4096
    ds_read_b128 a[12:15], v4 offset:5120
    s_add_u32 m0, s52, 8192
    s_add_u32 s53, s51, 8192
    buffer_load_dwordx4 v2, s[36:39], s53 offen offset:0 lds
    v_mfma_f32_32x32x16_bf16 v[176:191], a[20:23], v[144:147], v[176:191]
    s_waitcnt vmcnt(15) lgkmcnt(2)
    v_mfma_f32_32x32x16_bf16 v[160:175], a[0:3], v[148:151], v[160:175]
    ds_read_b128 a[16:19], v4 offset:6144
    ds_read_b128 a[20:23], v4 offset:7168
    s_add_u32 s51, s51, 36864
    s_add_u32 s52, s52, 36864
    s_cmp_ge_u32 s52, 147456
    s_cselect_b32 s52, s50, s52
    s_add_u32 m0, s52, 0
    s_nop 0
    buffer_load_dwordx4 v2, s[36:39], s51 offen offset:0 lds
    v_mfma_f32_32x32x16_bf16 v[176:191], a[4:7], v[148:151], v[176:191]
    s_waitcnt vmcnt(15) lgkmcnt(2)
    v_mfma_f32_32x32x16_bf16 v[160:175], a[8:11], v[152:155], v[160:175]
    buffer_load_dwordx4 v2, s[36:39], s51 offen offset:1024 lds
    v_mfma_f32_32x32x16_bf16 v[176:191], a[12:15], v[152:155], v[176:191]
    s_waitcnt vmcnt(15) lgkmcnt(0)
    v_mfma_f32_32x32x16_bf16 v[160:175], a[16:19], v[156:159], v[160:175]
    buffer_load_dwordx4 v2, s[36:39], s51 offen offset:2048 lds
    v_mfma_f32_32x32x16_bf16 v[176:191], a[20:23], v[156:159], v[176:191]
    ds_read_b128 v[48:51], v7 offset:256
    ds_read_b128 v[52:55], v7 offset:272
    ds_read_b128 v[56:59], v7 offset:320
    ds_read_b128 v[60:63], v7 offset:336
    ds_read_b128 v[64:67], v7 offset:384
    ds_read_b128 v[68:71], v7 offset:400
    ds_read_b128 v[72:75], v7 offset:448
    ds_read_b128 v[76:79], v7 offset:464
    s_waitcnt vmcnt(12)
    v_lshlrev_b32 v16, 16, v192
    v_and_b32 v17, s20, v192
    v_lshlrev_b32 v18, 16, v193
    v_and_b32 v19, s20, v193
    v_lshlrev_b32 v20, 16, v194
    v_and_b32 v21, s20, v194
    v_lshlrev_b32 v22, 16, v195
    v_and_b32 v23, s20, v195
    buffer_load_dwordx4 v2, s[36:39], s51 offen offset:3072 lds
    v_lshlrev_b32 v24, 16, v196
    v_and_b32 v25, s20, v196
    v_lshlrev_b32 v26, 16, v197
    v_and_b32 v27, s20, v197
    v_lshlrev_b32 v28, 16, v198
    v_and_b32 v29, s20, v198
    v_lshlrev_b32 v30, 16, v199
    v_and_b32 v31, s20, v199
    s_add_u32 m0, s52, 4096
    s_add_u32 s53, s51, 4096
    buffer_load_dwordx4 v2, s[36:39], s53 offen offset:0 lds
    v_lshlrev_b32 v32, 16, v200
    v_and_b32 v33, s20, v200
    v_lshlrev_b32 v34, 16, v201
    v_and_b32 v35, s20, v201
    v_lshlrev_b32 v36, 16, v202
    v_and_b32 v37, s20, v202
    v_lshlrev_b32 v38, 16, v203
    v_and_b32 v39, s20, v203
    buffer_load_dwordx4 v2, s[36:39], s53 offen offset:1024 lds
    v_lshlrev_b32 v40, 16, v204
    v_and_b32 v41, s20, v204
    v_lshlrev_b32 v42, 16, v205
    v_and_b32 v43, s20, v205
    v_lshlrev_b32 v44, 16, v206
    v_and_b32 v45, s20, v206
    v_lshlrev_b32 v46, 16, v207
    v_and_b32 v47, s20, v207
    buffer_load_dwordx4 v2, s[36:39], s53 offen offset:2048 lds
    v_pk_fma_f32 v[16:17], v[208:209], v[160:161], v[16:17]
    v_pk_fma_f32 v[18:19], v[210:211], v[162:163], v[18:19]
    v_pk_fma_f32 v[20:21], v[212:213], v[164:165], v[20:21]
    v_pk_fma_f32 v[22:23], v[214:215], v[166:167], v[22:23]
    v_pk_fma_f32 v[24:25], v[216:217], v[168:169], v[24:25]
    v_pk_fma_f32 v[26:27], v[218:219], v[170:171], v[26:27]
    v_pk_fma_f32 v[28:29], v[220:221], v[172:173], v[28:29]
    v_pk_fma_f32 v[30:31], v[222:223], v[174:175], v[30:31]
    buffer_load_dwordx4 v2, s[36:39], s53 offen offset:3072 lds
    v_pk_fma_f32 v[32:33], v[224:225], v[176:177], v[32:33]
    v_pk_fma_f32 v[34:35], v[226:227], v[178:179], v[34:35]
    v_pk_fma_f32 v[36:37], v[228:229], v[180:181], v[36:37]
    v_pk_fma_f32 v[38:39], v[230:231], v[182:183], v[38:39]
    v_pk_fma_f32 v[40:41], v[232:233], v[184:185], v[40:41]
    v_pk_fma_f32 v[42:43], v[234:235], v[186:187], v[42:43]
    v_pk_fma_f32 v[44:45], v[236:237], v[188:189], v[44:45]
    v_pk_fma_f32 v[46:47], v[238:239], v[190:191], v[46:47]
    s_add_u32 m0, s52, 8192
    s_add_u32 s53, s51, 8192
    buffer_load_dwordx4 v2, s[36:39], s53 offen offset:0 lds
    s_add_u32 s51, s51, 36864
    s_add_u32 s52, s52, 36864
    s_cmp_ge_u32 s52, 147456
    s_cselect_b32 s52, s50, s52
    s_waitcnt lgkmcnt(0)
    v_pk_mul_f32 v[48:49], v[48:49], v[16:17]
    v_pk_mul_f32 v[50:51], v[50:51], v[18:19]
    v_pk_mul_f32 v[52:53], v[52:53], v[20:21]
    v_pk_mul_f32 v[54:55], v[54:55], v[22:23]
    v_pk_mul_f32 v[56:57], v[56:57], v[24:25]
    v_pk_mul_f32 v[58:59], v[58:59], v[26:27]
    v_pk_mul_f32 v[60:61], v[60:61], v[28:29]
    v_pk_mul_f32 v[62:63], v[62:63], v[30:31]
    v_pk_mul_f32 v[64:65], v[64:65], v[32:33]
    v_pk_mul_f32 v[66:67], v[66:67], v[34:35]
    v_pk_mul_f32 v[68:69], v[68:69], v[36:37]
    v_pk_mul_f32 v[70:71], v[70:71], v[38:39]
    v_pk_mul_f32 v[72:73], v[72:73], v[40:41]
    v_pk_mul_f32 v[74:75], v[74:75], v[42:43]
    v_pk_mul_f32 v[76:77], v[76:77], v[44:45]
    v_pk_mul_f32 v[78:79], v[78:79], v[46:47]
    v_cvt_pk_bf16_f32 v208, v48, v49
    v_cvt_pk_bf16_f32 v209, v50, v51
    v_cvt_pk_bf16_f32 v210, v52, v53
    v_cvt_pk_bf16_f32 v211, v54, v55
    buffer_store_dwordx4 v[208:211], v12, s[8:11], s16 offen offset:0 sc1
    v_cvt_pk_bf16_f32 v212, v56, v57
    v_cvt_pk_bf16_f32 v213, v58, v59
    v_cvt_pk_bf16_f32 v214, v60, v61
    v_cvt_pk_bf16_f32 v215, v62, v63
    buffer_store_dwordx4 v[212:215], v12, s[8:11], s16 offen offset:512 sc1
    v_cvt_pk_bf16_f32 v216, v64, v65
    v_cvt_pk_bf16_f32 v217, v66, v67
    v_cvt_pk_bf16_f32 v218, v68, v69
    v_cvt_pk_bf16_f32 v219, v70, v71
    buffer_store_dwordx4 v[216:219], v12, s[8:11], s16 offen offset:1024 sc1
    v_cvt_pk_bf16_f32 v220, v72, v73
    v_cvt_pk_bf16_f32 v221, v74, v75
    v_cvt_pk_bf16_f32 v222, v76, v77
    v_cvt_pk_bf16_f32 v223, v78, v79
    buffer_store_dwordx4 v[220:223], v12, s[8:11], s16 offen offset:1536 sc1
    v_cvt_pk_bf16_f32 v192, v16, v17
    v_cvt_pk_bf16_f32 v193, v18, v19
    v_cvt_pk_bf16_f32 v194, v20, v21
    v_cvt_pk_bf16_f32 v195, v22, v23
    buffer_store_dwordx4 v[192:195], v12, s[56:59], s16 offen offset:0 sc1
    v_cvt_pk_bf16_f32 v196, v24, v25
    v_cvt_pk_bf16_f32 v197, v26, v27
    v_cvt_pk_bf16_f32 v198, v28, v29
    v_cvt_pk_bf16_f32 v199, v30, v31
    buffer_store_dwordx4 v[196:199], v12, s[56:59], s16 offen offset:512 sc1
    v_cvt_pk_bf16_f32 v200, v32, v33
    v_cvt_pk_bf16_f32 v201, v34, v35
    v_cvt_pk_bf16_f32 v202, v36, v37
    v_cvt_pk_bf16_f32 v203, v38, v39
    buffer_store_dwordx4 v[200:203], v12, s[56:59], s16 offen offset:1024 sc1
    v_cvt_pk_bf16_f32 v204, v40, v41
    v_cvt_pk_bf16_f32 v205, v42, v43
    v_cvt_pk_bf16_f32 v206, v44, v45
    v_cvt_pk_bf16_f32 v207, v46, v47
    buffer_store_dwordx4 v[204:207], v12, s[56:59], s16 offen offset:1536 sc1
    v_pk_add_f32 v[8:9], v[16:17], v[18:19]
    v_pk_add_f32 v[10:11], v[20:21], v[22:23]
    v_pk_add_f32 v[8:9], v[8:9], v[24:25]
    v_pk_add_f32 v[10:11], v[10:11], v[26:27]
    v_pk_add_f32 v[8:9], v[8:9], v[28:29]
    v_pk_add_f32 v[10:11], v[10:11], v[30:31]
    v_pk_add_f32 v[8:9], v[8:9], v[32:33]
    v_pk_add_f32 v[10:11], v[10:11], v[34:35]
    v_pk_add_f32 v[8:9], v[8:9], v[36:37]
    v_pk_add_f32 v[10:11], v[10:11], v[38:39]
    v_pk_add_f32 v[8:9], v[8:9], v[40:41]
    v_pk_add_f32 v[10:11], v[10:11], v[42:43]
    v_pk_add_f32 v[8:9], v[8:9], v[44:45]
    v_pk_add_f32 v[10:11], v[10:11], v[46:47]
    v_pk_add_f32 v[8:9], v[8:9], v[10:11]
    v_add_f32 v8, v8, v9
    v_mov_b32 v10, v8
    s_nop 1
    v_permlane32_swap_b32 v10, v8
    v_add_f32 v8, v8, v10
    v_mul_f32 v8, 0x3c800000, v8
    v_pk_add_f32 v[48:49], v[16:17], v[8:9] op_sel_hi:[1,0] neg_lo:[0,1] neg_hi:[0,1]
    v_pk_add_f32 v[50:51], v[18:19], v[8:9] op_sel_hi:[1,0] neg_lo:[0,1] neg_hi:[0,1]
    v_pk_add_f32 v[52:53], v[20:21], v[8:9] op_sel_hi:[1,0] neg_lo:[0,1] neg_hi:[0,1]
    v_pk_add_f32 v[54:55], v[22:23], v[8:9] op_sel_hi:[1,0] neg_lo:[0,1] neg_hi:[0,1]
    v_pk_add_f32 v[56:57], v[24:25], v[8:9] op_sel_hi:[1,0] neg_lo:[0,1] neg_hi:[0,1]
    v_pk_add_f32 v[58:59], v[26:27], v[8:9] op_sel_hi:[1,0] neg_lo:[0,1] neg_hi:[0,1]
    v_pk_add_f32 v[60:61], v[28:29], v[8:9] op_sel_hi:[1,0] neg_lo:[0,1] neg_hi:[0,1]
    v_pk_add_f32 v[62:63], v[30:31], v[8:9] op_sel_hi:[1,0] neg_lo:[0,1] neg_hi:[0,1]
    v_pk_add_f32 v[64:65], v[32:33], v[8:9] op_sel_hi:[1,0] neg_lo:[0,1] neg_hi:[0,1]
    v_pk_add_f32 v[66:67], v[34:35], v[8:9] op_sel_hi:[1,0] neg_lo:[0,1] neg_hi:[0,1]
    v_pk_add_f32 v[68:69], v[36:37], v[8:9] op_sel_hi:[1,0] neg_lo:[0,1] neg_hi:[0,1]
    v_pk_add_f32 v[70:71], v[38:39], v[8:9] op_sel_hi:[1,0] neg_lo:[0,1] neg_hi:[0,1]
    v_pk_add_f32 v[72:73], v[40:41], v[8:9] op_sel_hi:[1,0] neg_lo:[0,1] neg_hi:[0,1]
    v_pk_add_f32 v[74:75], v[42:43], v[8:9] op_sel_hi:[1,0] neg_lo:[0,1] neg_hi:[0,1]
    v_pk_add_f32 v[76:77], v[44:45], v[8:9] op_sel_hi:[1,0] neg_lo:[0,1] neg_hi:[0,1]
    v_pk_add_f32 v[78:79], v[46:47], v[8:9] op_sel_hi:[1,0] neg_lo:[0,1] neg_hi:[0,1]
    v_pk_mul_f32 v[10:11], v[48:49], v[48:49]
    v_pk_mul_f32 v[4:5], v[50:51], v[50:51]
    v_pk_fma_f32 v[10:11], v[52:53], v[52:53], v[10:11]
    v_pk_fma_f32 v[4:5], v[54:55], v[54:55], v[4:5]
    v_pk_fma_f32 v[10:11], v[56:57], v[56:57], v[10:11]
    v_pk_fma_f32 v[4:5], v[58:59], v[58:59], v[4:5]
    v_pk_fma_f32 v[10:11], v[60:61], v[60:61], v[10:11]
    v_pk_fma_f32 v[4:5], v[62:63], v[62:63], v[4:5]
    v_pk_fma_f32 v[10:11], v[64:65], v[64:65], v[10:11]
    v_pk_fma_f32 v[4:5], v[66:67], v[66:67], v[4:5]
    v_pk_fma_f32 v[10:11], v[68:69], v[68:69], v[10:11]
    v_pk_fma_f32 v[4:5], v[70:71], v[70:71], v[4:5]
    v_pk_fma_f32 v[10:11], v[72:73], v[72:73], v[10:11]
    v_pk_fma_f32 v[4:5], v[74:75], v[74:75], v[4:5]
    v_pk_fma_f32 v[10:11], v[76:77], v[76:77], v[10:11]
    v_pk_fma_f32 v[4:5], v[78:79], v[78:79], v[4:5]
    v_pk_add_f32 v[4:5], v[4:5], v[10:11]
    v_add_f32 v9, v4, v5
    v_mov_b32 v10, v9
    s_nop 1
    v_permlane32_swap_b32 v10, v9
    v_add_f32 v9, v9, v10
    s_mov_b32 exec_hi, 0
    buffer_store_dwordx2 v[8:9], v13, s[60:63], s18 offen sc1
    s_mov_b32 exec_hi, -1
    v_lshlrev_b32 v10, 7, v1
    v_cmp_gt_u32 vcc, 8, v1
    v_mov_b32 v11, 0x40000000
    s_nop 0
    v_cndmask_b32 v10, v11, v10, vcc
    s_waitcnt vmcnt(0)
    buffer_atomic_add v14, v10, s[12:15], s21 offen sc1
LF_p4:
    s_barrier
    s_and_b32 s28, s2, 1
    s_lshl_b32 s28, s28, 2
    s_bfe_u32 s29, s2, 0x20003
    s_add_u32 s28, s28, s29
    s_mov_b32 s29, s31
    s_lshl_b32 s30, s28, 2
    s_add_u32 s30, s30, s3
    v_add_u32 v3, 73728, v2
    v_add_u32 v5, 110592, v2
    v_lshlrev_b32 v8, 3, v1
    v_lshlrev_b32 v9, 2, v1
    v_cmp_gt_u32 vcc, 32, v1
    v_mov_b32 v6, 0x40000000
    s_nop 0
    v_cndmask_b32 v4, v6, v2, vcc
    s_add_u32 s32, s26, 0x5000000
    s_addc_u32 s33, s27, 0
    s_mov_b32 s34, 0x240000
    s_mov_b32 s35, 0x20000
    s_mul_i32 s48, s29, 9216
    s_add_u32 s48, s48, 88080384
    s_add_u32 s40, s26, s48
    s_addc_u32 s41, s27, 0
    s_mov_b32 s42, 9216
    s_mov_b32 s43, 0x20000
    s_add_u32 s44, s26, 0x10000
    s_addc_u32 s45, s27, 0
    s_mov_b32 s46, 0x24000
    s_mov_b32 s47, 0x20000
    s_add_u32 s56, s26, 0x2900000
    s_addc_u32 s57, s27, 0
    s_mov_b32 s58, 0x1200000
    s_mov_b32 s59, 0x20000
    s_mov_b32 s54, 0
    buffer_load_dwordx4 v[112:115], v4, s[40:43], s54 offen
    buffer_load_dwordx4 v[116:119], v4, s[40:43], s54 offen offset:512
    s_add_u32 s54, s54, 1024
    buffer_load_dwordx4 v[120:123], v4, s[40:43], s54 offen
    buffer_load_dwordx4 v[124:127], v4, s[40:43], s54 offen offset:512
    s_add_u32 s54, s54, 1024
    buffer_load_dwordx4 v[168:171], v4, s[40:43], s54 offen
    buffer_load_dwordx4 v[172:175], v4, s[40:43], s54 offen offset:512
    s_add_u32 s54, s54, 1024
    s_mul_i32 s48, s30, 73728
    s_lshl_b32 s49, s30, 9
    s_lshr_b32 s60, s29, 3
    s_mul_i32 s60, s60, 36
    s_and_b32 s61, s29, 7
    s_add_u32 s67, s60, s61
    s_add_u32 s67, s67, 28
    s_lshl_b32 s67, s67, 17
    s_mul_i32 s62, s61, 3
    s_add_u32 s62, s62, s60
    s_add_u32 s62, s62, 4
    s_lshl_b32 s62, s62, 17
    s_lshl_b32 s63, s30, 12
    s_add_u32 s62, s62, s63
    s_add_u32 s67, s67, s63
    s_lshr_b32 s61, s61, 1
    s_add_u32 s60, s60, s61
    s_lshl_b32 s60, s60, 17
    s_add_u32 s60, s60, s63
    s_and_b32 s61, s29, 1
    s_lshl_b32 s61, s61, 9
    s_add_u32 s60, s60, s61
    s_lshl_b32 s17, s30, 3
    s_lshr_b32 s16, s29, 2
    s_add_u32 s17, s17, s16
    s_lshl_b32 s17, s17, 7
    s_add_u32 s17, s17, 32768
    s_lshl_b32 s18, s30, 2
    s_lshr_b32 s16, s29, 3
    s_add_u32 s18, s18, s16
    s_lshl_b32 s18, s18, 7
    s_add_u32 s18, s18, 65536
    s_lshr_b32 s64, s2, 6
    s_mul_i32 s64, s64, 1327104
    s_and_b32 s65, s2, 3
    s_mul_i32 s65, s65, 331776
    s_add_u32 s64, s64, s65
    s_add_u32 s64, s64, 0x2300000
    s_add_u32 m0, s52, 0
    s_nop 0
    buffer_load_dwordx4 v2, s[36:39], s51 offen offset:0 lds
    buffer_load_dwordx4 v2, s[36:39], s51 offen offset:1024 lds
    buffer_load_dwordx4 v2, s[36:39], s51 offen offset:2048 lds
    buffer_load_dwordx4 v2, s[36:39], s51 offen offset:3072 lds
    s_add_u32 m0, s52, 4096
    s_add_u32 s53, s51, 4096
    buffer_load_dwordx4 v2, s[36:39], s53 offen offset:0 lds
    buffer_load_dwordx4 v2, s[36:39], s53 offen offset:1024 lds
    buffer_load_dwordx4 v2, s[36:39], s53 offen offset:2048 lds
    buffer_load_dwordx4 v2, s[36:39], s53 offen offset:3072 lds
    s_add_u32 m0, s52, 8192
    s_add_u32 s53, s51, 8192
    buffer_load_dwordx4 v2, s[36:39], s53 offen offset:0 lds
    s_add_u32 s51, s51, 36864
    s_add_u32 s52, s52, 36864
    s_cmp_ge_u32 s52, 147456
    s_cselect_b32 s52, s50, s52
    ds_read_b128 a[208:211], v3 offset:0
    ds_read_b128 a[212:215], v3 offset:1024
    ds_read_b128 a[216:219], v3 offset:2048
    ds_read_b128 a[220:223], v3 offset:3072
    ds_read_b128 a[224:227], v3 offset:4096
    ds_read_b128 a[228:231], v3 offset:5120
    ds_read_b128 a[232:235], v3 offset:18432
    ds_read_b128 a[236:239], v3 offset:19456
    ds_read_b128 a[240:243], v3 offset:20480
    ds_read_b128 a[244:247], v3 offset:21504
    ds_read_b128 a[248:251], v3 offset:22528
    ds_read_b128 a[252:255], v3 offset:23552
    s_getpc_b64 s[4:5]
Lpcf:
    s_add_u32 s4, s4, LF_loop4-Lpcf
    s_addc_u32 s5, s5, 0
    s_mul_i32 s6, s3, 5120
    v_add_u32 v10, s6, v2
    v_min_u32 v11, LF_exit-LF_loop4-16, v10
    global_load_dwordx4 v[16:19], v11, s[4:5]
    v_add_u32 v10, 1024, v10
    v_min_u32 v11, LF_exit-LF_loop4-16, v10
    global_load_dwordx4 v[16:19], v11, s[4:5]
    v_add_u32 v10, 1024, v10
    v_min_u32 v11, LF_exit-LF_loop4-16, v10
    global_load_dwordx4 v[16:19], v11, s[4:5]
    v_add_u32 v10, 1024, v10
    v_min_u32 v11, LF_exit-LF_loop4-16, v10
    global_load_dwordx4 v[16:19], v11, s[4:5]
    v_add_u32 v10, 1024, v10
    v_min_u32 v11, LF_exit-LF_loop4-16, v10
    global_load_dwordx4 v[16:19], v11, s[4:5]
    s_mov_b32 s10, 0
LF_a_poll:
    s_mov_b32 s11, 0
    s_atomic_add s11, s[12:13], s17 glc
    s_add_u32 s10, s10, 1
    s_waitcnt lgkmcnt(0)
    s_cmp_ge_u32 s11, 18
    s_cbranch_scc1 LF_a_go
    s_sleep 4
    s_cmp_lt_u32 s10, 0x20000
    s_cbranch_scc1 LF_a_poll
LF_a_go:
    buffer_load_dwordx2 v[80:81], v8, s[44:47], s49 offen sc1
    s_add_u32 s49, s49, 16384
    buffer_load_dwordx2 v[82:83], v8, s[44:47], s49 offen sc1
    s_add_u32 s49, s49, 16384
    buffer_load_dwordx2 v[84:85], v8, s[44:47], s49 offen sc1
    s_add_u32 s49, s49, 16384
    buffer_load_dwordx2 v[86:87], v8, s[44:47], s49 offen sc1
    s_add_u32 s49, s49, 16384
    buffer_load_dwordx2 v[88:89], v8, s[44:47], s49 offen sc1
    s_add_u32 s49, s49, 16384
    buffer_load_dwordx2 v[90:91], v8, s[44:47], s49 offen sc1
    s_add_u32 s49, s49, 16384
    buffer_load_dwordx2 v[92:93], v8, s[44:47], s49 offen sc1
    s_add_u32 s49, s49, 16384
    buffer_load_dwordx2 v[94:95], v8, s[44:47], s49 offen sc1
    s_add_u32 s49, s49, 16384
    buffer_load_dwordx2 v[96:97], v8, s[44:47], s49 offen sc1
    s_add_u32 s63, s48, 0
    buffer_load_dwordx4 v[176:179], v2, s[32:35], s63 offen offset:0 sc1
    buffer_load_dwordx4 v[180:183], v2, s[32:35], s63 offen offset:1024 sc1
    buffer_load_dwordx4 v[184:187], v2, s[32:35], s63 offen offset:2048 sc1
    buffer_load_dwordx4 v[188:191], v2, s[32:35], s63 offen offset:3072 sc1
    s_add_u32 s63, s63, 4096
    buffer_load_dwordx4 v[192:195], v2, s[32:35], s63 offen offset:0 sc1
    buffer_load_dwordx4 v[196:199], v2, s[32:35], s63 offen offset:1024 sc1
    s_add_u32 s63, s48, 18432
    buffer_load_dwordx4 v[248:251], v2, s[32:35], s63 offen offset:0 sc1
    buffer_load_dwordx4 v[252:255], v2, s[32:35], s63 offen offset:1024 sc1
    buffer_load_dwordx4 a[0:3], v2, s[32:35], s63 offen offset:2048 sc1
    buffer_load_dwordx4 a[4:7], v2, s[32:35], s63 offen offset:3072 sc1
    s_add_u32 s63, s63, 4096
    buffer_load_dwordx4 a[8:11], v2, s[32:35], s63 offen offset:0 sc1
    buffer_load_dwordx4 a[12:15], v2, s[32:35], s63 offen offset:1024 sc1
    s_add_u32 s63, s48, 36864
    buffer_load_dwordx4 a[64:67], v2, s[32:35], s63 offen offset:0 sc1
    buffer_load_dwordx4 a[68:71], v2, s[32:35], s63 offen offset:1024 sc1
    buffer_load_dwordx4 a[72:75], v2, s[32:35], s63 offen offset:2048 sc1
    s_waitcnt vmcnt(15)
    v_add_f32 v11, v80, v82
    v_add_f32 v11, v11, v84
    v_add_f32 v11, v11, v86
    v_add_f32 v11, v11, v88
    v_add_f32 v11, v11, v90
    v_add_f32 v11, v11, v92
    v_add_f32 v11, v11, v94
    v_add_f32 v11, v11, v96
    buffer_load_dwordx4 a[76:79], v2, s[32:35], s63 offen offset:3072 sc1
    v_mul_f32 v11, 0xbde38e39, v11
    v_add_f32 v12, v81, v83
    v_add_f32 v12, v12, v85
    v_add_f32 v12, v12, v87
    v_add_f32 v12, v12, v89
    v_add_f32 v12, v12, v91
    v_add_f32 v12, v12, v93
    v_add_f32 v12, v12, v95
    s_add_u32 s63, s63, 4096
    buffer_load_dwordx4 a[80:83], v2, s[32:35], s63 offen offset:0 sc1
    v_add_f32 v12, v12, v97
    v_add_f32 v80, v80, v11
    v_add_f32 v82, v82, v11
    v_add_f32 v84, v84, v11
    v_add_f32 v86, v86, v11
    v_add_f32 v88, v88, v11
    v_add_f32 v90, v90, v11
    v_add_f32 v92, v92, v11
    buffer_load_dwordx4 a[84:87], v2, s[32:35], s63 offen offset:1024 sc1
    v_add_f32 v94, v94, v11
    v_add_f32 v96, v96, v11
    v_mul_f32 v13, v80, v80
    v_fmac_f32 v13, v82, v82
    v_fmac_f32 v13, v84, v84
    v_fmac_f32 v13, v86, v86
    v_fmac_f32 v13, v88, v88
    v_fmac_f32 v13, v90, v90
    s_add_u32 s63, s48, 55296
    buffer_load_dwordx4 a[136:139], v2, s[32:35], s63 offen offset:0 sc1
    v_fmac_f32 v13, v92, v92
    v_fmac_f32 v13, v94, v94
    v_fmac_f32 v13, v96, v96
    v_fmac_f32 v12, 0x42800000, v13
    v_mov_b32 v13, 0x3727c5ac
    v_fmac_f32 v13, 0x3ae38e39, v12
    v_rsq_f32 v12, v13
    v_sqrt_f32 v7, v13
    buffer_load_dwordx4 a[140:143], v2, s[32:35], s63 offen offset:1024 sc1
    v_mul_f32 v128, 0xc0135761, v12
    v_mul_f32 v129, v12, v12
    v_mul_f32 v129, v129, v12
    v_mul_f32 v129, 0xbdd2d3e8, v129
    v_cvt_pk_bf16_f32 v130, v11, v11
    v_cvt_pk_bf16_f32 v132, v7, v7
    v_and_b32 v133, 0xffff0000, v130
    v_and_b32 v134, 0xffff0000, v132
    buffer_load_dwordx4 a[144:147], v2, s[32:35], s63 offen offset:2048 sc1
    v_sub_f32 v11, v11, v133
    v_sub_f32 v7, v7, v134
    v_cvt_pk_bf16_f32 v131, v11, v134
    v_cvt_pk_bf16_f32 v132, v134, v7
    v_and_b32 v9, 15, v1
    v_lshlrev_b32 v9, 2, v9
    v_and_b32 v13, 0xffffff7f, v13
    ds_bpermute_b32 v144, v9, v128
    ds_bpermute_b32 v148, v9, v129
    ds_bpermute_b32 v155, v9, v13
    ds_bpermute_b32 v152, v9, v130
    ds_bpermute_b32 v153, v9, v131
    ds_bpermute_b32 v154, v9, v132
    v_add_u32 v9, 64, v9
    buffer_load_dwordx4 a[148:151], v2, s[32:35], s63 offen offset:3072 sc1
    ds_bpermute_b32 v145, v9, v128
    ds_bpermute_b32 v149, v9, v129
    ds_bpermute_b32 v159, v9, v13
    ds_bpermute_b32 v156, v9, v130
    ds_bpermute_b32 v157, v9, v131
    ds_bpermute_b32 v158, v9, v132
    s_waitcnt lgkmcnt(0)
    v_add_u32 v9, 64, v9
    ds_bpermute_b32 v146, v9, v128
    ds_bpermute_b32 v150, v9, v129
    ds_bpermute_b32 v163, v9, v13
    ds_bpermute_b32 v160, v9, v130
    ds_bpermute_b32 v161, v9, v131
    ds_bpermute_b32 v162, v9, v132
    v_add_u32 v9, 64, v9
    ds_bpermute_b32 v147, v9, v128
    ds_bpermute_b32 v151, v9, v129
    ds_bpermute_b32 v167, v9, v13
    ds_bpermute_b32 v164, v9, v130
    ds_bpermute_b32 v165, v9, v131
    ds_bpermute_b32 v166, v9, v132
    s_waitcnt lgkmcnt(0)
    s_waitcnt vmcnt(16)
    v_mfma_f32_16x16x32_bf16 v[48:51], v[112:115], v[152:155], 0
    v_mfma_f32_16x16x32_bf16 v[48:51], a[208:211], v[176:179], v[48:51]
    v_mfma_f32_16x16x32_bf16 v[48:51], a[212:215], v[180:183], v[48:51]
    s_add_u32 s63, s63, 4096
    buffer_load_dwordx4 a[152:155], v2, s[32:35], s63 offen offset:0 sc1
    v_mfma_f32_16x16x32_bf16 v[48:51], a[216:219], v[184:187], v[48:51]
    v_mfma_f32_16x16x32_bf16 v[48:51], a[220:223], v[188:191], v[48:51]
    v_mfma_f32_16x16x32_bf16 v[48:51], a[224:227], v[192:195], v[48:51]
    buffer_load_dwordx4 a[156:159], v2, s[32:35], s63 offen offset:1024 sc1
    v_mfma_f32_16x16x32_bf16 v[48:51], a[228:231], v[196:199], v[48:51]
    v_mfma_f32_16x16x32_bf16 v[64:67], v[116:119], v[152:155], 0
    v_mfma_f32_16x16x32_bf16 v[64:67], a[232:235], v[176:179], v[64:67]
    s_add_u32 s63, s48, 6144
    buffer_load_dwordx4 v[200:203], v2, s[32:35], s63 offen offset:0 sc1
    v_mfma_f32_16x16x32_bf16 v[64:67], a[236:239], v[180:183], v[64:67]
    v_mfma_f32_16x16x32_bf16 v[64:67], a[240:243], v[184:187], v[64:67]
    v_mfma_f32_16x16x32_bf16 v[64:67], a[244:247], v[188:191], v[64:67]
    buffer_load_dwordx4 v[204:207], v2, s[32:35], s63 offen offset:1024 sc1
    v_mfma_f32_16x16x32_bf16 v[64:67], a[248:251], v[192:195], v[64:67]
    v_mfma_f32_16x16x32_bf16 v[64:67], a[252:255], v[196:199], v[64:67]
    s_waitcnt vmcnt(14)
    v_mfma_f32_16x16x32_bf16 v[52:55], v[112:115], v[156:159], 0
    v_mfma_f32_16x16x32_bf16 v[52:55], a[208:211], v[248:251], v[52:55]
    v_mfma_f32_16x16x32_bf16 v[52:55], a[212:215], v[252:255], v[52:55]
    buffer_load_dwordx4 v[208:211], v2, s[32:35], s63 offen offset:2048 sc1
    v_mfma_f32_16x16x32_bf16 v[52:55], a[216:219], a[0:3], v[52:55]
    v_mfma_f32_16x16x32_bf16 v[52:55], a[220:223], a[4:7], v[52:55]
    v_mfma_f32_16x16x32_bf16 v[52:55], a[224:227], a[8:11], v[52:55]
    buffer_load_dwordx4 v[212:215], v2, s[32:35], s63 offen offset:3072 sc1
    v_mfma_f32_16x16x32_bf16 v[52:55], a[228:231], a[12:15], v[52:55]
    v_mfma_f32_16x16x32_bf16 v[68:71], v[116:119], v[156:159], 0
    v_mfma_f32_16x16x32_bf16 v[68:71], a[232:235], v[248:251], v[68:71]
    s_add_u32 s63, s63, 4096
    buffer_load_dwordx4 v[216:219], v2, s[32:35], s63 offen offset:0 sc1
    v_mfma_f32_16x16x32_bf16 v[68:71], a[236:239], v[252:255], v[68:71]
    v_mfma_f32_16x16x32_bf16 v[68:71], a[240:243], a[0:3], v[68:71]
    v_mfma_f32_16x16x32_bf16 v[68:71], a[244:247], a[4:7], v[68:71]
    buffer_load_dwordx4 v[220:223], v2, s[32:35], s63 offen offset:1024 sc1
    v_mfma_f32_16x16x32_bf16 v[68:71], a[248:251], a[8:11], v[68:71]
    v_mfma_f32_16x16x32_bf16 v[68:71], a[252:255], a[12:15], v[68:71]
    s_waitcnt vmcnt(12)
    v_mfma_f32_16x16x32_bf16 v[56:59], v[112:115], v[160:163], 0
    v_mfma_f32_16x16x32_bf16 v[56:59], a[208:211], a[64:67], v[56:59]
    v_mfma_f32_16x16x32_bf16 v[56:59], a[212:215], a[68:71], v[56:59]
    s_add_u32 s63, s48, 24576
    buffer_load_dwordx4 a[16:19], v2, s[32:35], s63 offen offset:0 sc1
    v_mfma_f32_16x16x32_bf16 v[56:59], a[216:219], a[72:75], v[56:59]
    v_mfma_f32_16x16x32_bf16 v[56:59], a[220:223], a[76:79], v[56:59]
    v_mfma_f32_16x16x32_bf16 v[56:59], a[224:227], a[80:83], v[56:59]
    buffer_load_dwordx4 a[20:23], v2, s[32:35], s63 offen offset:1024 sc1
    v_mfma_f32_16x16x32_bf16 v[56:59], a[228:231], a[84:87], v[56:59]
    v_mfma_f32_16x16x32_bf16 v[72:75], v[116:119], v[160:163], 0
    v_mfma_f32_16x16x32_bf16 v[72:75], a[232:235], a[64:67], v[72:75]
    buffer_load_dwordx4 a[24:27], v2, s[32:35], s63 offen offset:2048 sc1
    v_mfma_f32_16x16x32_bf16 v[72:75], a[236:239], a[68:71], v[72:75]
    v_mfma_f32_16x16x32_bf16 v[72:75], a[240:243], a[72:75], v[72:75]
    v_mfma_f32_16x16x32_bf16 v[72:75], a[244:247], a[76:79], v[72:75]
    buffer_load_dwordx4 a[28:31], v2, s[32:35], s63 offen offset:3072 sc1
    v_mfma_f32_16x16x32_bf16 v[72:75], a[248:251], a[80:83], v[72:75]
    v_mfma_f32_16x16x32_bf16 v[72:75], a[252:255], a[84:87], v[72:75]
    s_waitcnt vmcnt(10)
    v_mfma_f32_16x16x32_bf16 v[60:63], v[112:115], v[164:167], 0
    v_mfma_f32_16x16x32_bf16 v[60:63], a[208:211], a[136:139], v[60:63]
    v_mfma_f32_16x16x32_bf16 v[60:63], a[212:215], a[140:143], v[60:63]
    s_add_u32 s63, s63, 4096
    buffer_load_dwordx4 a[32:35], v2, s[32:35], s63 offen offset:0 sc1
    v_mfma_f32_16x16x32_bf16 v[60:63], a[216:219], a[144:147], v[60:63]
    v_mfma_f32_16x16x32_bf16 v[60:63], a[220:223], a[148:151], v[60:63]
    v_mfma_f32_16x16x32_bf16 v[60:63], a[224:227], a[152:155], v[60:63]
    buffer_load_dwordx4 a[36:39], v2, s[32:35], s63 offen offset:1024 sc1
    v_mfma_f32_16x16x32_bf16 v[60:63], a[228:231], a[156:159], v[60:63]
    v_mfma_f32_16x16x32_bf16 v[76:79], v[116:119], v[164:167], 0
    v_mfma_f32_16x16x32_bf16 v[76:79], a[232:235], a[136:139], v[76:79]
    s_add_u32 s63, s48, 43008
    buffer_load_dwordx4 a[88:91], v2, s[32:35], s63 offen offset:0 sc1
    v_mfma_f32_16x16x32_bf16 v[76:79], a[236:239], a[140:143], v[76:79]
    v_mfma_f32_16x16x32_bf16 v[76:79], a[240:243], a[144:147], v[76:79]
    v_mfma_f32_16x16x32_bf16 v[76:79], a[244:247], a[148:151], v[76:79]
    buffer_load_dwordx4 a[92:95], v2, s[32:35], s63 offen offset:1024 sc1
    v_mfma_f32_16x16x32_bf16 v[76:79], a[248:251], a[152:155], v[76:79]
    v_mfma_f32_16x16x32_bf16 v[76:79], a[252:255], a[156:159], v[76:79]
    s_barrier
    ds_read_b128 a[208:211], v5 offset:0
    ds_read_b128 a[212:215], v5 offset:1024
    ds_read_b128 a[216:219], v5 offset:2048
    ds_read_b128 a[220:223], v5 offset:3072
    ds_read_b128 a[224:227], v5 offset:4096
    ds_read_b128 a[228:231], v5 offset:5120
    ds_read_b128 a[232:235], v5 offset:18432
    ds_read_b128 a[236:239], v5 offset:19456
    ds_read_b128 a[240:243], v5 offset:20480
    ds_read_b128 a[244:247], v5 offset:21504
    ds_read_b128 a[248:251], v5 offset:22528
    ds_read_b128 a[252:255], v5 offset:23552
    buffer_load_dwordx4 a[96:99], v2, s[32:35], s63 offen offset:2048 sc1
    buffer_load_dwordx4 a[100:103], v2, s[32:35], s63 offen offset:3072 sc1
    s_waitcnt lgkmcnt(6)
    v_mfma_f32_16x16x32_bf16 v[80:83], v[120:123], v[152:155], 0
    v_mfma_f32_16x16x32_bf16 v[80:83], a[208:211], v[176:179], v[80:83]
    v_mfma_f32_16x16x32_bf16 v[80:83], a[212:215], v[180:183], v[80:83]
    v_mfma_f32_16x16x32_bf16 v[80:83], a[216:219], v[184:187], v[80:83]
    v_mfma_f32_16x16x32_bf16 v[80:83], a[220:223], v[188:191], v[80:83]
    s_add_u32 s63, s63, 4096
    buffer_load_dwordx4 a[104:107], v2, s[32:35], s63 offen offset:0 sc1
    v_mfma_f32_16x16x32_bf16 v[80:83], a[224:227], v[192:195], v[80:83]
    v_mfma_f32_16x16x32_bf16 v[80:83], a[228:231], v[196:199], v[80:83]
    v_mfma_f32_16x16x32_bf16 v[84:87], v[120:123], v[156:159], 0
    v_mfma_f32_16x16x32_bf16 v[84:87], a[208:211], v[248:251], v[84:87]
    v_mfma_f32_16x16x32_bf16 v[84:87], a[212:215], v[252:255], v[84:87]
    v_mfma_f32_16x16x32_bf16 v[84:87], a[216:219], a[0:3], v[84:87]
    v_mfma_f32_16x16x32_bf16 v[84:87], a[220:223], a[4:7], v[84:87]
    buffer_load_dwordx4 a[108:111], v2, s[32:35], s63 offen offset:1024 sc1
    v_mfma_f32_16x16x32_bf16 v[84:87], a[224:227], a[8:11], v[84:87]
    v_mfma_f32_16x16x32_bf16 v[84:87], a[228:231], a[12:15], v[84:87]
    v_mfma_f32_16x16x32_bf16 v[88:91], v[120:123], v[160:163], 0
    v_mfma_f32_16x16x32_bf16 v[88:91], a[208:211], a[64:67], v[88:91]
    v_mfma_f32_16x16x32_bf16 v[88:91], a[212:215], a[68:71], v[88:91]
    v_mfma_f32_16x16x32_bf16 v[88:91], a[216:219], a[72:75], v[88:91]
    v_mfma_f32_16x16x32_bf16 v[88:91], a[220:223], a[76:79], v[88:91]
    s_add_u32 s63, s48, 61440
    buffer_load_dwordx4 a[160:163], v2, s[32:35], s63 offen offset:0 sc1
    v_mfma_f32_16x16x32_bf16 v[88:91], a[224:227], a[80:83], v[88:91]
    v_mfma_f32_16x16x32_bf16 v[88:91], a[228:231], a[84:87], v[88:91]
    v_mfma_f32_16x16x32_bf16 v[92:95], v[120:123], v[164:167], 0
    v_mfma_f32_16x16x32_bf16 v[92:95], a[208:211], a[136:139], v[92:95]
    v_mfma_f32_16x16x32_bf16 v[92:95], a[212:215], a[140:143], v[92:95]
    v_mfma_f32_16x16x32_bf16 v[92:95], a[216:219], a[144:147], v[92:95]
    v_mfma_f32_16x16x32_bf16 v[92:95], a[220:223], a[148:151], v[92:95]
    buffer_load_dwordx4 a[164:167], v2, s[32:35], s63 offen offset:1024 sc1
    v_mfma_f32_16x16x32_bf16 v[92:95], a[224:227], a[152:155], v[92:95]
    v_mfma_f32_16x16x32_bf16 v[92:95], a[228:231], a[156:159], v[92:95]
    ds_read_b128 a[208:211], v2 offset:0
    ds_read_b128 a[212:215], v2 offset:1024
    ds_read_b128 a[216:219], v2 offset:2048
    ds_read_b128 a[220:223], v2 offset:3072
    ds_read_b128 a[224:227], v2 offset:4096
    ds_read_b128 a[228:231], v2 offset:5120
    s_waitcnt lgkmcnt(6)
    v_mfma_f32_16x16x32_bf16 v[96:99], v[124:127], v[152:155], 0
    v_mfma_f32_16x16x32_bf16 v[96:99], a[232:235], v[176:179], v[96:99]
    v_mfma_f32_16x16x32_bf16 v[96:99], a[236:239], v[180:183], v[96:99]
    v_mfma_f32_16x16x32_bf16 v[96:99], a[240:243], v[184:187], v[96:99]
    v_mfma_f32_16x16x32_bf16 v[96:99], a[244:247], v[188:191], v[96:99]
    buffer_load_dwordx4 a[168:171], v2, s[32:35], s63 offen offset:2048 sc1
    v_mfma_f32_16x16x32_bf16 v[96:99], a[248:251], v[192:195], v[96:99]
    v_mfma_f32_16x16x32_bf16 v[96:99], a[252:255], v[196:199], v[96:99]
    v_mfma_f32_16x16x32_bf16 v[100:103], v[124:127], v[156:159], 0
    v_mfma_f32_16x16x32_bf16 v[100:103], a[232:235], v[248:251], v[100:103]
    v_mfma_f32_16x16x32_bf16 v[100:103], a[236:239], v[252:255], v[100:103]
    v_mfma_f32_16x16x32_bf16 v[100:103], a[240:243], a[0:3], v[100:103]
    v_mfma_f32_16x16x32_bf16 v[100:103], a[244:247], a[4:7], v[100:103]
    buffer_load_dwordx4 a[172:175], v2, s[32:35], s63 offen offset:3072 sc1
    v_mfma_f32_16x16x32_bf16 v[100:103], a[248:251], a[8:11], v[100:103]
    v_mfma_f32_16x16x32_bf16 v[100:103], a[252:255], a[12:15], v[100:103]
    v_mfma_f32_16x16x32_bf16 v[104:107], v[124:127], v[160:163], 0
    v_mfma_f32_16x16x32_bf16 v[104:107], a[232:235], a[64:67], v[104:107]
    v_mfma_f32_16x16x32_bf16 v[104:107], a[236:239], a[68:71], v[104:107]
    v_mfma_f32_16x16x32_bf16 v[104:107], a[240:243], a[72:75], v[104:107]
    v_mfma_f32_16x16x32_bf16 v[104:107], a[244:247], a[76:79], v[104:107]
    s_add_u32 s63, s63, 4096
    buffer_load_dwordx4 a[176:179], v2, s[32:35], s63 offen offset:0 sc1
    v_mfma_f32_16x16x32_bf16 v[104:107], a[248:251], a[80:83], v[104:107]
    v_mfma_f32_16x16x32_bf16 v[104:107], a[252:255], a[84:87], v[104:107]
    v_mfma_f32_16x16x32_bf16 v[108:111], v[124:127], v[164:167], 0
    v_mfma_f32_16x16x32_bf16 v[108:111], a[232:235], a[136:139], v[108:111]
    v_mfma_f32_16x16x32_bf16 v[108:111], a[236:239], a[140:143], v[108:111]
    v_mfma_f32_16x16x32_bf16 v[108:111], a[240:243], a[144:147], v[108:111]
    v_mfma_f32_16x16x32_bf16 v[108:111], a[244:247], a[148:151], v[108:111]
    buffer_load_dwordx4 a[180:183], v2, s[32:35], s63 offen offset:1024 sc1
    v_mfma_f32_16x16x32_bf16 v[108:111], a[248:251], a[152:155], v[108:111]
    v_mfma_f32_16x16x32_bf16 v[108:111], a[252:255], a[156:159], v[108:111]
    ds_read_b128 a[232:235], v2 offset:18432
    ds_read_b128 a[236:239], v2 offset:19456
    ds_read_b128 a[240:243], v2 offset:20480
    ds_read_b128 a[244:247], v2 offset:21504
    ds_read_b128 a[248:251], v2 offset:22528
    ds_read_b128 a[252:255], v2 offset:23552
    s_waitcnt lgkmcnt(6)
    v_mfma_f32_16x16x32_bf16 v[16:19], v[168:171], v[152:155], 0
    v_mfma_f32_16x16x32_bf16 v[16:19], a[208:211], v[176:179], v[16:19]
    v_mfma_f32_16x16x32_bf16 v[16:19], a[212:215], v[180:183], v[16:19]
    v_mfma_f32_16x16x32_bf16 v[16:19], a[216:219], v[184:187], v[16:19]
    v_mfma_f32_16x16x32_bf16 v[16:19], a[220:223], v[188:191], v[16:19]
    s_add_u32 s63, s48, 12288
    buffer_load_dwordx4 v[224:227], v2, s[32:35], s63 offen offset:0 sc1
    v_mfma_f32_16x16x32_bf16 v[16:19], a[224:227], v[192:195], v[16:19]
    v_mfma_f32_16x16x32_bf16 v[16:19], a[228:231], v[196:199], v[16:19]
    v_mfma_f32_16x16x32_bf16 v[20:23], v[168:171], v[156:159], 0
    v_mfma_f32_16x16x32_bf16 v[20:23], a[208:211], v[248:251], v[20:23]
    v_mfma_f32_16x16x32_bf16 v[20:23], a[212:215], v[252:255], v[20:23]
    v_mfma_f32_16x16x32_bf16 v[20:23], a[216:219], a[0:3], v[20:23]
    v_mfma_f32_16x16x32_bf16 v[20:23], a[220:223], a[4:7], v[20:23]
    buffer_load_dwordx4 v[228:231], v2, s[32:35], s63 offen offset:1024 sc1
    v_mfma_f32_16x16x32_bf16 v[20:23], a[224:227], a[8:11], v[20:23]
    v_mfma_f32_16x16x32_bf16 v[20:23], a[228:231], a[12:15], v[20:23]
    v_mfma_f32_16x16x32_bf16 v[24:27], v[168:171], v[160:163], 0
    v_mfma_f32_16x16x32_bf16 v[24:27], a[208:211], a[64:67], v[24:27]
    v_mfma_f32_16x16x32_bf16 v[24:27], a[212:215], a[68:71], v[24:27]
    v_mfma_f32_16x16x32_bf16 v[24:27], a[216:219], a[72:75], v[24:27]
    v_mfma_f32_16x16x32_bf16 v[24:27], a[220:223], a[76:79], v[24:27]
    buffer_load_dwordx4 v[232:235], v2, s[32:35], s63 offen offset:2048 sc1
    v_mfma_f32_16x16x32_bf16 v[24:27], a[224:227], a[80:83], v[24:27]
    v_mfma_f32_16x16x32_bf16 v[24:27], a[228:231], a[84:87], v[24:27]
    v_mfma_f32_16x16x32_bf16 v[28:31], v[168:171], v[164:167], 0
    v_mfma_f32_16x16x32_bf16 v[28:31], a[208:211], a[136:139], v[28:31]
    v_mfma_f32_16x16x32_bf16 v[28:31], a[212:215], a[140:143], v[28:31]
    v_mfma_f32_16x16x32_bf16 v[28:31], a[216:219], a[144:147], v[28:31]
    v_mfma_f32_16x16x32_bf16 v[28:31], a[220:223], a[148:151], v[28:31]
    buffer_load_dwordx4 v[236:239], v2, s[32:35], s63 offen offset:3072 sc1
    v_mfma_f32_16x16x32_bf16 v[28:31], a[224:227], a[152:155], v[28:31]
    v_mfma_f32_16x16x32_bf16 v[28:31], a[228:231], a[156:159], v[28:31]
    ds_read_b128 a[208:211], v3 offset:6144
    ds_read_b128 a[212:215], v3 offset:7168
    ds_read_b128 a[216:219], v3 offset:8192
    ds_read_b128 a[220:223], v3 offset:9216
    ds_read_b128 a[224:227], v3 offset:10240
    ds_read_b128 a[228:231], v3 offset:11264
    s_waitcnt lgkmcnt(6)
    v_mfma_f32_16x16x32_bf16 v[32:35], v[172:175], v[152:155], 0
    v_mfma_f32_16x16x32_bf16 v[32:35], a[232:235], v[176:179], v[32:35]
    v_mfma_f32_16x16x32_bf16 v[32:35], a[236:239], v[180:183], v[32:35]
    v_mfma_f32_16x16x32_bf16 v[32:35], a[240:243], v[184:187], v[32:35]
    v_mfma_f32_16x16x32_bf16 v[32:35], a[244:247], v[188:191], v[32:35]
    s_add_u32 s63, s63, 4096
    buffer_load_dwordx4 v[240:243], v2, s[32:35], s63 offen offset:0 sc1
    v_mfma_f32_16x16x32_bf16 v[32:35], a[248:251], v[192:195], v[32:35]
    v_mfma_f32_16x16x32_bf16 v[32:35], a[252:255], v[196:199], v[32:35]
    v_mfma_f32_16x16x32_bf16 v[36:39], v[172:175], v[156:159], 0
    v_mfma_f32_16x16x32_bf16 v[36:39], a[232:235], v[248:251], v[36:39]
    v_mfma_f32_16x16x32_bf16 v[36:39], a[236:239], v[252:255], v[36:39]
    v_mfma_f32_16x16x32_bf16 v[36:39], a[240:243], a[0:3], v[36:39]
    v_mfma_f32_16x16x32_bf16 v[36:39], a[244:247], a[4:7], v[36:39]
    buffer_load_dwordx4 v[244:247], v2, s[32:35], s63 offen offset:1024 sc1
    v_mfma_f32_16x16x32_bf16 v[36:39], a[248:251], a[8:11], v[36:39]
    v_mfma_f32_16x16x32_bf16 v[36:39], a[252:255], a[12:15], v[36:39]
    v_mfma_f32_16x16x32_bf16 v[40:43], v[172:175], v[160:163], 0
    v_mfma_f32_16x16x32_bf16 v[40:43], a[232:235], a[64:67], v[40:43]
    v_mfma_f32_16x16x32_bf16 v[40:43], a[236:239], a[68:71], v[40:43]
    v_mfma_f32_16x16x32_bf16 v[40:43], a[240:243], a[72:75], v[40:43]
    v_mfma_f32_16x16x32_bf16 v[40:43], a[244:247], a[76:79], v[40:43]
    s_add_u32 s63, s48, 30720
    buffer_load_dwordx4 a[40:43], v2, s[32:35], s63 offen offset:0 sc1
    v_mfma_f32_16x16x32_bf16 v[40:43], a[248:251], a[80:83], v[40:43]
    v_mfma_f32_16x16x32_bf16 v[40:43], a[252:255], a[84:87], v[40:43]
    v_mfma_f32_16x16x32_bf16 v[44:47], v[172:175], v[164:167], 0
    v_mfma_f32_16x16x32_bf16 v[44:47], a[232:235], a[136:139], v[44:47]
    v_mfma_f32_16x16x32_bf16 v[44:47], a[236:239], a[140:143], v[44:47]
    v_mfma_f32_16x16x32_bf16 v[44:47], a[240:243], a[144:147], v[44:47]
    v_mfma_f32_16x16x32_bf16 v[44:47], a[244:247], a[148:151], v[44:47]
    buffer_load_dwordx4 a[44:47], v2, s[32:35], s63 offen offset:1024 sc1
    v_mfma_f32_16x16x32_bf16 v[44:47], a[248:251], a[152:155], v[44:47]
    v_mfma_f32_16x16x32_bf16 v[44:47], a[252:255], a[156:159], v[44:47]
    ds_read_b128 a[232:235], v3 offset:24576
    ds_read_b128 a[236:239], v3 offset:25600
    ds_read_b128 a[240:243], v3 offset:26624
    ds_read_b128 a[244:247], v3 offset:27648
    ds_read_b128 a[248:251], v3 offset:28672
    ds_read_b128 a[252:255], v3 offset:29696
    s_waitcnt lgkmcnt(6)
    s_waitcnt vmcnt(26)
    v_mfma_f32_16x16x32_bf16 v[48:51], a[208:211], v[200:203], v[48:51]
    v_mfma_f32_16x16x32_bf16 v[48:51], a[212:215], v[204:207], v[48:51]
    v_mfma_f32_16x16x32_bf16 v[48:51], a[216:219], v[208:211], v[48:51]
    v_mfma_f32_16x16x32_bf16 v[48:51], a[220:223], v[212:215], v[48:51]
    v_mfma_f32_16x16x32_bf16 v[48:51], a[224:227], v[216:219], v[48:51]
    buffer_load_dwordx4 a[48:51], v2, s[32:35], s63 offen offset:2048 sc1
    v_mfma_f32_16x16x32_bf16 v[48:51], a[228:231], v[220:223], v[48:51]
    s_waitcnt vmcnt(21)
    v_mfma_f32_16x16x32_bf16 v[52:55], a[208:211], a[16:19], v[52:55]
    v_mfma_f32_16x16x32_bf16 v[52:55], a[212:215], a[20:23], v[52:55]
    v_mfma_f32_16x16x32_bf16 v[52:55], a[216:219], a[24:27], v[52:55]
    v_mfma_f32_16x16x32_bf16 v[52:55], a[220:223], a[28:31], v[52:55]
    v_mfma_f32_16x16x32_bf16 v[52:55], a[224:227], a[32:35], v[52:55]
    buffer_load_dwordx4 a[52:55], v2, s[32:35], s63 offen offset:3072 sc1
    v_mfma_f32_16x16x32_bf16 v[52:55], a[228:231], a[36:39], v[52:55]
    s_waitcnt vmcnt(16)
    v_mfma_f32_16x16x32_bf16 v[56:59], a[208:211], a[88:91], v[56:59]
    v_mfma_f32_16x16x32_bf16 v[56:59], a[212:215], a[92:95], v[56:59]
    v_mfma_f32_16x16x32_bf16 v[56:59], a[216:219], a[96:99], v[56:59]
    v_mfma_f32_16x16x32_bf16 v[56:59], a[220:223], a[100:103], v[56:59]
    v_mfma_f32_16x16x32_bf16 v[56:59], a[224:227], a[104:107], v[56:59]
    s_add_u32 s63, s63, 4096
    buffer_load_dwordx4 a[56:59], v2, s[32:35], s63 offen offset:0 sc1
    v_mfma_f32_16x16x32_bf16 v[56:59], a[228:231], a[108:111], v[56:59]
    s_waitcnt vmcnt(11)
    v_mfma_f32_16x16x32_bf16 v[60:63], a[208:211], a[160:163], v[60:63]
    v_mfma_f32_16x16x32_bf16 v[60:63], a[212:215], a[164:167], v[60:63]
    v_mfma_f32_16x16x32_bf16 v[60:63], a[216:219], a[168:171], v[60:63]
    v_mfma_f32_16x16x32_bf16 v[60:63], a[220:223], a[172:175], v[60:63]
    v_mfma_f32_16x16x32_bf16 v[60:63], a[224:227], a[176:179], v[60:63]
    buffer_load_dwordx4 a[60:63], v2, s[32:35], s63 offen offset:1024 sc1
    v_mfma_f32_16x16x32_bf16 v[60:63], a[228:231], a[180:183], v[60:63]
    ds_read_b128 a[208:211], v5 offset:6144
    ds_read_b128 a[212:215], v5 offset:7168
    ds_read_b128 a[216:219], v5 offset:8192
    ds_read_b128 a[220:223], v5 offset:9216
    ds_read_b128 a[224:227], v5 offset:10240
    ds_read_b128 a[228:231], v5 offset:11264
    s_waitcnt lgkmcnt(6)
    v_mfma_f32_16x16x32_bf16 v[64:67], a[232:235], v[200:203], v[64:67]
    v_mfma_f32_16x16x32_bf16 v[64:67], a[236:239], v[204:207], v[64:67]
    v_mfma_f32_16x16x32_bf16 v[64:67], a[240:243], v[208:211], v[64:67]
    v_mfma_f32_16x16x32_bf16 v[64:67], a[244:247], v[212:215], v[64:67]
    v_mfma_f32_16x16x32_bf16 v[64:67], a[248:251], v[216:219], v[64:67]
    s_add_u32 s63, s48, 49152
    buffer_load_dwordx4 a[112:115], v2, s[32:35], s63 offen offset:0 sc1
    v_mfma_f32_16x16x32_bf16 v[64:67], a[252:255], v[220:223], v[64:67]
    v_mfma_f32_16x16x32_bf16 v[68:71], a[232:235], a[16:19], v[68:71]
    v_mfma_f32_16x16x32_bf16 v[68:71], a[236:239], a[20:23], v[68:71]
    v_mfma_f32_16x16x32_bf16 v[68:71], a[240:243], a[24:27], v[68:71]
    v_mfma_f32_16x16x32_bf16 v[68:71], a[244:247], a[28:31], v[68:71]
    v_mfma_f32_16x16x32_bf16 v[68:71], a[248:251], a[32:35], v[68:71]
    buffer_load_dwordx4 a[116:119], v2, s[32:35], s63 offen offset:1024 sc1
    v_mfma_f32_16x16x32_bf16 v[68:71], a[252:255], a[36:39], v[68:71]
    v_mfma_f32_16x16x32_bf16 v[72:75], a[232:235], a[88:91], v[72:75]
    v_mfma_f32_16x16x32_bf16 v[72:75], a[236:239], a[92:95], v[72:75]
    v_mfma_f32_16x16x32_bf16 v[72:75], a[240:243], a[96:99], v[72:75]
    v_mfma_f32_16x16x32_bf16 v[72:75], a[244:247], a[100:103], v[72:75]
    v_mfma_f32_16x16x32_bf16 v[72:75], a[248:251], a[104:107], v[72:75]
    buffer_load_dwordx4 a[120:123], v2, s[32:35], s63 offen offset:2048 sc1
    v_mfma_f32_16x16x32_bf16 v[72:75], a[252:255], a[108:111], v[72:75]
    v_mfma_f32_16x16x32_bf16 v[76:79], a[232:235], a[160:163], v[76:79]
    v_mfma_f32_16x16x32_bf16 v[76:79], a[236:239], a[164:167], v[76:79]
    v_mfma_f32_16x16x32_bf16 v[76:79], a[240:243], a[168:171], v[76:79]
    v_mfma_f32_16x16x32_bf16 v[76:79], a[244:247], a[172:175], v[76:79]
    v_mfma_f32_16x16x32_bf16 v[76:79], a[248:251], a[176:179], v[76:79]
    buffer_load_dwordx4 a[124:127], v2, s[32:35], s63 offen offset:3072 sc1
    v_mfma_f32_16x16x32_bf16 v[76:79], a[252:255], a[180:183], v[76:79]
    ds_read_b128 a[232:235], v5 offset:24576
    ds_read_b128 a[236:239], v5 offset:25600
    ds_read_b128 a[240:243], v5 offset:26624
    ds_read_b128 a[244:247], v5 offset:27648
    ds_read_b128 a[248:251], v5 offset:28672
    ds_read_b128 a[252:255], v5 offset:29696
    s_waitcnt lgkmcnt(6)
    v_mfma_f32_16x16x32_bf16 v[80:83], a[208:211], v[200:203], v[80:83]
    v_mfma_f32_16x16x32_bf16 v[80:83], a[212:215], v[204:207], v[80:83]
    v_mfma_f32_16x16x32_bf16 v[80:83], a[216:219], v[208:211], v[80:83]
    v_mfma_f32_16x16x32_bf16 v[80:83], a[220:223], v[212:215], v[80:83]
    v_mfma_f32_16x16x32_bf16 v[80:83], a[224:227], v[216:219], v[80:83]
    s_add_u32 s63, s63, 4096
    buffer_load_dwordx4 a[128:131], v2, s[32:35], s63 offen offset:0 sc1
    v_mfma_f32_16x16x32_bf16 v[80:83], a[228:231], v[220:223], v[80:83]
    v_mfma_f32_16x16x32_bf16 v[84:87], a[208:211], a[16:19], v[84:87]
    v_mfma_f32_16x16x32_bf16 v[84:87], a[212:215], a[20:23], v[84:87]
    v_mfma_f32_16x16x32_bf16 v[84:87], a[216:219], a[24:27], v[84:87]
    v_mfma_f32_16x16x32_bf16 v[84:87], a[220:223], a[28:31], v[84:87]
    v_mfma_f32_16x16x32_bf16 v[84:87], a[224:227], a[32:35], v[84:87]
    buffer_load_dwordx4 a[132:135], v2, s[32:35], s63 offen offset:1024 sc1
    v_mfma_f32_16x16x32_bf16 v[84:87], a[228:231], a[36:39], v[84:87]
    v_mfma_f32_16x16x32_bf16 v[88:91], a[208:211], a[88:91], v[88:91]
    v_mfma_f32_16x16x32_bf16 v[88:91], a[212:215], a[92:95], v[88:91]
    v_mfma_f32_16x16x32_bf16 v[88:91], a[216:219], a[96:99], v[88:91]
    v_mfma_f32_16x16x32_bf16 v[88:91], a[220:223], a[100:103], v[88:91]
    v_mfma_f32_16x16x32_bf16 v[88:91], a[224:227], a[104:107], v[88:91]
    s_add_u32 s63, s48, 67584
    buffer_load_dwordx4 a[184:187], v2, s[32:35], s63 offen offset:0 sc1
    v_mfma_f32_16x16x32_bf16 v[88:91], a[228:231], a[108:111], v[88:91]
    v_mfma_f32_16x16x32_bf16 v[92:95], a[208:211], a[160:163], v[92:95]
    v_mfma_f32_16x16x32_bf16 v[92:95], a[212:215], a[164:167], v[92:95]
    v_mfma_f32_16x16x32_bf16 v[92:95], a[216:219], a[168:171], v[92:95]
    v_mfma_f32_16x16x32_bf16 v[92:95], a[220:223], a[172:175], v[92:95]
    v_mfma_f32_16x16x32_bf16 v[92:95], a[224:227], a[176:179], v[92:95]
    buffer_load_dwordx4 a[188:191], v2, s[32:35], s63 offen offset:1024 sc1
    v_mfma_f32_16x16x32_bf16 v[92:95], a[228:231], a[180:183], v[92:95]
    ds_read_b128 a[208:211], v3 offset:12288
    ds_read_b128 a[212:215], v3 offset:13312
    ds_read_b128 a[216:219], v3 offset:14336
    ds_read_b128 a[220:223], v3 offset:15360
    ds_read_b128 a[224:227], v3 offset:16384
    ds_read_b128 a[228:231], v3 offset:17408
    s_waitcnt lgkmcnt(6)
    v_mfma_f32_16x16x32_bf16 v[96:99], a[232:235], v[200:203], v[96:99]
    v_mfma_f32_16x16x32_bf16 v[96:99], a[236:239], v[204:207], v[96:99]
    v_mfma_f32_16x16x32_bf16 v[96:99], a[240:243], v[208:211], v[96:99]
    v_mfma_f32_16x16x32_bf16 v[96:99], a[244:247], v[212:215], v[96:99]
    v_mfma_f32_16x16x32_bf16 v[96:99], a[248:251], v[216:219], v[96:99]
    buffer_load_dwordx4 a[192:195], v2, s[32:35], s63 offen offset:2048 sc1
    v_mfma_f32_16x16x32_bf16 v[96:99], a[252:255], v[220:223], v[96:99]
    v_mfma_f32_16x16x32_bf16 v[100:103], a[232:235], a[16:19], v[100:103]
    v_mfma_f32_16x16x32_bf16 v[100:103], a[236:239], a[20:23], v[100:103]
    v_mfma_f32_16x16x32_bf16 v[100:103], a[240:243], a[24:27], v[100:103]
    v_mfma_f32_16x16x32_bf16 v[100:103], a[244:247], a[28:31], v[100:103]
    v_mfma_f32_16x16x32_bf16 v[100:103], a[248:251], a[32:35], v[100:103]
    buffer_load_dwordx4 a[196:199], v2, s[32:35], s63 offen offset:3072 sc1
    v_mfma_f32_16x16x32_bf16 v[100:103], a[252:255], a[36:39], v[100:103]
    v_mfma_f32_16x16x32_bf16 v[104:107], a[232:235], a[88:91], v[104:107]
    v_mfma_f32_16x16x32_bf16 v[104:107], a[236:239], a[92:95], v[104:107]
    v_mfma_f32_16x16x32_bf16 v[104:107], a[240:243], a[96:99], v[104:107]
    v_mfma_f32_16x16x32_bf16 v[104:107], a[244:247], a[100:103], v[104:107]
    v_mfma_f32_16x16x32_bf16 v[104:107], a[248:251], a[104:107], v[104:107]
    s_add_u32 s63, s63, 4096
    buffer_load_dwordx4 a[200:203], v2, s[32:35], s63 offen offset:0 sc1
    v_mfma_f32_16x16x32_bf16 v[104:107], a[252:255], a[108:111], v[104:107]
    v_mfma_f32_16x16x32_bf16 v[108:111], a[232:235], a[160:163], v[108:111]
    v_mfma_f32_16x16x32_bf16 v[108:111], a[236:239], a[164:167], v[108:111]
    v_mfma_f32_16x16x32_bf16 v[108:111], a[240:243], a[168:171], v[108:111]
    v_mfma_f32_16x16x32_bf16 v[108:111], a[244:247], a[172:175], v[108:111]
    v_mfma_f32_16x16x32_bf16 v[108:111], a[248:251], a[176:179], v[108:111]
    buffer_load_dwordx4 a[204:207], v2, s[32:35], s63 offen offset:1024 sc1
    v_mfma_f32_16x16x32_bf16 v[108:111], a[252:255], a[180:183], v[108:111]
    ds_read_b128 a[232:235], v3 offset:30720
    ds_read_b128 a[236:239], v3 offset:31744
    ds_read_b128 a[240:243], v3 offset:32768
    ds_read_b128 a[244:247], v3 offset:33792
    ds_read_b128 a[248:251], v3 offset:34816
    ds_read_b128 a[252:255], v3 offset:35840
    s_waitcnt lgkmcnt(6)
    s_waitcnt vmcnt(18)
    v_mfma_f32_16x16x32_bf16 v[48:51], a[208:211], v[224:227], v[48:51]
    v_mfma_f32_16x16x32_bf16 v[48:51], a[212:215], v[228:231], v[48:51]
    v_mfma_f32_16x16x32_bf16 v[48:51], a[216:219], v[232:235], v[48:51]
    v_mfma_f32_16x16x32_bf16 v[48:51], a[220:223], v[236:239], v[48:51]
    v_mfma_f32_16x16x32_bf16 v[48:51], a[224:227], v[240:243], v[48:51]
    s_add_u32 m0, s52, 0
    s_nop 0
    buffer_load_dwordx4 v2, s[36:39], s51 offen offset:0 lds
    v_mfma_f32_16x16x32_bf16 v[48:51], a[228:231], v[244:247], v[48:51]
    s_waitcnt vmcnt(13)
    v_mfma_f32_16x16x32_bf16 v[52:55], a[208:211], a[40:43], v[52:55]
    v_mfma_f32_16x16x32_bf16 v[52:55], a[212:215], a[44:47], v[52:55]
    v_mfma_f32_16x16x32_bf16 v[52:55], a[216:219], a[48:51], v[52:55]
    v_mfma_f32_16x16x32_bf16 v[52:55], a[220:223], a[52:55], v[52:55]
    v_mfma_f32_16x16x32_bf16 v[52:55], a[224:227], a[56:59], v[52:55]
    buffer_load_dwordx4 v2, s[36:39], s51 offen offset:1024 lds
    v_mfma_f32_16x16x32_bf16 v[52:55], a[228:231], a[60:63], v[52:55]
    s_waitcnt vmcnt(8)
    v_mfma_f32_16x16x32_bf16 v[56:59], a[208:211], a[112:115], v[56:59]
    v_mfma_f32_16x16x32_bf16 v[56:59], a[212:215], a[116:119], v[56:59]
    v_mfma_f32_16x16x32_bf16 v[56:59], a[216:219], a[120:123], v[56:59]
    v_mfma_f32_16x16x32_bf16 v[56:59], a[220:223], a[124:127], v[56:59]
    v_mfma_f32_16x16x32_bf16 v[56:59], a[224:227], a[128:131], v[56:59]
    buffer_load_dwordx4 v2, s[36:39], s51 offen offset:2048 lds
    v_mfma_f32_16x16x32_bf16 v[56:59], a[228:231], a[132:135], v[56:59]
    s_waitcnt vmcnt(3)
    v_mfma_f32_16x16x32_bf16 v[60:63], a[208:211], a[184:187], v[60:63]
    v_mfma_f32_16x16x32_bf16 v[60:63], a[212:215], a[188:191], v[60:63]
    v_mfma_f32_16x16x32_bf16 v[60:63], a[216:219], a[192:195], v[60:63]
    v_mfma_f32_16x16x32_bf16 v[60:63], a[220:223], a[196:199], v[60:63]
    v_mfma_f32_16x16x32_bf16 v[60:63], a[224:227], a[200:203], v[60:63]
    buffer_load_dwordx4 v2, s[36:39], s51 offen offset:3072 lds
    v_mfma_f32_16x16x32_bf16 v[60:63], a[228:231], a[204:207], v[60:63]
    ds_read_b128 a[208:211], v2 offset:6144
    ds_read_b128 a[212:215], v2 offset:7168
    ds_read_b128 a[216:219], v2 offset:8192
    ds_read_b128 a[220:223], v2 offset:9216
    ds_read_b128 a[224:227], v2 offset:10240
    ds_read_b128 a[228:231], v2 offset:11264
    s_waitcnt lgkmcnt(6)
    v_mfma_f32_16x16x32_bf16 v[64:67], a[232:235], v[224:227], v[64:67]
    v_mfma_f32_16x16x32_bf16 v[64:67], a[236:239], v[228:231], v[64:67]
    v_mfma_f32_16x16x32_bf16 v[64:67], a[240:243], v[232:235], v[64:67]
    v_mfma_f32_16x16x32_bf16 v[64:67], a[244:247], v[236:239], v[64:67]
    v_mfma_f32_16x16x32_bf16 v[64:67], a[248:251], v[240:243], v[64:67]
    s_add_u32 m0, s52, 4096
    s_add_u32 s53, s51, 4096
    buffer_load_dwordx4 v2, s[36:39], s53 offen offset:0 lds
    v_mfma_f32_16x16x32_bf16 v[64:67], a[252:255], v[244:247], v[64:67]
    v_mfma_f32_16x16x32_bf16 v[68:71], a[232:235], a[40:43], v[68:71]
    v_mfma_f32_16x16x32_bf16 v[68:71], a[236:239], a[44:47], v[68:71]
    v_mfma_f32_16x16x32_bf16 v[68:71], a[240:243], a[48:51], v[68:71]
    v_mfma_f32_16x16x32_bf16 v[68:71], a[244:247], a[52:55], v[68:71]
    v_mfma_f32_16x16x32_bf16 v[68:71], a[248:251], a[56:59], v[68:71]
    buffer_load_dwordx4 v2, s[36:39], s53 offen offset:1024 lds
    v_mfma_f32_16x16x32_bf16 v[68:71], a[252:255], a[60:63], v[68:71]
    v_mfma_f32_16x16x32_bf16 v[72:75], a[232:235], a[112:115], v[72:75]
    v_mfma_f32_16x16x32_bf16 v[72:75], a[236:239], a[116:119], v[72:75]
    v_mfma_f32_16x16x32_bf16 v[72:75], a[240:243], a[120:123], v[72:75]
    v_mfma_f32_16x16x32_bf16 v[72:75], a[244:247], a[124:127], v[72:75]
    v_mfma_f32_16x16x32_bf16 v[72:75], a[248:251], a[128:131], v[72:75]
    buffer_load_dwordx4 v2, s[36:39], s53 offen offset:2048 lds
    v_mfma_f32_16x16x32_bf16 v[72:75], a[252:255], a[132:135], v[72:75]
    v_mfma_f32_16x16x32_bf16 v[76:79], a[232:235], a[184:187], v[76:79]
    v_mfma_f32_16x16x32_bf16 v[76:79], a[236:239], a[188:191], v[76:79]
    v_mfma_f32_16x16x32_bf16 v[76:79], a[240:243], a[192:195], v[76:79]
    v_mfma_f32_16x16x32_bf16 v[76:79], a[244:247], a[196:199], v[76:79]
    v_mfma_f32_16x16x32_bf16 v[76:79], a[248:251], a[200:203], v[76:79]
    buffer_load_dwordx4 v2, s[36:39], s53 offen offset:3072 lds
    v_mfma_f32_16x16x32_bf16 v[76:79], a[252:255], a[204:207], v[76:79]
    ds_read_b128 a[232:235], v2 offset:24576
    ds_read_b128 a[236:239], v2 offset:25600
    ds_read_b128 a[240:243], v2 offset:26624
    ds_read_b128 a[244:247], v2 offset:27648
    ds_read_b128 a[248:251], v2 offset:28672
    ds_read_b128 a[252:255], v2 offset:29696
    s_add_u32 m0, s52, 8192
    s_add_u32 s53, s51, 8192
    buffer_load_dwordx4 v2, s[36:39], s53 offen offset:0 lds
    s_add_u32 s51, s51, 36864
    s_add_u32 s52, s52, 36864
    s_cmp_ge_u32 s52, 147456
    s_cselect_b32 s52, s50, s52
    buffer_load_dwordx4 v[168:171], v4, s[40:43], s54 offen
    buffer_load_dwordx4 v[172:175], v4, s[40:43], s54 offen offset:512
    s_add_u32 s54, s54, 1024
    s_barrier
    s_waitcnt lgkmcnt(6)
    v_mfma_f32_16x16x32_bf16 v[16:19], a[208:211], v[200:203], v[16:19]
    v_mul_f32 v128, v48, v48
    v_mul_f32 v129, v49, v49
    v_mfma_f32_16x16x32_bf16 v[16:19], a[212:215], v[204:207], v[16:19]
    v_mul_f32 v130, v50, v50
    v_mul_f32 v131, v51, v51
    v_mfma_f32_16x16x32_bf16 v[16:19], a[216:219], v[208:211], v[16:19]
    v_fma_f32 v128, v128, v148, v144
    v_fma_f32 v129, v129, v148, v144
    v_mfma_f32_16x16x32_bf16 v[16:19], a[220:223], v[212:215], v[16:19]
    v_fma_f32 v130, v130, v148, v144
    v_fma_f32 v131, v131, v148, v144
    v_mfma_f32_16x16x32_bf16 v[16:19], a[224:227], v[216:219], v[16:19]
    v_mul_f32 v128, v128, v48
    v_mul_f32 v129, v129, v49
    v_mfma_f32_16x16x32_bf16 v[16:19], a[228:231], v[220:223], v[16:19]
    v_mul_f32 v130, v130, v50
    v_mul_f32 v131, v131, v51
    v_mfma_f32_16x16x32_bf16 v[20:23], a[208:211], a[16:19], v[20:23]
    s_add_u32 m0, s52, 0
    v_mfma_f32_16x16x32_bf16 v[20:23], a[212:215], a[20:23], v[20:23]
    buffer_load_dwordx4 v2, s[36:39], s51 offen offset:0 lds
    v_mfma_f32_16x16x32_bf16 v[20:23], a[216:219], a[24:27], v[20:23]
    v_exp_f32 v128, v128
    v_mfma_f32_16x16x32_bf16 v[20:23], a[220:223], a[28:31], v[20:23]
    v_exp_f32 v129, v129
    v_mfma_f32_16x16x32_bf16 v[20:23], a[224:227], a[32:35], v[20:23]
    v_exp_f32 v130, v130
    v_mfma_f32_16x16x32_bf16 v[20:23], a[228:231], a[36:39], v[20:23]
    v_exp_f32 v131, v131
    v_mfma_f32_16x16x32_bf16 v[24:27], a[208:211], a[88:91], v[24:27]
    v_mul_f32 v132, v48, v64
    v_mul_f32 v133, v49, v65
    v_mfma_f32_16x16x32_bf16 v[24:27], a[212:215], a[92:95], v[24:27]
    v_mul_f32 v134, v50, v66
    v_mul_f32 v135, v51, v67
    v_mfma_f32_16x16x32_bf16 v[24:27], a[216:219], a[96:99], v[24:27]
    v_fma_f32 v128, v128, v155, v155
    v_fma_f32 v129, v129, v155, v155
    v_mfma_f32_16x16x32_bf16 v[24:27], a[220:223], a[100:103], v[24:27]
    buffer_load_dwordx4 v2, s[36:39], s51 offen offset:1024 lds
    v_fma_f32 v130, v130, v155, v155
    v_mfma_f32_16x16x32_bf16 v[24:27], a[224:227], a[104:107], v[24:27]
    v_fma_f32 v131, v131, v155, v155
    v_mfma_f32_16x16x32_bf16 v[24:27], a[228:231], a[108:111], v[24:27]
    v_rcp_f32 v128, v128
    v_mfma_f32_16x16x32_bf16 v[28:31], a[208:211], a[160:163], v[28:31]
    v_rcp_f32 v129, v129
    v_mfma_f32_16x16x32_bf16 v[28:31], a[212:215], a[164:167], v[28:31]
    v_rcp_f32 v130, v130
    v_mfma_f32_16x16x32_bf16 v[28:31], a[216:219], a[168:171], v[28:31]
    v_rcp_f32 v131, v131
    v_mfma_f32_16x16x32_bf16 v[28:31], a[220:223], a[172:175], v[28:31]
    v_mul_f32 v132, v132, v128
    v_mul_f32 v133, v133, v129
    v_mfma_f32_16x16x32_bf16 v[28:31], a[224:227], a[176:179], v[28:31]
    v_mul_f32 v134, v134, v130
    v_mul_f32 v135, v135, v131
    v_mfma_f32_16x16x32_bf16 v[28:31], a[228:231], a[180:183], v[28:31]
    v_cvt_pk_bf16_f32 v114, v132, v133
    s_waitcnt lgkmcnt(0)
    v_mfma_f32_16x16x32_bf16 v[32:35], a[232:235], v[200:203], v[32:35]
    ds_read_b128 a[208:211], v5 offset:12288
    buffer_load_dwordx4 v2, s[36:39], s51 offen offset:2048 lds
    v_mfma_f32_16x16x32_bf16 v[32:35], a[236:239], v[204:207], v[32:35]
    ds_read_b128 a[212:215], v5 offset:13312
    v_cvt_pk_bf16_f32 v115, v134, v135
    v_mfma_f32_16x16x32_bf16 v[32:35], a[240:243], v[208:211], v[32:35]
    ds_read_b128 a[216:219], v5 offset:14336
    buffer_store_dwordx2 v[114:115], v8, s[56:59], s60 offen offset:0 sc1
    v_mfma_f32_16x16x32_bf16 v[32:35], a[244:247], v[212:215], v[32:35]
    ds_read_b128 a[220:223], v5 offset:15360
    v_mul_f32 v136, v52, v52
    v_mfma_f32_16x16x32_bf16 v[32:35], a[248:251], v[216:219], v[32:35]
    ds_read_b128 a[224:227], v5 offset:16384
    v_mul_f32 v137, v53, v53
    v_mfma_f32_16x16x32_bf16 v[32:35], a[252:255], v[220:223], v[32:35]
    ds_read_b128 a[228:231], v5 offset:17408
    v_mul_f32 v138, v54, v54
    v_mfma_f32_16x16x32_bf16 v[36:39], a[232:235], a[16:19], v[36:39]
    v_mul_f32 v139, v55, v55
    v_fma_f32 v136, v136, v149, v145
    v_mfma_f32_16x16x32_bf16 v[36:39], a[236:239], a[20:23], v[36:39]
    v_fma_f32 v137, v137, v149, v145
    v_fma_f32 v138, v138, v149, v145
    v_mfma_f32_16x16x32_bf16 v[36:39], a[240:243], a[24:27], v[36:39]
    v_fma_f32 v139, v139, v149, v145
    v_mul_f32 v136, v136, v52
    v_mfma_f32_16x16x32_bf16 v[36:39], a[244:247], a[28:31], v[36:39]
    v_mul_f32 v137, v137, v53
    v_mul_f32 v138, v138, v54
    v_mfma_f32_16x16x32_bf16 v[36:39], a[248:251], a[32:35], v[36:39]
    buffer_load_dwordx4 v2, s[36:39], s51 offen offset:3072 lds
    v_mul_f32 v139, v139, v55
    v_mfma_f32_16x16x32_bf16 v[36:39], a[252:255], a[36:39], v[36:39]
    v_exp_f32 v136, v136
    v_mfma_f32_16x16x32_bf16 v[40:43], a[232:235], a[88:91], v[40:43]
    v_exp_f32 v137, v137
    v_mfma_f32_16x16x32_bf16 v[40:43], a[236:239], a[92:95], v[40:43]
    v_exp_f32 v138, v138
    v_mfma_f32_16x16x32_bf16 v[40:43], a[240:243], a[96:99], v[40:43]
    v_exp_f32 v139, v139
    v_mfma_f32_16x16x32_bf16 v[40:43], a[244:247], a[100:103], v[40:43]
    v_mul_f32 v140, v52, v68
    v_mul_f32 v141, v53, v69
    v_mfma_f32_16x16x32_bf16 v[40:43], a[248:251], a[104:107], v[40:43]
    v_mul_f32 v142, v54, v70
    v_mul_f32 v143, v55, v71
    v_mfma_f32_16x16x32_bf16 v[40:43], a[252:255], a[108:111], v[40:43]
    v_fma_f32 v136, v136, v159, v159
    v_fma_f32 v137, v137, v159, v159
    v_mfma_f32_16x16x32_bf16 v[44:47], a[232:235], a[160:163], v[44:47]
    v_fma_f32 v138, v138, v159, v159
    v_fma_f32 v139, v139, v159, v159
    v_mfma_f32_16x16x32_bf16 v[44:47], a[236:239], a[164:167], v[44:47]
    s_add_u32 m0, s52, 4096
    v_mfma_f32_16x16x32_bf16 v[44:47], a[240:243], a[168:171], v[44:47]
    s_add_u32 s53, s51, 4096
    v_mfma_f32_16x16x32_bf16 v[44:47], a[244:247], a[172:175], v[44:47]
    buffer_load_dwordx4 v2, s[36:39], s53 offen offset:0 lds
    v_mfma_f32_16x16x32_bf16 v[44:47], a[248:251], a[176:179], v[44:47]
    v_rcp_f32 v136, v136
    v_mfma_f32_16x16x32_bf16 v[44:47], a[252:255], a[180:183], v[44:47]
    s_waitcnt lgkmcnt(0)
    v_mfma_f32_16x16x32_bf16 v[80:83], a[208:211], v[224:227], v[80:83]
    ds_read_b128 a[232:235], v5 offset:30720
    v_mfma_f32_16x16x32_bf16 v[80:83], a[212:215], v[228:231], v[80:83]
    ds_read_b128 a[236:239], v5 offset:31744
    v_mfma_f32_16x16x32_bf16 v[80:83], a[216:219], v[232:235], v[80:83]
    ds_read_b128 a[240:243], v5 offset:32768
    v_mfma_f32_16x16x32_bf16 v[80:83], a[220:223], v[236:239], v[80:83]
    ds_read_b128 a[244:247], v5 offset:33792
    v_mfma_f32_16x16x32_bf16 v[80:83], a[224:227], v[240:243], v[80:83]
    ds_read_b128 a[248:251], v5 offset:34816
    buffer_load_dwordx4 v2, s[36:39], s53 offen offset:1024 lds
    v_mfma_f32_16x16x32_bf16 v[80:83], a[228:231], v[244:247], v[80:83]
    ds_read_b128 a[252:255], v5 offset:35840
    v_mfma_f32_16x16x32_bf16 v[84:87], a[208:211], a[40:43], v[84:87]
    v_rcp_f32 v137, v137
    v_mfma_f32_16x16x32_bf16 v[84:87], a[212:215], a[44:47], v[84:87]
    v_rcp_f32 v138, v138
    v_mfma_f32_16x16x32_bf16 v[84:87], a[216:219], a[48:51], v[84:87]
    v_rcp_f32 v139, v139
    v_mfma_f32_16x16x32_bf16 v[84:87], a[220:223], a[52:55], v[84:87]
    v_mul_f32 v140, v140, v136
    v_mul_f32 v141, v141, v137
    v_mfma_f32_16x16x32_bf16 v[84:87], a[224:227], a[56:59], v[84:87]
    v_mul_f32 v142, v142, v138
    v_mul_f32 v143, v143, v139
    v_mfma_f32_16x16x32_bf16 v[84:87], a[228:231], a[60:63], v[84:87]
    v_cvt_pk_bf16_f32 v118, v140, v141
    v_cvt_pk_bf16_f32 v119, v142, v143
    v_mfma_f32_16x16x32_bf16 v[88:91], a[208:211], a[112:115], v[88:91]
    buffer_store_dwordx2 v[118:119], v8, s[56:59], s60 offen offset:1024 sc1
    v_mul_f32 v128, v56, v56
    v_mfma_f32_16x16x32_bf16 v[88:91], a[212:215], a[116:119], v[88:91]
    v_mul_f32 v129, v57, v57
    v_mul_f32 v130, v58, v58
    v_mfma_f32_16x16x32_bf16 v[88:91], a[216:219], a[120:123], v[88:91]
    buffer_load_dwordx4 v2, s[36:39], s53 offen offset:2048 lds
    v_mul_f32 v131, v59, v59
    v_mfma_f32_16x16x32_bf16 v[88:91], a[220:223], a[124:127], v[88:91]
    v_fma_f32 v128, v128, v150, v146
    v_fma_f32 v129, v129, v150, v146
    v_mfma_f32_16x16x32_bf16 v[88:91], a[224:227], a[128:131], v[88:91]
    v_fma_f32 v130, v130, v150, v146
    v_fma_f32 v131, v131, v150, v146
    v_mfma_f32_16x16x32_bf16 v[88:91], a[228:231], a[132:135], v[88:91]
    v_mul_f32 v128, v128, v56
    v_mul_f32 v129, v129, v57
    v_mfma_f32_16x16x32_bf16 v[92:95], a[208:211], a[184:187], v[92:95]
    v_mul_f32 v130, v130, v58
    v_mul_f32 v131, v131, v59
    v_mfma_f32_16x16x32_bf16 v[92:95], a[212:215], a[188:191], v[92:95]
    v_exp_f32 v128, v128
    v_mfma_f32_16x16x32_bf16 v[92:95], a[216:219], a[192:195], v[92:95]
    v_exp_f32 v129, v129
    v_mfma_f32_16x16x32_bf16 v[92:95], a[220:223], a[196:199], v[92:95]
    v_exp_f32 v130, v130
    v_mfma_f32_16x16x32_bf16 v[92:95], a[224:227], a[200:203], v[92:95]
    v_exp_f32 v131, v131
    v_mfma_f32_16x16x32_bf16 v[92:95], a[228:231], a[204:207], v[92:95]
    buffer_load_dwordx4 v2, s[36:39], s53 offen offset:3072 lds
    s_waitcnt lgkmcnt(0)
    v_mfma_f32_16x16x32_bf16 v[96:99], a[232:235], v[224:227], v[96:99]
    ds_read_b128 a[208:211], v2 offset:12288
    v_mul_f32 v132, v56, v72
    v_mfma_f32_16x16x32_bf16 v[96:99], a[236:239], v[228:231], v[96:99]
    ds_read_b128 a[212:215], v2 offset:13312
    v_mul_f32 v133, v57, v73
    v_mfma_f32_16x16x32_bf16 v[96:99], a[240:243], v[232:235], v[96:99]
    ds_read_b128 a[216:219], v2 offset:14336
    v_mul_f32 v134, v58, v74
    v_mfma_f32_16x16x32_bf16 v[96:99], a[244:247], v[236:239], v[96:99]
    ds_read_b128 a[220:223], v2 offset:15360
    v_mul_f32 v135, v59, v75
    v_mfma_f32_16x16x32_bf16 v[96:99], a[248:251], v[240:243], v[96:99]
    ds_read_b128 a[224:227], v2 offset:16384
    v_fma_f32 v128, v128, v163, v163
    v_mfma_f32_16x16x32_bf16 v[96:99], a[252:255], v[244:247], v[96:99]
    ds_read_b128 a[228:231], v2 offset:17408
    v_fma_f32 v129, v129, v163, v163
    v_mfma_f32_16x16x32_bf16 v[100:103], a[232:235], a[40:43], v[100:103]
    v_fma_f32 v130, v130, v163, v163
    v_fma_f32 v131, v131, v163, v163
    v_mfma_f32_16x16x32_bf16 v[100:103], a[236:239], a[44:47], v[100:103]
    v_rcp_f32 v128, v128
    v_mfma_f32_16x16x32_bf16 v[100:103], a[240:243], a[48:51], v[100:103]
    s_add_u32 m0, s52, 8192
    v_mfma_f32_16x16x32_bf16 v[100:103], a[244:247], a[52:55], v[100:103]
    s_add_u32 s53, s51, 8192
    v_mfma_f32_16x16x32_bf16 v[100:103], a[248:251], a[56:59], v[100:103]
    buffer_load_dwordx4 v2, s[36:39], s53 offen offset:0 lds
    v_mfma_f32_16x16x32_bf16 v[100:103], a[252:255], a[60:63], v[100:103]
    v_rcp_f32 v129, v129
    v_mfma_f32_16x16x32_bf16 v[104:107], a[232:235], a[112:115], v[104:107]
    v_rcp_f32 v130, v130
    v_mfma_f32_16x16x32_bf16 v[104:107], a[236:239], a[116:119], v[104:107]
    v_rcp_f32 v131, v131
    v_mfma_f32_16x16x32_bf16 v[104:107], a[240:243], a[120:123], v[104:107]
    v_mul_f32 v132, v132, v128
    v_mul_f32 v133, v133, v129
    v_mfma_f32_16x16x32_bf16 v[104:107], a[244:247], a[124:127], v[104:107]
    v_mul_f32 v134, v134, v130
    v_mul_f32 v135, v135, v131
    v_mfma_f32_16x16x32_bf16 v[104:107], a[248:251], a[128:131], v[104:107]
    v_cvt_pk_bf16_f32 v122, v132, v133
    v_cvt_pk_bf16_f32 v123, v134, v135
    v_mfma_f32_16x16x32_bf16 v[104:107], a[252:255], a[132:135], v[104:107]
    buffer_store_dwordx2 v[122:123], v8, s[56:59], s60 offen offset:2048 sc1
    v_mul_f32 v136, v60, v60
    v_mfma_f32_16x16x32_bf16 v[108:111], a[232:235], a[184:187], v[108:111]
    s_add_u32 s51, s51, 36864
    s_add_u32 s52, s52, 36864
    s_cmp_ge_u32 s52, 147456
    s_cselect_b32 s52, s50, s52
    v_mfma_f32_16x16x32_bf16 v[108:111], a[236:239], a[188:191], v[108:111]
    v_mul_f32 v137, v61, v61
    v_mul_f32 v138, v62, v62
    v_mfma_f32_16x16x32_bf16 v[108:111], a[240:243], a[192:195], v[108:111]
    v_mul_f32 v139, v63, v63
    v_fma_f32 v136, v136, v151, v147
    v_mfma_f32_16x16x32_bf16 v[108:111], a[244:247], a[196:199], v[108:111]
    v_fma_f32 v137, v137, v151, v147
    v_fma_f32 v138, v138, v151, v147
    v_mfma_f32_16x16x32_bf16 v[108:111], a[248:251], a[200:203], v[108:111]
    v_fma_f32 v139, v139, v151, v147
    v_mul_f32 v136, v136, v60
    v_mfma_f32_16x16x32_bf16 v[108:111], a[252:255], a[204:207], v[108:111]
    v_mul_f32 v137, v137, v61
    v_mul_f32 v138, v138, v62
    v_mul_f32 v139, v139, v63
    v_exp_f32 v136, v136
    v_exp_f32 v137, v137
    v_exp_f32 v138, v138
    v_exp_f32 v139, v139
    v_mul_f32 v140, v60, v76
    v_mul_f32 v141, v61, v77
    v_mul_f32 v142, v62, v78
    v_mul_f32 v143, v63, v79
    v_fma_f32 v136, v136, v167, v167
    v_fma_f32 v137, v137, v167, v167
    v_fma_f32 v138, v138, v167, v167
    v_fma_f32 v139, v139, v167, v167
    v_rcp_f32 v136, v136
    v_rcp_f32 v137, v137
    v_rcp_f32 v138, v138
    v_rcp_f32 v139, v139
    v_mul_f32 v140, v140, v136
    v_mul_f32 v141, v141, v137
    v_mul_f32 v142, v142, v138
    v_mul_f32 v143, v143, v139
    v_cvt_pk_bf16_f32 v126, v140, v141
    v_cvt_pk_bf16_f32 v127, v142, v143
    buffer_store_dwordx2 v[126:127], v8, s[56:59], s60 offen offset:3072 sc1
    s_waitcnt lgkmcnt(0)
    v_mfma_f32_16x16x32_bf16 v[16:19], a[208:211], v[224:227], v[16:19]
    ds_read_b128 a[232:235], v2 offset:30720
    v_mul_f32 v128, v80, v80
    v_mul_f32 v129, v81, v81
    v_mfma_f32_16x16x32_bf16 v[16:19], a[212:215], v[228:231], v[16:19]
    ds_read_b128 a[236:239], v2 offset:31744
    v_mul_f32 v130, v82, v82
    v_mul_f32 v131, v83, v83
    v_mfma_f32_16x16x32_bf16 v[16:19], a[216:219], v[232:235], v[16:19]
    ds_read_b128 a[240:243], v2 offset:32768
    v_fma_f32 v128, v128, v148, v144
    v_fma_f32 v129, v129, v148, v144
    v_mfma_f32_16x16x32_bf16 v[16:19], a[220:223], v[236:239], v[16:19]
    ds_read_b128 a[244:247], v2 offset:33792
    v_fma_f32 v130, v130, v148, v144
    v_fma_f32 v131, v131, v148, v144
    v_mfma_f32_16x16x32_bf16 v[16:19], a[224:227], v[240:243], v[16:19]
    ds_read_b128 a[248:251], v2 offset:34816
    v_mul_f32 v128, v128, v80
    v_mul_f32 v129, v129, v81
    v_mfma_f32_16x16x32_bf16 v[16:19], a[228:231], v[244:247], v[16:19]
    ds_read_b128 a[252:255], v2 offset:35840
    v_mul_f32 v130, v130, v82
    v_mul_f32 v131, v131, v83
    v_mfma_f32_16x16x32_bf16 v[20:23], a[208:211], a[40:43], v[20:23]
    v_exp_f32 v128, v128
    v_mfma_f32_16x16x32_bf16 v[20:23], a[212:215], a[44:47], v[20:23]
    v_exp_f32 v129, v129
    v_mfma_f32_16x16x32_bf16 v[20:23], a[216:219], a[48:51], v[20:23]
    v_exp_f32 v130, v130
    v_mfma_f32_16x16x32_bf16 v[20:23], a[220:223], a[52:55], v[20:23]
    v_exp_f32 v131, v131
    v_mul_f32 v132, v80, v96
    v_mfma_f32_16x16x32_bf16 v[20:23], a[224:227], a[56:59], v[20:23]
    v_mul_f32 v133, v81, v97
    v_mul_f32 v134, v82, v98
    v_mul_f32 v135, v83, v99
    v_mfma_f32_16x16x32_bf16 v[20:23], a[228:231], a[60:63], v[20:23]
    v_fma_f32 v128, v128, v155, v155
    v_fma_f32 v129, v129, v155, v155
    v_fma_f32 v130, v130, v155, v155
    v_mfma_f32_16x16x32_bf16 v[24:27], a[208:211], a[112:115], v[24:27]
    v_fma_f32 v131, v131, v155, v155
    v_rcp_f32 v128, v128
    v_mfma_f32_16x16x32_bf16 v[24:27], a[212:215], a[116:119], v[24:27]
    v_rcp_f32 v129, v129
    v_mfma_f32_16x16x32_bf16 v[24:27], a[216:219], a[120:123], v[24:27]
    v_rcp_f32 v130, v130
    v_mfma_f32_16x16x32_bf16 v[24:27], a[220:223], a[124:127], v[24:27]
    v_rcp_f32 v131, v131
    v_mul_f32 v132, v132, v128
    v_mfma_f32_16x16x32_bf16 v[24:27], a[224:227], a[128:131], v[24:27]
    v_mul_f32 v133, v133, v129
    v_mul_f32 v134, v134, v130
    v_mul_f32 v135, v135, v131
    v_mfma_f32_16x16x32_bf16 v[24:27], a[228:231], a[132:135], v[24:27]
    v_cvt_pk_bf16_f32 v112, v132, v133
    v_cvt_pk_bf16_f32 v113, v134, v135
    v_mul_f32 v136, v84, v84
    v_mfma_f32_16x16x32_bf16 v[28:31], a[208:211], a[184:187], v[28:31]
    v_mul_f32 v137, v85, v85
    v_mul_f32 v138, v86, v86
    v_mul_f32 v139, v87, v87
    v_mfma_f32_16x16x32_bf16 v[28:31], a[212:215], a[188:191], v[28:31]
    v_fma_f32 v136, v136, v149, v145
    v_fma_f32 v137, v137, v149, v145
    v_fma_f32 v138, v138, v149, v145
    v_mfma_f32_16x16x32_bf16 v[28:31], a[216:219], a[192:195], v[28:31]
    v_fma_f32 v139, v139, v149, v145
    v_mul_f32 v136, v136, v84
    v_mul_f32 v137, v137, v85
    v_mfma_f32_16x16x32_bf16 v[28:31], a[220:223], a[196:199], v[28:31]
    v_mul_f32 v138, v138, v86
    v_mul_f32 v139, v139, v87
    v_mfma_f32_16x16x32_bf16 v[28:31], a[224:227], a[200:203], v[28:31]
    v_exp_f32 v136, v136
    v_mfma_f32_16x16x32_bf16 v[28:31], a[228:231], a[204:207], v[28:31]
    v_exp_f32 v137, v137
    s_waitcnt lgkmcnt(0)
    v_mfma_f32_16x16x32_bf16 v[32:35], a[232:235], v[224:227], v[32:35]
    s_waitcnt vmcnt(15)
    s_barrier
    v_mfma_f32_16x16x32_bf16 v[32:35], a[236:239], v[228:231], v[32:35]
    s_mov_b32 s55, 36864
    v_add_u32 v3, 36864, v2
    v_mfma_f32_16x16x32_bf16 v[32:35], a[240:243], v[232:235], v[32:35]
    ds_read_b128 a[208:211], v3 offset:0
    v_exp_f32 v138, v138
    v_mfma_f32_16x16x32_bf16 v[32:35], a[244:247], v[236:239], v[32:35]
    ds_read_b128 a[212:215], v3 offset:1024
    v_exp_f32 v139, v139
    v_mfma_f32_16x16x32_bf16 v[32:35], a[248:251], v[240:243], v[32:35]
    ds_read_b128 a[216:219], v3 offset:2048
    s_add_u32 m0, s52, 0
    v_mul_f32 v140, v84, v100
    v_mfma_f32_16x16x32_bf16 v[32:35], a[252:255], v[244:247], v[32:35]
    ds_read_b128 a[220:223], v3 offset:3072
    buffer_load_dwordx4 v2, s[36:39], s51 offen offset:0 lds
    v_mul_f32 v141, v85, v101
    v_mfma_f32_16x16x32_bf16 v[36:39], a[232:235], a[40:43], v[36:39]
    ds_read_b128 a[224:227], v3 offset:4096
    buffer_load_dwordx4 v2, s[36:39], s51 offen offset:1024 lds
    v_mul_f32 v142, v86, v102
    v_mfma_f32_16x16x32_bf16 v[36:39], a[236:239], a[44:47], v[36:39]
    ds_read_b128 a[228:231], v3 offset:5120
    v_mul_f32 v143, v87, v103
    v_fma_f32 v136, v136, v159, v159
    v_mfma_f32_16x16x32_bf16 v[36:39], a[240:243], a[48:51], v[36:39]
    buffer_load_dwordx4 v2, s[36:39], s51 offen offset:2048 lds
    v_fma_f32 v137, v137, v159, v159
    v_fma_f32 v138, v138, v159, v159
    v_mfma_f32_16x16x32_bf16 v[36:39], a[244:247], a[52:55], v[36:39]
    v_fma_f32 v139, v139, v159, v159
    v_rcp_f32 v136, v136
    v_mfma_f32_16x16x32_bf16 v[36:39], a[248:251], a[56:59], v[36:39]
    buffer_load_dwordx4 v2, s[36:39], s51 offen offset:3072 lds
    v_rcp_f32 v137, v137
    v_mfma_f32_16x16x32_bf16 v[36:39], a[252:255], a[60:63], v[36:39]
    v_rcp_f32 v138, v138
    v_mfma_f32_16x16x32_bf16 v[40:43], a[232:235], a[112:115], v[40:43]
    s_add_u32 m0, s52, 4096
    v_rcp_f32 v139, v139
    v_mfma_f32_16x16x32_bf16 v[40:43], a[236:239], a[116:119], v[40:43]
    s_add_u32 s53, s51, 4096
    v_mul_f32 v140, v140, v136
    v_mul_f32 v141, v141, v137
    v_mfma_f32_16x16x32_bf16 v[40:43], a[240:243], a[120:123], v[40:43]
    buffer_load_dwordx4 v2, s[36:39], s53 offen offset:0 lds
    buffer_load_dwordx4 v2, s[36:39], s53 offen offset:1024 lds
    v_mul_f32 v142, v142, v138
    v_mfma_f32_16x16x32_bf16 v[40:43], a[244:247], a[124:127], v[40:43]
    v_mul_f32 v143, v143, v139
    v_cvt_pk_bf16_f32 v116, v140, v141
    v_cvt_pk_bf16_f32 v117, v142, v143
    v_mfma_f32_16x16x32_bf16 v[40:43], a[248:251], a[128:131], v[40:43]
    buffer_load_dwordx4 v2, s[36:39], s53 offen offset:2048 lds
    v_mul_f32 v128, v88, v88
    v_mul_f32 v129, v89, v89
    v_mfma_f32_16x16x32_bf16 v[40:43], a[252:255], a[132:135], v[40:43]
    v_mul_f32 v130, v90, v90
    v_mul_f32 v131, v91, v91
    v_fma_f32 v128, v128, v150, v146
    v_mfma_f32_16x16x32_bf16 v[44:47], a[232:235], a[184:187], v[44:47]
    buffer_load_dwordx4 v2, s[36:39], s53 offen offset:3072 lds
    v_fma_f32 v129, v129, v150, v146
    v_fma_f32 v130, v130, v150, v146
    v_mfma_f32_16x16x32_bf16 v[44:47], a[236:239], a[188:191], v[44:47]
    v_fma_f32 v131, v131, v150, v146
    v_mul_f32 v128, v128, v88
    v_mul_f32 v129, v129, v89
    v_mfma_f32_16x16x32_bf16 v[44:47], a[240:243], a[192:195], v[44:47]
    s_add_u32 m0, s52, 8192
    v_mul_f32 v130, v130, v90
    v_mul_f32 v131, v131, v91
    v_mfma_f32_16x16x32_bf16 v[44:47], a[244:247], a[196:199], v[44:47]
    s_add_u32 s53, s51, 8192
    v_exp_f32 v128, v128
    v_mfma_f32_16x16x32_bf16 v[44:47], a[248:251], a[200:203], v[44:47]
    buffer_load_dwordx4 v2, s[36:39], s53 offen offset:0 lds
    s_add_u32 s51, s51, 36864
    s_add_u32 s52, s52, 36864
    s_cmp_ge_u32 s52, 147456
    s_cselect_b32 s52, s50, s52
    v_mfma_f32_16x16x32_bf16 v[44:47], a[252:255], a[204:207], v[44:47]
    v_exp_f32 v129, v129
    v_exp_f32 v130, v130
    v_exp_f32 v131, v131
    v_mul_f32 v132, v88, v104
    v_mul_f32 v133, v89, v105
    v_mul_f32 v134, v90, v106
    v_mul_f32 v135, v91, v107
    v_fma_f32 v128, v128, v163, v163
    v_fma_f32 v129, v129, v163, v163
    v_fma_f32 v130, v130, v163, v163
    v_fma_f32 v131, v131, v163, v163
    v_rcp_f32 v128, v128
    v_rcp_f32 v129, v129
    v_rcp_f32 v130, v130
    v_rcp_f32 v131, v131
    v_mul_f32 v132, v132, v128
    v_mul_f32 v133, v133, v129
    v_mul_f32 v134, v134, v130
    v_mul_f32 v135, v135, v131
    v_cvt_pk_bf16_f32 v120, v132, v133
    v_cvt_pk_bf16_f32 v121, v134, v135
    v_mul_f32 v136, v92, v92
    v_mul_f32 v137, v93, v93
    v_mul_f32 v138, v94, v94
    v_mul_f32 v139, v95, v95
    v_fma_f32 v136, v136, v151, v147
    v_fma_f32 v137, v137, v151, v147
    v_fma_f32 v138, v138, v151, v147
    v_fma_f32 v139, v139, v151, v147
    v_mul_f32 v136, v136, v92
    v_mul_f32 v137, v137, v93
    v_mul_f32 v138, v138, v94
    v_mul_f32 v139, v139, v95
    v_exp_f32 v136, v136
    v_exp_f32 v137, v137
    v_exp_f32 v138, v138
    v_exp_f32 v139, v139
    v_mul_f32 v140, v92, v108
    v_mul_f32 v141, v93, v109
    v_mul_f32 v142, v94, v110
    v_mul_f32 v143, v95, v111
    v_fma_f32 v136, v136, v167, v167
    v_fma_f32 v137, v137, v167, v167
    v_fma_f32 v138, v138, v167, v167
    v_fma_f32 v139, v139, v167, v167
    v_rcp_f32 v136, v136
    v_rcp_f32 v137, v137
    v_rcp_f32 v138, v138
    v_rcp_f32 v139, v139
    v_mul_f32 v140, v140, v136
    v_mul_f32 v141, v141, v137
    v_mul_f32 v142, v142, v138
    v_mul_f32 v143, v143, v139
    v_cvt_pk_bf16_f32 v124, v140, v141
    v_cvt_pk_bf16_f32 v125, v142, v143
    s_mov_b32 s66, 0
    s_branch LF_h2
.p2align 3
LF_loop4:
    s_cmp_lg_u32 s66, 2
    s_cbranch_scc1 LF_h1
    s_add_u32 s36, s26, s64
    s_addc_u32 s37, s27, 0
    s_mov_b32 s51, s50
LF_h1:
    s_waitcnt vmcnt(5) lgkmcnt(0)
    v_mfma_f32_16x16x32_bf16 v[16:19], v[168:171], v[152:155], 0
    ds_read_b128 a[232:235], v3 offset:18432
    v_mfma_f32_16x16x32_bf16 v[16:19], a[208:211], v[176:179], v[16:19]
    ds_read_b128 a[236:239], v3 offset:19456
    v_mfma_f32_16x16x32_bf16 v[16:19], a[212:215], v[180:183], v[16:19]
    ds_read_b128 a[240:243], v3 offset:20480
    v_mfma_f32_16x16x32_bf16 v[16:19], a[216:219], v[184:187], v[16:19]
    ds_read_b128 a[244:247], v3 offset:21504
    v_mfma_f32_16x16x32_bf16 v[16:19], a[220:223], v[188:191], v[16:19]
    ds_read_b128 a[248:251], v3 offset:22528
    v_mfma_f32_16x16x32_bf16 v[16:19], a[224:227], v[192:195], v[16:19]
    ds_read_b128 a[252:255], v3 offset:23552
    v_mfma_f32_16x16x32_bf16 v[16:19], a[228:231], v[196:199], v[16:19]
    v_mfma_f32_16x16x32_bf16 v[20:23], v[168:171], v[156:159], 0
    v_mfma_f32_16x16x32_bf16 v[20:23], a[208:211], v[248:251], v[20:23]
    s_add_u32 m0, s52, 0
    v_mul_f32 v128, v48, v48
    v_mfma_f32_16x16x32_bf16 v[20:23], a[212:215], v[252:255], v[20:23]
    buffer_load_dwordx4 v2, s[36:39], s51 offen offset:0 lds
    v_mul_f32 v129, v49, v49
    v_mfma_f32_16x16x32_bf16 v[20:23], a[216:219], a[0:3], v[20:23]
    v_mul_f32 v130, v50, v50
    v_mul_f32 v131, v51, v51
    v_mfma_f32_16x16x32_bf16 v[20:23], a[220:223], a[4:7], v[20:23]
    v_fma_f32 v128, v128, v148, v144
    v_fma_f32 v129, v129, v148, v144
    v_mfma_f32_16x16x32_bf16 v[20:23], a[224:227], a[8:11], v[20:23]
    v_fma_f32 v130, v130, v148, v144
    v_fma_f32 v131, v131, v148, v144
    v_mfma_f32_16x16x32_bf16 v[20:23], a[228:231], a[12:15], v[20:23]
    v_mul_f32 v128, v128, v48
    v_mul_f32 v129, v129, v49
    v_mfma_f32_16x16x32_bf16 v[24:27], v[168:171], v[160:163], 0
    v_mul_f32 v130, v130, v50
    v_mul_f32 v131, v131, v51
    v_mfma_f32_16x16x32_bf16 v[24:27], a[208:211], a[64:67], v[24:27]
    v_exp_f32 v128, v128
    v_mfma_f32_16x16x32_bf16 v[24:27], a[212:215], a[68:71], v[24:27]
    v_exp_f32 v129, v129
    v_mfma_f32_16x16x32_bf16 v[24:27], a[216:219], a[72:75], v[24:27]
    v_exp_f32 v130, v130
    v_mfma_f32_16x16x32_bf16 v[24:27], a[220:223], a[76:79], v[24:27]
    v_exp_f32 v131, v131
    v_mfma_f32_16x16x32_bf16 v[24:27], a[224:227], a[80:83], v[24:27]
    v_mul_f32 v132, v48, v64
    v_mul_f32 v133, v49, v65
    v_mfma_f32_16x16x32_bf16 v[24:27], a[228:231], a[84:87], v[24:27]
    buffer_load_dwordx4 v2, s[36:39], s51 offen offset:1024 lds
    v_mul_f32 v134, v50, v66
    v_mfma_f32_16x16x32_bf16 v[28:31], v[168:171], v[164:167], 0
    v_mul_f32 v135, v51, v67
    v_fma_f32 v128, v128, v155, v155
    v_mfma_f32_16x16x32_bf16 v[28:31], a[208:211], a[136:139], v[28:31]
    v_fma_f32 v129, v129, v155, v155
    v_fma_f32 v130, v130, v155, v155
    v_mfma_f32_16x16x32_bf16 v[28:31], a[212:215], a[140:143], v[28:31]
    v_fma_f32 v131, v131, v155, v155
    v_mfma_f32_16x16x32_bf16 v[28:31], a[216:219], a[144:147], v[28:31]
    v_rcp_f32 v128, v128
    v_mfma_f32_16x16x32_bf16 v[28:31], a[220:223], a[148:151], v[28:31]
    v_rcp_f32 v129, v129
    v_mfma_f32_16x16x32_bf16 v[28:31], a[224:227], a[152:155], v[28:31]
    v_rcp_f32 v130, v130
    v_mfma_f32_16x16x32_bf16 v[28:31], a[228:231], a[156:159], v[28:31]
    s_waitcnt lgkmcnt(0)
    v_mfma_f32_16x16x32_bf16 v[32:35], v[172:175], v[152:155], 0
    ds_read_b128 a[208:211], v3 offset:6144
    v_mfma_f32_16x16x32_bf16 v[32:35], a[232:235], v[176:179], v[32:35]
    ds_read_b128 a[212:215], v3 offset:7168
    v_mfma_f32_16x16x32_bf16 v[32:35], a[236:239], v[180:183], v[32:35]
    ds_read_b128 a[216:219], v3 offset:8192
    v_mfma_f32_16x16x32_bf16 v[32:35], a[240:243], v[184:187], v[32:35]
    ds_read_b128 a[220:223], v3 offset:9216
    v_mfma_f32_16x16x32_bf16 v[32:35], a[244:247], v[188:191], v[32:35]
    ds_read_b128 a[224:227], v3 offset:10240
    buffer_load_dwordx4 v2, s[36:39], s51 offen offset:2048 lds
    v_mfma_f32_16x16x32_bf16 v[32:35], a[248:251], v[192:195], v[32:35]
    ds_read_b128 a[228:231], v3 offset:11264
    v_mfma_f32_16x16x32_bf16 v[32:35], a[252:255], v[196:199], v[32:35]
    v_rcp_f32 v131, v131
    v_mfma_f32_16x16x32_bf16 v[36:39], v[172:175], v[156:159], 0
    v_mul_f32 v132, v132, v128
    v_mul_f32 v133, v133, v129
    v_mfma_f32_16x16x32_bf16 v[36:39], a[232:235], v[248:251], v[36:39]
    v_mul_f32 v134, v134, v130
    v_mul_f32 v135, v135, v131
    v_mfma_f32_16x16x32_bf16 v[36:39], a[236:239], v[252:255], v[36:39]
    v_cvt_pk_bf16_f32 v112, v132, v133
    v_cvt_pk_bf16_f32 v113, v134, v135
    v_mfma_f32_16x16x32_bf16 v[36:39], a[240:243], a[0:3], v[36:39]
    v_mul_f32 v136, v52, v52
    v_mul_f32 v137, v53, v53
    v_mfma_f32_16x16x32_bf16 v[36:39], a[244:247], a[4:7], v[36:39]
    v_mul_f32 v138, v54, v54
    v_mul_f32 v139, v55, v55
    v_mfma_f32_16x16x32_bf16 v[36:39], a[248:251], a[8:11], v[36:39]
    v_fma_f32 v136, v136, v149, v145
    v_fma_f32 v137, v137, v149, v145
    v_mfma_f32_16x16x32_bf16 v[36:39], a[252:255], a[12:15], v[36:39]
    v_fma_f32 v138, v138, v149, v145
    v_fma_f32 v139, v139, v149, v145
    v_mfma_f32_16x16x32_bf16 v[40:43], v[172:175], v[160:163], 0
    v_mul_f32 v136, v136, v52
    v_mul_f32 v137, v137, v53
    v_mfma_f32_16x16x32_bf16 v[40:43], a[232:235], a[64:67], v[40:43]
    v_mul_f32 v138, v138, v54
    v_mul_f32 v139, v139, v55
    v_mfma_f32_16x16x32_bf16 v[40:43], a[236:239], a[68:71], v[40:43]
    v_exp_f32 v136, v136
    v_mfma_f32_16x16x32_bf16 v[40:43], a[240:243], a[72:75], v[40:43]
    buffer_load_dwordx4 v2, s[36:39], s51 offen offset:3072 lds
    v_mfma_f32_16x16x32_bf16 v[40:43], a[244:247], a[76:79], v[40:43]
    v_exp_f32 v137, v137
    v_mfma_f32_16x16x32_bf16 v[40:43], a[248:251], a[80:83], v[40:43]
    v_exp_f32 v138, v138
    v_mfma_f32_16x16x32_bf16 v[40:43], a[252:255], a[84:87], v[40:43]
    v_exp_f32 v139, v139
    v_mfma_f32_16x16x32_bf16 v[44:47], v[172:175], v[164:167], 0
    v_mul_f32 v140, v52, v68
    v_mul_f32 v141, v53, v69
    v_mfma_f32_16x16x32_bf16 v[44:47], a[232:235], a[136:139], v[44:47]
    v_mul_f32 v142, v54, v70
    v_mul_f32 v143, v55, v71
    v_mfma_f32_16x16x32_bf16 v[44:47], a[236:239], a[140:143], v[44:47]
    v_fma_f32 v136, v136, v159, v159
    v_fma_f32 v137, v137, v159, v159
    v_mfma_f32_16x16x32_bf16 v[44:47], a[240:243], a[144:147], v[44:47]
    v_fma_f32 v138, v138, v159, v159
    v_fma_f32 v139, v139, v159, v159
    v_mfma_f32_16x16x32_bf16 v[44:47], a[244:247], a[148:151], v[44:47]
    v_rcp_f32 v136, v136
    v_mfma_f32_16x16x32_bf16 v[44:47], a[248:251], a[152:155], v[44:47]
    v_rcp_f32 v137, v137
    v_mfma_f32_16x16x32_bf16 v[44:47], a[252:255], a[156:159], v[44:47]
    s_waitcnt lgkmcnt(0)
    v_mfma_f32_16x16x32_bf16 v[16:19], a[208:211], v[200:203], v[16:19]
    ds_read_b128 a[232:235], v3 offset:24576
    v_mfma_f32_16x16x32_bf16 v[16:19], a[212:215], v[204:207], v[16:19]
    ds_read_b128 a[236:239], v3 offset:25600
    s_add_u32 m0, s52, 4096
    v_mfma_f32_16x16x32_bf16 v[16:19], a[216:219], v[208:211], v[16:19]
    ds_read_b128 a[240:243], v3 offset:26624
    s_add_u32 s53, s51, 4096
    v_mfma_f32_16x16x32_bf16 v[16:19], a[220:223], v[212:215], v[16:19]
    ds_read_b128 a[244:247], v3 offset:27648
    buffer_load_dwordx4 v2, s[36:39], s53 offen offset:0 lds
    v_mfma_f32_16x16x32_bf16 v[16:19], a[224:227], v[216:219], v[16:19]
    ds_read_b128 a[248:251], v3 offset:28672
    v_mfma_f32_16x16x32_bf16 v[16:19], a[228:231], v[220:223], v[16:19]
    ds_read_b128 a[252:255], v3 offset:29696
    v_mfma_f32_16x16x32_bf16 v[20:23], a[208:211], a[16:19], v[20:23]
    v_rcp_f32 v138, v138
    v_mfma_f32_16x16x32_bf16 v[20:23], a[212:215], a[20:23], v[20:23]
    v_rcp_f32 v139, v139
    v_mfma_f32_16x16x32_bf16 v[20:23], a[216:219], a[24:27], v[20:23]
    v_mul_f32 v140, v140, v136
    v_mul_f32 v141, v141, v137
    v_mfma_f32_16x16x32_bf16 v[20:23], a[220:223], a[28:31], v[20:23]
    buffer_load_dwordx4 v[168:171], v4, s[40:43], s54 offen
    v_mul_f32 v142, v142, v138
    v_mfma_f32_16x16x32_bf16 v[20:23], a[224:227], a[32:35], v[20:23]
    v_mul_f32 v143, v143, v139
    v_cvt_pk_bf16_f32 v116, v140, v141
    v_mfma_f32_16x16x32_bf16 v[20:23], a[228:231], a[36:39], v[20:23]
    v_cvt_pk_bf16_f32 v117, v142, v143
    v_mul_f32 v128, v56, v56
    v_mfma_f32_16x16x32_bf16 v[24:27], a[208:211], a[88:91], v[24:27]
    v_mul_f32 v129, v57, v57
    v_mul_f32 v130, v58, v58
    v_mfma_f32_16x16x32_bf16 v[24:27], a[212:215], a[92:95], v[24:27]
    v_mul_f32 v131, v59, v59
    v_fma_f32 v128, v128, v150, v146
    v_mfma_f32_16x16x32_bf16 v[24:27], a[216:219], a[96:99], v[24:27]
    buffer_load_dwordx4 v2, s[36:39], s53 offen offset:1024 lds
    v_fma_f32 v129, v129, v150, v146
    v_mfma_f32_16x16x32_bf16 v[24:27], a[220:223], a[100:103], v[24:27]
    buffer_load_dwordx4 v[172:175], v4, s[40:43], s54 offen offset:512
    v_fma_f32 v130, v130, v150, v146
    v_mfma_f32_16x16x32_bf16 v[24:27], a[224:227], a[104:107], v[24:27]
    v_fma_f32 v131, v131, v150, v146
    v_mul_f32 v128, v128, v56
    v_mfma_f32_16x16x32_bf16 v[24:27], a[228:231], a[108:111], v[24:27]
    v_mul_f32 v129, v129, v57
    v_mul_f32 v130, v130, v58
    v_mfma_f32_16x16x32_bf16 v[28:31], a[208:211], a[160:163], v[28:31]
    v_mul_f32 v131, v131, v59
    v_mfma_f32_16x16x32_bf16 v[28:31], a[212:215], a[164:167], v[28:31]
    v_exp_f32 v128, v128
    v_mfma_f32_16x16x32_bf16 v[28:31], a[216:219], a[168:171], v[28:31]
    v_exp_f32 v129, v129
    v_mfma_f32_16x16x32_bf16 v[28:31], a[220:223], a[172:175], v[28:31]
    s_add_u32 s54, s54, 1024
    v_mfma_f32_16x16x32_bf16 v[28:31], a[224:227], a[176:179], v[28:31]
    v_exp_f32 v130, v130
    v_mfma_f32_16x16x32_bf16 v[28:31], a[228:231], a[180:183], v[28:31]
    s_waitcnt lgkmcnt(0)
    v_mfma_f32_16x16x32_bf16 v[32:35], a[232:235], v[200:203], v[32:35]
    ds_read_b128 a[208:211], v3 offset:12288
    v_mfma_f32_16x16x32_bf16 v[32:35], a[236:239], v[204:207], v[32:35]
    ds_read_b128 a[212:215], v3 offset:13312
    v_mfma_f32_16x16x32_bf16 v[32:35], a[240:243], v[208:211], v[32:35]
    ds_read_b128 a[216:219], v3 offset:14336
    buffer_load_dwordx4 v2, s[36:39], s53 offen offset:2048 lds
    v_mfma_f32_16x16x32_bf16 v[32:35], a[244:247], v[212:215], v[32:35]
    ds_read_b128 a[220:223], v3 offset:15360
    v_mfma_f32_16x16x32_bf16 v[32:35], a[248:251], v[216:219], v[32:35]
    ds_read_b128 a[224:227], v3 offset:16384
    v_mfma_f32_16x16x32_bf16 v[32:35], a[252:255], v[220:223], v[32:35]
    ds_read_b128 a[228:231], v3 offset:17408
    v_mfma_f32_16x16x32_bf16 v[36:39], a[232:235], a[16:19], v[36:39]
    v_exp_f32 v131, v131
    v_mfma_f32_16x16x32_bf16 v[36:39], a[236:239], a[20:23], v[36:39]
    v_mul_f32 v132, v56, v72
    v_mul_f32 v133, v57, v73
    v_mfma_f32_16x16x32_bf16 v[36:39], a[240:243], a[24:27], v[36:39]
    s_cmp_eq_u32 s66, 3
    s_cselect_b32 s63, s18, 0x40000000
    v_mfma_f32_16x16x32_bf16 v[36:39], a[244:247], a[28:31], v[36:39]
    s_waitcnt vmcnt(9)
    v_mul_f32 v134, v58, v74
    v_mfma_f32_16x16x32_bf16 v[36:39], a[248:251], a[32:35], v[36:39]
    buffer_atomic_add v14, v15, s[12:15], s63 offen sc1
    v_mul_f32 v135, v59, v75
    v_mfma_f32_16x16x32_bf16 v[36:39], a[252:255], a[36:39], v[36:39]
    v_fma_f32 v128, v128, v163, v163
    v_fma_f32 v129, v129, v163, v163
    v_mfma_f32_16x16x32_bf16 v[40:43], a[232:235], a[88:91], v[40:43]
    v_fma_f32 v130, v130, v163, v163
    v_fma_f32 v131, v131, v163, v163
    v_mfma_f32_16x16x32_bf16 v[40:43], a[236:239], a[92:95], v[40:43]
    v_rcp_f32 v128, v128
    v_mfma_f32_16x16x32_bf16 v[40:43], a[240:243], a[96:99], v[40:43]
    v_rcp_f32 v129, v129
    v_mfma_f32_16x16x32_bf16 v[40:43], a[244:247], a[100:103], v[40:43]
    buffer_load_dwordx4 v2, s[36:39], s53 offen offset:3072 lds
    v_mfma_f32_16x16x32_bf16 v[40:43], a[248:251], a[104:107], v[40:43]
    v_rcp_f32 v130, v130
    v_mfma_f32_16x16x32_bf16 v[40:43], a[252:255], a[108:111], v[40:43]
    v_rcp_f32 v131, v131
    v_mfma_f32_16x16x32_bf16 v[44:47], a[232:235], a[160:163], v[44:47]
    v_mul_f32 v132, v132, v128
    v_mul_f32 v133, v133, v129
    v_mfma_f32_16x16x32_bf16 v[44:47], a[236:239], a[164:167], v[44:47]
    v_mul_f32 v134, v134, v130
    v_mul_f32 v135, v135, v131
    v_mfma_f32_16x16x32_bf16 v[44:47], a[240:243], a[168:171], v[44:47]
    v_cvt_pk_bf16_f32 v120, v132, v133
    v_cvt_pk_bf16_f32 v121, v134, v135
    v_mfma_f32_16x16x32_bf16 v[44:47], a[244:247], a[172:175], v[44:47]
    v_mul_f32 v136, v60, v60
    v_mul_f32 v137, v61, v61
    v_mfma_f32_16x16x32_bf16 v[44:47], a[248:251], a[176:179], v[44:47]
    v_mul_f32 v138, v62, v62
    v_mul_f32 v139, v63, v63
    v_mfma_f32_16x16x32_bf16 v[44:47], a[252:255], a[180:183], v[44:47]
    v_fma_f32 v136, v136, v151, v147
    s_waitcnt lgkmcnt(0)
    v_mfma_f32_16x16x32_bf16 v[16:19], a[208:211], v[224:227], v[16:19]
    ds_read_b128 a[232:235], v3 offset:30720
    v_fma_f32 v137, v137, v151, v147
    v_mfma_f32_16x16x32_bf16 v[16:19], a[212:215], v[228:231], v[16:19]
    ds_read_b128 a[236:239], v3 offset:31744
    v_fma_f32 v138, v138, v151, v147
    v_mfma_f32_16x16x32_bf16 v[16:19], a[216:219], v[232:235], v[16:19]
    ds_read_b128 a[240:243], v3 offset:32768
    v_fma_f32 v139, v139, v151, v147
    v_mfma_f32_16x16x32_bf16 v[16:19], a[220:223], v[236:239], v[16:19]
    ds_read_b128 a[244:247], v3 offset:33792
    s_add_u32 m0, s52, 8192
    v_mfma_f32_16x16x32_bf16 v[16:19], a[224:227], v[240:243], v[16:19]
    ds_read_b128 a[248:251], v3 offset:34816
    s_add_u32 s53, s51, 8192
    v_mfma_f32_16x16x32_bf16 v[16:19], a[228:231], v[244:247], v[16:19]
    ds_read_b128 a[252:255], v3 offset:35840
    buffer_load_dwordx4 v2, s[36:39], s53 offen offset:0 lds
    v_mfma_f32_16x16x32_bf16 v[20:23], a[208:211], a[40:43], v[20:23]
    v_mul_f32 v136, v136, v60
    v_mul_f32 v137, v137, v61
    v_mfma_f32_16x16x32_bf16 v[20:23], a[212:215], a[44:47], v[20:23]
    v_mul_f32 v138, v138, v62
    v_mul_f32 v139, v139, v63
    v_mfma_f32_16x16x32_bf16 v[20:23], a[216:219], a[48:51], v[20:23]
    v_exp_f32 v136, v136
    v_mfma_f32_16x16x32_bf16 v[20:23], a[220:223], a[52:55], v[20:23]
    v_exp_f32 v137, v137
    v_mfma_f32_16x16x32_bf16 v[20:23], a[224:227], a[56:59], v[20:23]
    v_exp_f32 v138, v138
    v_mfma_f32_16x16x32_bf16 v[20:23], a[228:231], a[60:63], v[20:23]
    v_exp_f32 v139, v139
    v_mfma_f32_16x16x32_bf16 v[24:27], a[208:211], a[112:115], v[24:27]
    v_mul_f32 v140, v60, v76
    v_mul_f32 v141, v61, v77
    v_mfma_f32_16x16x32_bf16 v[24:27], a[212:215], a[116:119], v[24:27]
    v_mul_f32 v142, v62, v78
    v_mul_f32 v143, v63, v79
    v_mfma_f32_16x16x32_bf16 v[24:27], a[216:219], a[120:123], v[24:27]
    v_fma_f32 v136, v136, v167, v167
    v_fma_f32 v137, v137, v167, v167
    v_mfma_f32_16x16x32_bf16 v[24:27], a[220:223], a[124:127], v[24:27]
    v_fma_f32 v138, v138, v167, v167
    v_fma_f32 v139, v139, v167, v167
    v_mfma_f32_16x16x32_bf16 v[24:27], a[224:227], a[128:131], v[24:27]
    s_add_u32 s51, s51, 36864
    s_add_u32 s52, s52, 36864
    s_cmp_ge_u32 s52, 147456
    s_cselect_b32 s52, s50, s52
    v_mfma_f32_16x16x32_bf16 v[24:27], a[228:231], a[132:135], v[24:27]
    v_rcp_f32 v136, v136
    v_mfma_f32_16x16x32_bf16 v[28:31], a[208:211], a[184:187], v[28:31]
    v_rcp_f32 v137, v137
    v_mfma_f32_16x16x32_bf16 v[28:31], a[212:215], a[188:191], v[28:31]
    v_rcp_f32 v138, v138
    v_mfma_f32_16x16x32_bf16 v[28:31], a[216:219], a[192:195], v[28:31]
    v_rcp_f32 v139, v139
    v_mfma_f32_16x16x32_bf16 v[28:31], a[220:223], a[196:199], v[28:31]
    v_mul_f32 v140, v140, v136
    v_mul_f32 v141, v141, v137
    v_mfma_f32_16x16x32_bf16 v[28:31], a[224:227], a[200:203], v[28:31]
    v_mul_f32 v142, v142, v138
    v_mul_f32 v143, v143, v139
    v_mfma_f32_16x16x32_bf16 v[28:31], a[228:231], a[204:207], v[28:31]
    v_cvt_pk_bf16_f32 v124, v140, v141
    s_waitcnt lgkmcnt(0)
    v_mfma_f32_16x16x32_bf16 v[32:35], a[232:235], v[224:227], v[32:35]
    s_waitcnt vmcnt(12)
    s_barrier
    v_mfma_f32_16x16x32_bf16 v[32:35], a[236:239], v[228:231], v[32:35]
    s_add_u32 s55, s55, 36864
    s_cmp_ge_u32 s55, 147456
    s_cselect_b32 s55, 0, s55
    v_mfma_f32_16x16x32_bf16 v[32:35], a[240:243], v[232:235], v[32:35]
    v_add_u32 v3, s55, v2
    v_cvt_pk_bf16_f32 v125, v142, v143
    v_mfma_f32_16x16x32_bf16 v[32:35], a[244:247], v[236:239], v[32:35]
    ds_read_b128 a[208:211], v3 offset:0
    v_mfma_f32_16x16x32_bf16 v[32:35], a[248:251], v[240:243], v[32:35]
    ds_read_b128 a[212:215], v3 offset:1024
    v_mfma_f32_16x16x32_bf16 v[32:35], a[252:255], v[244:247], v[32:35]
    ds_read_b128 a[216:219], v3 offset:2048
    v_mfma_f32_16x16x32_bf16 v[36:39], a[232:235], a[40:43], v[36:39]
    ds_read_b128 a[220:223], v3 offset:3072
    v_mfma_f32_16x16x32_bf16 v[36:39], a[236:239], a[44:47], v[36:39]
    ds_read_b128 a[224:227], v3 offset:4096
    v_mfma_f32_16x16x32_bf16 v[36:39], a[240:243], a[48:51], v[36:39]
    ds_read_b128 a[228:231], v3 offset:5120
    v_mfma_f32_16x16x32_bf16 v[36:39], a[244:247], a[52:55], v[36:39]
    v_mfma_f32_16x16x32_bf16 v[36:39], a[248:251], a[56:59], v[36:39]
    v_mfma_f32_16x16x32_bf16 v[36:39], a[252:255], a[60:63], v[36:39]
    v_mfma_f32_16x16x32_bf16 v[40:43], a[232:235], a[112:115], v[40:43]
    v_mfma_f32_16x16x32_bf16 v[40:43], a[236:239], a[116:119], v[40:43]
    v_mfma_f32_16x16x32_bf16 v[40:43], a[240:243], a[120:123], v[40:43]
    v_mfma_f32_16x16x32_bf16 v[40:43], a[244:247], a[124:127], v[40:43]
    v_mfma_f32_16x16x32_bf16 v[40:43], a[248:251], a[128:131], v[40:43]
    v_mfma_f32_16x16x32_bf16 v[40:43], a[252:255], a[132:135], v[40:43]
    v_mfma_f32_16x16x32_bf16 v[44:47], a[232:235], a[184:187], v[44:47]
    v_mfma_f32_16x16x32_bf16 v[44:47], a[236:239], a[188:191], v[44:47]
    v_mfma_f32_16x16x32_bf16 v[44:47], a[240:243], a[192:195], v[44:47]
    v_mfma_f32_16x16x32_bf16 v[44:47], a[244:247], a[196:199], v[44:47]
    v_mfma_f32_16x16x32_bf16 v[44:47], a[248:251], a[200:203], v[44:47]
    v_mfma_f32_16x16x32_bf16 v[44:47], a[252:255], a[204:207], v[44:47]
    s_cmp_eq_u32 s66, 3
    s_cbranch_scc1 LF_p4done
LF_h2:
    s_waitcnt vmcnt(4) lgkmcnt(0)
    v_mfma_f32_16x16x32_bf16 v[48:51], v[168:171], v[152:155], 0
    ds_read_b128 a[232:235], v3 offset:18432
    v_mfma_f32_16x16x32_bf16 v[48:51], a[208:211], v[176:179], v[48:51]
    ds_read_b128 a[236:239], v3 offset:19456
    v_mfma_f32_16x16x32_bf16 v[48:51], a[212:215], v[180:183], v[48:51]
    ds_read_b128 a[240:243], v3 offset:20480
    v_mfma_f32_16x16x32_bf16 v[48:51], a[216:219], v[184:187], v[48:51]
    ds_read_b128 a[244:247], v3 offset:21504
    v_mfma_f32_16x16x32_bf16 v[48:51], a[220:223], v[188:191], v[48:51]
    ds_read_b128 a[248:251], v3 offset:22528
    v_mfma_f32_16x16x32_bf16 v[48:51], a[224:227], v[192:195], v[48:51]
    ds_read_b128 a[252:255], v3 offset:23552
    v_mfma_f32_16x16x32_bf16 v[48:51], a[228:231], v[196:199], v[48:51]
    v_mfma_f32_16x16x32_bf16 v[52:55], v[168:171], v[156:159], 0
    v_mfma_f32_16x16x32_bf16 v[52:55], a[208:211], v[248:251], v[52:55]
    s_add_u32 m0, s52, 0
    v_mul_f32 v128, v16, v16
    v_mfma_f32_16x16x32_bf16 v[52:55], a[212:215], v[252:255], v[52:55]
    buffer_load_dwordx4 v2, s[36:39], s51 offen offset:0 lds
    v_mul_f32 v129, v17, v17
    v_mfma_f32_16x16x32_bf16 v[52:55], a[216:219], a[0:3], v[52:55]
    v_mul_f32 v130, v18, v18
    v_mul_f32 v131, v19, v19
    v_mfma_f32_16x16x32_bf16 v[52:55], a[220:223], a[4:7], v[52:55]
    v_fma_f32 v128, v128, v148, v144
    v_fma_f32 v129, v129, v148, v144
    v_mfma_f32_16x16x32_bf16 v[52:55], a[224:227], a[8:11], v[52:55]
    v_fma_f32 v130, v130, v148, v144
    v_fma_f32 v131, v131, v148, v144
    v_mfma_f32_16x16x32_bf16 v[52:55], a[228:231], a[12:15], v[52:55]
    v_mul_f32 v128, v128, v16
    v_mul_f32 v129, v129, v17
    v_mfma_f32_16x16x32_bf16 v[56:59], v[168:171], v[160:163], 0
    v_mul_f32 v130, v130, v18
    v_mul_f32 v131, v131, v19
    v_mfma_f32_16x16x32_bf16 v[56:59], a[208:211], a[64:67], v[56:59]
    v_exp_f32 v128, v128
    v_mfma_f32_16x16x32_bf16 v[56:59], a[212:215], a[68:71], v[56:59]
    v_exp_f32 v129, v129
    v_mfma_f32_16x16x32_bf16 v[56:59], a[216:219], a[72:75], v[56:59]
    v_exp_f32 v130, v130
    v_mfma_f32_16x16x32_bf16 v[56:59], a[220:223], a[76:79], v[56:59]
    v_exp_f32 v131, v131
    v_mfma_f32_16x16x32_bf16 v[56:59], a[224:227], a[80:83], v[56:59]
    v_mul_f32 v132, v16, v32
    v_mul_f32 v133, v17, v33
    v_mfma_f32_16x16x32_bf16 v[56:59], a[228:231], a[84:87], v[56:59]
    buffer_load_dwordx4 v2, s[36:39], s51 offen offset:1024 lds
    v_mul_f32 v134, v18, v34
    v_mfma_f32_16x16x32_bf16 v[60:63], v[168:171], v[164:167], 0
    v_mul_f32 v135, v19, v35
    v_fma_f32 v128, v128, v155, v155
    v_mfma_f32_16x16x32_bf16 v[60:63], a[208:211], a[136:139], v[60:63]
    v_fma_f32 v129, v129, v155, v155
    v_fma_f32 v130, v130, v155, v155
    v_mfma_f32_16x16x32_bf16 v[60:63], a[212:215], a[140:143], v[60:63]
    v_fma_f32 v131, v131, v155, v155
    v_mfma_f32_16x16x32_bf16 v[60:63], a[216:219], a[144:147], v[60:63]
    v_rcp_f32 v128, v128
    v_mfma_f32_16x16x32_bf16 v[60:63], a[220:223], a[148:151], v[60:63]
    v_rcp_f32 v129, v129
    v_mfma_f32_16x16x32_bf16 v[60:63], a[224:227], a[152:155], v[60:63]
    v_rcp_f32 v130, v130
    v_mfma_f32_16x16x32_bf16 v[60:63], a[228:231], a[156:159], v[60:63]
    s_waitcnt lgkmcnt(0)
    v_mfma_f32_16x16x32_bf16 v[64:67], v[172:175], v[152:155], 0
    ds_read_b128 a[208:211], v3 offset:6144
    v_mfma_f32_16x16x32_bf16 v[64:67], a[232:235], v[176:179], v[64:67]
    ds_read_b128 a[212:215], v3 offset:7168
    v_mfma_f32_16x16x32_bf16 v[64:67], a[236:239], v[180:183], v[64:67]
    ds_read_b128 a[216:219], v3 offset:8192
    v_mfma_f32_16x16x32_bf16 v[64:67], a[240:243], v[184:187], v[64:67]
    ds_read_b128 a[220:223], v3 offset:9216
    v_mfma_f32_16x16x32_bf16 v[64:67], a[244:247], v[188:191], v[64:67]
    ds_read_b128 a[224:227], v3 offset:10240
    buffer_load_dwordx4 v2, s[36:39], s51 offen offset:2048 lds
    v_mfma_f32_16x16x32_bf16 v[64:67], a[248:251], v[192:195], v[64:67]
    ds_read_b128 a[228:231], v3 offset:11264
    v_mfma_f32_16x16x32_bf16 v[64:67], a[252:255], v[196:199], v[64:67]
    v_rcp_f32 v131, v131
    v_mfma_f32_16x16x32_bf16 v[68:71], v[172:175], v[156:159], 0
    v_mul_f32 v132, v132, v128
    v_mul_f32 v133, v133, v129
    v_mfma_f32_16x16x32_bf16 v[68:71], a[232:235], v[248:251], v[68:71]
    v_mul_f32 v134, v134, v130
    v_mul_f32 v135, v135, v131
    v_mfma_f32_16x16x32_bf16 v[68:71], a[236:239], v[252:255], v[68:71]
    v_cvt_pk_bf16_f32 v114, v132, v133
    v_cvt_pk_bf16_f32 v115, v134, v135
    v_mfma_f32_16x16x32_bf16 v[68:71], a[240:243], a[0:3], v[68:71]
    buffer_store_dwordx4 v[112:115], v2, s[56:59], s62 offen offset:0 sc1
    v_mul_f32 v136, v20, v20
    v_mfma_f32_16x16x32_bf16 v[68:71], a[244:247], a[4:7], v[68:71]
    v_mul_f32 v137, v21, v21
    v_mul_f32 v138, v22, v22
    v_mfma_f32_16x16x32_bf16 v[68:71], a[248:251], a[8:11], v[68:71]
    v_mul_f32 v139, v23, v23
    v_fma_f32 v136, v136, v149, v145
    v_mfma_f32_16x16x32_bf16 v[68:71], a[252:255], a[12:15], v[68:71]
    v_fma_f32 v137, v137, v149, v145
    v_fma_f32 v138, v138, v149, v145
    v_mfma_f32_16x16x32_bf16 v[72:75], v[172:175], v[160:163], 0
    v_fma_f32 v139, v139, v149, v145
    v_mul_f32 v136, v136, v20
    v_mfma_f32_16x16x32_bf16 v[72:75], a[232:235], a[64:67], v[72:75]
    v_mul_f32 v137, v137, v21
    v_mul_f32 v138, v138, v22
    v_mfma_f32_16x16x32_bf16 v[72:75], a[236:239], a[68:71], v[72:75]
    v_mul_f32 v139, v139, v23
    v_mfma_f32_16x16x32_bf16 v[72:75], a[240:243], a[72:75], v[72:75]
    buffer_load_dwordx4 v2, s[36:39], s51 offen offset:3072 lds
    v_mfma_f32_16x16x32_bf16 v[72:75], a[244:247], a[76:79], v[72:75]
    v_exp_f32 v136, v136
    v_mfma_f32_16x16x32_bf16 v[72:75], a[248:251], a[80:83], v[72:75]
    v_exp_f32 v137, v137
    v_mfma_f32_16x16x32_bf16 v[72:75], a[252:255], a[84:87], v[72:75]
    v_exp_f32 v138, v138
    v_mfma_f32_16x16x32_bf16 v[76:79], v[172:175], v[164:167], 0
    v_exp_f32 v139, v139
    v_mfma_f32_16x16x32_bf16 v[76:79], a[232:235], a[136:139], v[76:79]
    v_mul_f32 v140, v20, v36
    v_mul_f32 v141, v21, v37
    v_mfma_f32_16x16x32_bf16 v[76:79], a[236:239], a[140:143], v[76:79]
    v_mul_f32 v142, v22, v38
    v_mul_f32 v143, v23, v39
    v_mfma_f32_16x16x32_bf16 v[76:79], a[240:243], a[144:147], v[76:79]
    v_fma_f32 v136, v136, v159, v159
    v_fma_f32 v137, v137, v159, v159
    v_mfma_f32_16x16x32_bf16 v[76:79], a[244:247], a[148:151], v[76:79]
    v_fma_f32 v138, v138, v159, v159
    v_fma_f32 v139, v139, v159, v159
    v_mfma_f32_16x16x32_bf16 v[76:79], a[248:251], a[152:155], v[76:79]
    v_rcp_f32 v136, v136
    v_mfma_f32_16x16x32_bf16 v[76:79], a[252:255], a[156:159], v[76:79]
    s_waitcnt lgkmcnt(0)
    v_mfma_f32_16x16x32_bf16 v[48:51], a[208:211], v[200:203], v[48:51]
    ds_read_b128 a[232:235], v3 offset:24576
    v_mfma_f32_16x16x32_bf16 v[48:51], a[212:215], v[204:207], v[48:51]
    ds_read_b128 a[236:239], v3 offset:25600
    s_add_u32 m0, s52, 4096
    v_mfma_f32_16x16x32_bf16 v[48:51], a[216:219], v[208:211], v[48:51]
    ds_read_b128 a[240:243], v3 offset:26624
    s_add_u32 s53, s51, 4096
    v_mfma_f32_16x16x32_bf16 v[48:51], a[220:223], v[212:215], v[48:51]
    ds_read_b128 a[244:247], v3 offset:27648
    buffer_load_dwordx4 v2, s[36:39], s53 offen offset:0 lds
    v_mfma_f32_16x16x32_bf16 v[48:51], a[224:227], v[216:219], v[48:51]
    ds_read_b128 a[248:251], v3 offset:28672
    v_mfma_f32_16x16x32_bf16 v[48:51], a[228:231], v[220:223], v[48:51]
    ds_read_b128 a[252:255], v3 offset:29696
    v_mfma_f32_16x16x32_bf16 v[52:55], a[208:211], a[16:19], v[52:55]
    v_rcp_f32 v137, v137
    v_mfma_f32_16x16x32_bf16 v[52:55], a[212:215], a[20:23], v[52:55]
    v_rcp_f32 v138, v138
    v_mfma_f32_16x16x32_bf16 v[52:55], a[216:219], a[24:27], v[52:55]
    v_rcp_f32 v139, v139
    v_mfma_f32_16x16x32_bf16 v[52:55], a[220:223], a[28:31], v[52:55]
    buffer_load_dwordx4 v[168:171], v4, s[40:43], s54 offen
    v_mul_f32 v140, v140, v136
    v_mfma_f32_16x16x32_bf16 v[52:55], a[224:227], a[32:35], v[52:55]
    v_mul_f32 v141, v141, v137
    v_mul_f32 v142, v142, v138
    v_mfma_f32_16x16x32_bf16 v[52:55], a[228:231], a[36:39], v[52:55]
    v_mul_f32 v143, v143, v139
    v_cvt_pk_bf16_f32 v118, v140, v141
    v_mfma_f32_16x16x32_bf16 v[56:59], a[208:211], a[88:91], v[56:59]
    v_cvt_pk_bf16_f32 v119, v142, v143
    buffer_store_dwordx4 v[116:119], v2, s[56:59], s62 offen offset:1024 sc1
    v_mfma_f32_16x16x32_bf16 v[56:59], a[212:215], a[92:95], v[56:59]
    v_mul_f32 v128, v24, v24
    v_mul_f32 v129, v25, v25
    v_mfma_f32_16x16x32_bf16 v[56:59], a[216:219], a[96:99], v[56:59]
    buffer_load_dwordx4 v2, s[36:39], s53 offen offset:1024 lds
    v_mul_f32 v130, v26, v26
    v_mfma_f32_16x16x32_bf16 v[56:59], a[220:223], a[100:103], v[56:59]
    buffer_load_dwordx4 v[172:175], v4, s[40:43], s54 offen offset:512
    v_mul_f32 v131, v27, v27
    v_mfma_f32_16x16x32_bf16 v[56:59], a[224:227], a[104:107], v[56:59]
    v_fma_f32 v128, v128, v150, v146
    v_fma_f32 v129, v129, v150, v146
    v_mfma_f32_16x16x32_bf16 v[56:59], a[228:231], a[108:111], v[56:59]
    v_fma_f32 v130, v130, v150, v146
    v_fma_f32 v131, v131, v150, v146
    v_mfma_f32_16x16x32_bf16 v[60:63], a[208:211], a[160:163], v[60:63]
    v_mul_f32 v128, v128, v24
    v_mul_f32 v129, v129, v25
    v_mfma_f32_16x16x32_bf16 v[60:63], a[212:215], a[164:167], v[60:63]
    v_mul_f32 v130, v130, v26
    v_mul_f32 v131, v131, v27
    v_mfma_f32_16x16x32_bf16 v[60:63], a[216:219], a[168:171], v[60:63]
    v_exp_f32 v128, v128
    v_mfma_f32_16x16x32_bf16 v[60:63], a[220:223], a[172:175], v[60:63]
    s_add_u32 s54, s54, 1024
    v_mfma_f32_16x16x32_bf16 v[60:63], a[224:227], a[176:179], v[60:63]
    v_exp_f32 v129, v129
    v_mfma_f32_16x16x32_bf16 v[60:63], a[228:231], a[180:183], v[60:63]
    s_waitcnt lgkmcnt(0)
    v_mfma_f32_16x16x32_bf16 v[64:67], a[232:235], v[200:203], v[64:67]
    ds_read_b128 a[208:211], v3 offset:12288
    v_mfma_f32_16x16x32_bf16 v[64:67], a[236:239], v[204:207], v[64:67]
    ds_read_b128 a[212:215], v3 offset:13312
    v_mfma_f32_16x16x32_bf16 v[64:67], a[240:243], v[208:211], v[64:67]
    ds_read_b128 a[216:219], v3 offset:14336
    buffer_load_dwordx4 v2, s[36:39], s53 offen offset:2048 lds
    v_mfma_f32_16x16x32_bf16 v[64:67], a[244:247], v[212:215], v[64:67]
    ds_read_b128 a[220:223], v3 offset:15360
    v_mfma_f32_16x16x32_bf16 v[64:67], a[248:251], v[216:219], v[64:67]
    ds_read_b128 a[224:227], v3 offset:16384
    v_mfma_f32_16x16x32_bf16 v[64:67], a[252:255], v[220:223], v[64:67]
    ds_read_b128 a[228:231], v3 offset:17408
    v_mfma_f32_16x16x32_bf16 v[68:71], a[232:235], a[16:19], v[68:71]
    v_exp_f32 v130, v130
    v_mfma_f32_16x16x32_bf16 v[68:71], a[236:239], a[20:23], v[68:71]
    v_exp_f32 v131, v131
    v_mfma_f32_16x16x32_bf16 v[68:71], a[240:243], a[24:27], v[68:71]
    v_mul_f32 v132, v24, v40
    v_mul_f32 v133, v25, v41
    v_mfma_f32_16x16x32_bf16 v[68:71], a[244:247], a[28:31], v[68:71]
    v_mul_f32 v134, v26, v42
    v_mul_f32 v135, v27, v43
    v_mfma_f32_16x16x32_bf16 v[68:71], a[248:251], a[32:35], v[68:71]
    v_fma_f32 v128, v128, v163, v163
    v_fma_f32 v129, v129, v163, v163
    v_mfma_f32_16x16x32_bf16 v[68:71], a[252:255], a[36:39], v[68:71]
    v_fma_f32 v130, v130, v163, v163
    v_fma_f32 v131, v131, v163, v163
    v_mfma_f32_16x16x32_bf16 v[72:75], a[232:235], a[88:91], v[72:75]
    v_rcp_f32 v128, v128
    v_mfma_f32_16x16x32_bf16 v[72:75], a[236:239], a[92:95], v[72:75]
    v_rcp_f32 v129, v129
    v_mfma_f32_16x16x32_bf16 v[72:75], a[240:243], a[96:99], v[72:75]
    v_rcp_f32 v130, v130
    v_mfma_f32_16x16x32_bf16 v[72:75], a[244:247], a[100:103], v[72:75]
    buffer_load_dwordx4 v2, s[36:39], s53 offen offset:3072 lds
    v_mfma_f32_16x16x32_bf16 v[72:75], a[248:251], a[104:107], v[72:75]
    v_rcp_f32 v131, v131
    v_mfma_f32_16x16x32_bf16 v[72:75], a[252:255], a[108:111], v[72:75]
    v_mul_f32 v132, v132, v128
    v_mul_f32 v133, v133, v129
    v_mfma_f32_16x16x32_bf16 v[76:79], a[232:235], a[160:163], v[76:79]
    v_mul_f32 v134, v134, v130
    v_mul_f32 v135, v135, v131
    v_mfma_f32_16x16x32_bf16 v[76:79], a[236:239], a[164:167], v[76:79]
    v_cvt_pk_bf16_f32 v122, v132, v133
    v_cvt_pk_bf16_f32 v123, v134, v135
    v_mfma_f32_16x16x32_bf16 v[76:79], a[240:243], a[168:171], v[76:79]
    buffer_store_dwordx4 v[120:123], v2, s[56:59], s62 offen offset:2048 sc1
    v_mul_f32 v136, v28, v28
    v_mfma_f32_16x16x32_bf16 v[76:79], a[244:247], a[172:175], v[76:79]
    v_mul_f32 v137, v29, v29
    v_mul_f32 v138, v30, v30
    v_mfma_f32_16x16x32_bf16 v[76:79], a[248:251], a[176:179], v[76:79]
    v_mul_f32 v139, v31, v31
    v_fma_f32 v136, v136, v151, v147
    v_mfma_f32_16x16x32_bf16 v[76:79], a[252:255], a[180:183], v[76:79]
    v_fma_f32 v137, v137, v151, v147
    s_waitcnt lgkmcnt(0)
    v_mfma_f32_16x16x32_bf16 v[48:51], a[208:211], v[224:227], v[48:51]
    ds_read_b128 a[232:235], v3 offset:30720
    v_fma_f32 v138, v138, v151, v147
    v_mfma_f32_16x16x32_bf16 v[48:51], a[212:215], v[228:231], v[48:51]
    ds_read_b128 a[236:239], v3 offset:31744
    v_fma_f32 v139, v139, v151, v147
    v_mfma_f32_16x16x32_bf16 v[48:51], a[216:219], v[232:235], v[48:51]
    ds_read_b128 a[240:243], v3 offset:32768
    v_mul_f32 v136, v136, v28
    v_mfma_f32_16x16x32_bf16 v[48:51], a[220:223], v[236:239], v[48:51]
    ds_read_b128 a[244:247], v3 offset:33792
    s_add_u32 m0, s52, 8192
    v_mfma_f32_16x16x32_bf16 v[48:51], a[224:227], v[240:243], v[48:51]
    ds_read_b128 a[248:251], v3 offset:34816
    s_add_u32 s53, s51, 8192
    v_mfma_f32_16x16x32_bf16 v[48:51], a[228:231], v[244:247], v[48:51]
    ds_read_b128 a[252:255], v3 offset:35840
    buffer_load_dwordx4 v2, s[36:39], s53 offen offset:0 lds
    v_mfma_f32_16x16x32_bf16 v[52:55], a[208:211], a[40:43], v[52:55]
    v_mul_f32 v137, v137, v29
    v_mul_f32 v138, v138, v30
    v_mfma_f32_16x16x32_bf16 v[52:55], a[212:215], a[44:47], v[52:55]
    v_mul_f32 v139, v139, v31
    v_mfma_f32_16x16x32_bf16 v[52:55], a[216:219], a[48:51], v[52:55]
    v_exp_f32 v136, v136
    v_mfma_f32_16x16x32_bf16 v[52:55], a[220:223], a[52:55], v[52:55]
    v_exp_f32 v137, v137
    v_mfma_f32_16x16x32_bf16 v[52:55], a[224:227], a[56:59], v[52:55]
    v_exp_f32 v138, v138
    v_mfma_f32_16x16x32_bf16 v[52:55], a[228:231], a[60:63], v[52:55]
    v_exp_f32 v139, v139
    v_mfma_f32_16x16x32_bf16 v[56:59], a[208:211], a[112:115], v[56:59]
    v_mul_f32 v140, v28, v44
    v_mul_f32 v141, v29, v45
    v_mfma_f32_16x16x32_bf16 v[56:59], a[212:215], a[116:119], v[56:59]
    v_mul_f32 v142, v30, v46
    v_mul_f32 v143, v31, v47
    v_mfma_f32_16x16x32_bf16 v[56:59], a[216:219], a[120:123], v[56:59]
    v_fma_f32 v136, v136, v167, v167
    v_fma_f32 v137, v137, v167, v167
    v_mfma_f32_16x16x32_bf16 v[56:59], a[220:223], a[124:127], v[56:59]
    v_fma_f32 v138, v138, v167, v167
    v_fma_f32 v139, v139, v167, v167
    v_mfma_f32_16x16x32_bf16 v[56:59], a[224:227], a[128:131], v[56:59]
    s_add_u32 s51, s51, 36864
    s_add_u32 s52, s52, 36864
    s_cmp_ge_u32 s52, 147456
    s_cselect_b32 s52, s50, s52
    v_mfma_f32_16x16x32_bf16 v[56:59], a[228:231], a[132:135], v[56:59]
    v_rcp_f32 v136, v136
    v_mfma_f32_16x16x32_bf16 v[60:63], a[208:211], a[184:187], v[60:63]
    v_rcp_f32 v137, v137
    v_mfma_f32_16x16x32_bf16 v[60:63], a[212:215], a[188:191], v[60:63]
    v_rcp_f32 v138, v138
    v_mfma_f32_16x16x32_bf16 v[60:63], a[216:219], a[192:195], v[60:63]
    v_rcp_f32 v139, v139
    v_mfma_f32_16x16x32_bf16 v[60:63], a[220:223], a[196:199], v[60:63]
    v_mul_f32 v140, v140, v136
    v_mul_f32 v141, v141, v137
    v_mfma_f32_16x16x32_bf16 v[60:63], a[224:227], a[200:203], v[60:63]
    v_mul_f32 v142, v142, v138
    v_mul_f32 v143, v143, v139
    v_mfma_f32_16x16x32_bf16 v[60:63], a[228:231], a[204:207], v[60:63]
    v_cvt_pk_bf16_f32 v126, v140, v141
    s_waitcnt lgkmcnt(0)
    v_mfma_f32_16x16x32_bf16 v[64:67], a[232:235], v[224:227], v[64:67]
    s_waitcnt vmcnt(18)
    s_barrier
    v_mfma_f32_16x16x32_bf16 v[64:67], a[236:239], v[228:231], v[64:67]
    s_add_u32 s55, s55, 36864
    s_cmp_ge_u32 s55, 147456
    s_cselect_b32 s55, 0, s55
    v_mfma_f32_16x16x32_bf16 v[64:67], a[240:243], v[232:235], v[64:67]
    v_add_u32 v3, s55, v2
    v_cvt_pk_bf16_f32 v127, v142, v143
    v_mfma_f32_16x16x32_bf16 v[64:67], a[244:247], v[236:239], v[64:67]
    ds_read_b128 a[208:211], v3 offset:0
    buffer_store_dwordx4 v[124:127], v2, s[56:59], s62 offen offset:3072 sc1
    v_mfma_f32_16x16x32_bf16 v[64:67], a[248:251], v[240:243], v[64:67]
    ds_read_b128 a[212:215], v3 offset:1024
    s_add_u32 s62, s62, 131072
    v_mfma_f32_16x16x32_bf16 v[64:67], a[252:255], v[244:247], v[64:67]
    ds_read_b128 a[216:219], v3 offset:2048
    v_mfma_f32_16x16x32_bf16 v[68:71], a[232:235], a[40:43], v[68:71]
    ds_read_b128 a[220:223], v3 offset:3072
    v_mfma_f32_16x16x32_bf16 v[68:71], a[236:239], a[44:47], v[68:71]
    ds_read_b128 a[224:227], v3 offset:4096
    v_mfma_f32_16x16x32_bf16 v[68:71], a[240:243], a[48:51], v[68:71]
    ds_read_b128 a[228:231], v3 offset:5120
    v_mfma_f32_16x16x32_bf16 v[68:71], a[244:247], a[52:55], v[68:71]
    v_mfma_f32_16x16x32_bf16 v[68:71], a[248:251], a[56:59], v[68:71]
    v_mfma_f32_16x16x32_bf16 v[68:71], a[252:255], a[60:63], v[68:71]
    v_mfma_f32_16x16x32_bf16 v[72:75], a[232:235], a[112:115], v[72:75]
    v_mfma_f32_16x16x32_bf16 v[72:75], a[236:239], a[116:119], v[72:75]
    v_mfma_f32_16x16x32_bf16 v[72:75], a[240:243], a[120:123], v[72:75]
    v_mfma_f32_16x16x32_bf16 v[72:75], a[244:247], a[124:127], v[72:75]
    v_mfma_f32_16x16x32_bf16 v[72:75], a[248:251], a[128:131], v[72:75]
    v_mfma_f32_16x16x32_bf16 v[72:75], a[252:255], a[132:135], v[72:75]
    v_mfma_f32_16x16x32_bf16 v[76:79], a[232:235], a[184:187], v[76:79]
    v_mfma_f32_16x16x32_bf16 v[76:79], a[236:239], a[188:191], v[76:79]
    v_mfma_f32_16x16x32_bf16 v[76:79], a[240:243], a[192:195], v[76:79]
    v_mfma_f32_16x16x32_bf16 v[76:79], a[244:247], a[196:199], v[76:79]
    v_mfma_f32_16x16x32_bf16 v[76:79], a[248:251], a[200:203], v[76:79]
    v_mfma_f32_16x16x32_bf16 v[76:79], a[252:255], a[204:207], v[76:79]
    s_add_u32 s66, s66, 1
    s_branch LF_loop4
LF_p4done:
    s_nop 4
    s_mov_b32 s62, s67
    s_add_u32 s18, s18, 16384
    v_mul_f32 v128, v16, v16
    v_mul_f32 v129, v17, v17
    v_mul_f32 v130, v18, v18
    v_mul_f32 v131, v19, v19
    v_fma_f32 v128, v128, v148, v144
    v_fma_f32 v129, v129, v148, v144
    v_fma_f32 v130, v130, v148, v144
    v_fma_f32 v131, v131, v148, v144
    v_mul_f32 v128, v128, v16
    v_mul_f32 v129, v129, v17
    v_mul_f32 v130, v130, v18
    v_mul_f32 v131, v131, v19
    v_exp_f32 v128, v128
    v_exp_f32 v129, v129
    v_exp_f32 v130, v130
    v_exp_f32 v131, v131
    v_mul_f32 v132, v16, v32
    v_mul_f32 v133, v17, v33
    v_mul_f32 v134, v18, v34
    v_mul_f32 v135, v19, v35
    v_fma_f32 v128, v128, v155, v155
    v_fma_f32 v129, v129, v155, v155
    v_fma_f32 v130, v130, v155, v155
    v_fma_f32 v131, v131, v155, v155
    v_rcp_f32 v128, v128
    v_rcp_f32 v129, v129
    v_rcp_f32 v130, v130
    v_rcp_f32 v131, v131
    v_mul_f32 v132, v132, v128
    v_mul_f32 v133, v133, v129
    v_mul_f32 v134, v134, v130
    v_mul_f32 v135, v135, v131
    v_cvt_pk_bf16_f32 v114, v132, v133
    v_cvt_pk_bf16_f32 v115, v134, v135
    buffer_store_dwordx4 v[112:115], v2, s[56:59], s62 offen offset:0 sc1
    v_mul_f32 v136, v20, v20
    v_mul_f32 v137, v21, v21
    v_mul_f32 v138, v22, v22
    v_mul_f32 v139, v23, v23
    v_fma_f32 v136, v136, v149, v145
    v_fma_f32 v137, v137, v149, v145
    v_fma_f32 v138, v138, v149, v145
    v_fma_f32 v139, v139, v149, v145
    v_mul_f32 v136, v136, v20
    v_mul_f32 v137, v137, v21
    v_mul_f32 v138, v138, v22
    v_mul_f32 v139, v139, v23
    v_exp_f32 v136, v136
    v_exp_f32 v137, v137
    v_exp_f32 v138, v138
    v_exp_f32 v139, v139
    v_mul_f32 v140, v20, v36
    v_mul_f32 v141, v21, v37
    v_mul_f32 v142, v22, v38
    v_mul_f32 v143, v23, v39
    v_fma_f32 v136, v136, v159, v159
    v_fma_f32 v137, v137, v159, v159
    v_fma_f32 v138, v138, v159, v159
    v_fma_f32 v139, v139, v159, v159
    v_rcp_f32 v136, v136
    v_rcp_f32 v137, v137
    v_rcp_f32 v138, v138
    v_rcp_f32 v139, v139
    v_mul_f32 v140, v140, v136
    v_mul_f32 v141, v141, v137
    v_mul_f32 v142, v142, v138
    v_mul_f32 v143, v143, v139
    v_cvt_pk_bf16_f32 v118, v140, v141
    v_cvt_pk_bf16_f32 v119, v142, v143
    buffer_store_dwordx4 v[116:119], v2, s[56:59], s62 offen offset:1024 sc1
    v_mul_f32 v128, v24, v24
    v_mul_f32 v129, v25, v25
    v_mul_f32 v130, v26, v26
    v_mul_f32 v131, v27, v27
    v_fma_f32 v128, v128, v150, v146
    v_fma_f32 v129, v129, v150, v146
    v_fma_f32 v130, v130, v150, v146
    v_fma_f32 v131, v131, v150, v146
    v_mul_f32 v128, v128, v24
    v_mul_f32 v129, v129, v25
    v_mul_f32 v130, v130, v26
    v_mul_f32 v131, v131, v27
    v_exp_f32 v128, v128
    v_exp_f32 v129, v129
    v_exp_f32 v130, v130
    v_exp_f32 v131, v131
    v_mul_f32 v132, v24, v40
    v_mul_f32 v133, v25, v41
    v_mul_f32 v134, v26, v42
    v_mul_f32 v135, v27, v43
    v_fma_f32 v128, v128, v163, v163
    v_fma_f32 v129, v129, v163, v163
    v_fma_f32 v130, v130, v163, v163
    v_fma_f32 v131, v131, v163, v163
    v_rcp_f32 v128, v128
    v_rcp_f32 v129, v129
    v_rcp_f32 v130, v130
    v_rcp_f32 v131, v131
    v_mul_f32 v132, v132, v128
    v_mul_f32 v133, v133, v129
    v_mul_f32 v134, v134, v130
    v_mul_f32 v135, v135, v131
    v_cvt_pk_bf16_f32 v122, v132, v133
    v_cvt_pk_bf16_f32 v123, v134, v135
    buffer_store_dwordx4 v[120:123], v2, s[56:59], s62 offen offset:2048 sc1
    v_mul_f32 v136, v28, v28
    v_mul_f32 v137, v29, v29
    v_mul_f32 v138, v30, v30
    v_mul_f32 v139, v31, v31
    v_fma_f32 v136, v136, v151, v147
    v_fma_f32 v137, v137, v151, v147
    v_fma_f32 v138, v138, v151, v147
    v_fma_f32 v139, v139, v151, v147
    v_mul_f32 v136, v136, v28
    v_mul_f32 v137, v137, v29
    v_mul_f32 v138, v138, v30
    v_mul_f32 v139, v139, v31
    v_exp_f32 v136, v136
    v_exp_f32 v137, v137
    v_exp_f32 v138, v138
    v_exp_f32 v139, v139
    v_mul_f32 v140, v28, v44
    v_mul_f32 v141, v29, v45
    v_mul_f32 v142, v30, v46
    v_mul_f32 v143, v31, v47
    v_fma_f32 v136, v136, v167, v167
    v_fma_f32 v137, v137, v167, v167
    v_fma_f32 v138, v138, v167, v167
    v_fma_f32 v139, v139, v167, v167
    v_rcp_f32 v136, v136
    v_rcp_f32 v137, v137
    v_rcp_f32 v138, v138
    v_rcp_f32 v139, v139
    v_mul_f32 v140, v140, v136
    v_mul_f32 v141, v141, v137
    v_mul_f32 v142, v142, v138
    v_mul_f32 v143, v143, v139
    v_cvt_pk_bf16_f32 v126, v140, v141
    v_cvt_pk_bf16_f32 v127, v142, v143
    buffer_store_dwordx4 v[124:127], v2, s[56:59], s62 offen offset:3072 sc1
    s_add_u32 s62, s62, 131072
    s_and_b32 s31, s2, 3
    s_bfe_u32 s28, s2, 0x10002
    s_lshl_b32 s28, s28, 3
    s_bfe_u32 s29, s2, 0x30003
    s_add_u32 s28, s28, s29
    s_lshr_b32 s29, s2, 6
    s_lshl_b32 s30, s28, 2
    s_add_u32 s30, s30, s3
    s_and_b32 s55, s31, 1
    s_lshl_b32 s55, s55, 12
    v_add_u32 v6, s55, v2
    s_sub_u32 s55, 4096, s55
    v_add_u32 v7, s55, v2
    s_mov_b32 s54, 110592
    v_add_u32 v3, s54, v6
    v_add_u32 v4, s54, v7
    v_add_u32 v5, s54, v2
    s_lshr_b32 s48, s31, 1
    s_lshl_b32 s48, s48, 10
    v_add_u32 v8, s48, v2
    v_xor_b32 v9, 1024, v8
    s_add_u32 s32, s26, 0x2900000
    s_addc_u32 s33, s27, 0
    s_add_u32 s34, s31, 1
    s_mul_i32 s34, s34, 4718592
    s_mov_b32 s35, 0x20000
    s_add_u32 s40, s26, 0x3c00000
    s_addc_u32 s41, s27, 0
    s_mov_b32 s42, 0x780000
    s_mov_b32 s43, 0x20000
    s_mul_i32 s48, s31, 4718592
    s_lshl_b32 s49, s30, 11
    s_add_u32 s48, s48, s49
    s_lshr_b32 s17, s30, 1
    s_lshl_b32 s17, s17, 2
    s_add_u32 s17, s17, s31
    s_lshl_b32 s17, s17, 7
    s_add_u32 s17, s17, 65536
    s_waitcnt vmcnt(16)
    s_barrier
    s_mov_b32 s24, s18
    s_add_u32 s44, s26, 0x1500000
    s_addc_u32 s45, s27, 0
    s_mov_b32 s46, 0x240000
    s_mov_b32 s47, 0x20000
    s_mov_b32 s56, s26
    s_mov_b32 s57, s27
    s_mov_b32 s58, 0x3600
    s_mov_b32 s59, 0x20000
    s_mov_b32 s64, s22
    s_mov_b32 s65, s23
    s_mov_b32 s66, 0x240000
    s_mov_b32 s67, 0x20000
    s_lshl_b32 s8, s28, 2
    s_add_u32 s8, s8, s29
    s_xor_b32 s9, s31, 1
    s_lshl_b32 s60, s8, 2
    s_add_u32 s60, s60, s9
    s_mul_i32 s60, s60, 3
    s_add_u32 s60, s60, 0
    s_lshl_b32 s60, s60, 2
    s_add_u32 s60, s60, s3
    s_mul_i32 s60, s60, 2560
    s_xor_b32 s9, s31, 2
    s_lshl_b32 s61, s8, 2
    s_add_u32 s61, s61, s9
    s_mul_i32 s61, s61, 3
    s_add_u32 s61, s61, 1
    s_lshl_b32 s61, s61, 2
    s_add_u32 s61, s61, s3
    s_mul_i32 s61, s61, 2560
    s_xor_b32 s9, s31, 3
    s_lshl_b32 s62, s8, 2
    s_add_u32 s62, s62, s9
    s_mul_i32 s62, s62, 3
    s_add_u32 s62, s62, 2
    s_lshl_b32 s62, s62, 2
    s_add_u32 s62, s62, s3
    s_mul_i32 s62, s62, 2560
    s_lshl_b32 s16, s8, 2
    s_add_u32 s16, s16, s31
    s_mul_i32 s16, s16, 3
    s_add_u32 s16, s16, 0
    s_lshl_b32 s16, s16, 2
    s_add_u32 s16, s16, s3
    s_mul_i32 s16, s16, 2560
    s_bitcmp1_b32 s31, 0
    s_cselect_b32 s63, s60, 0x40000000
    s_cselect_b32 s68, s62, s61
    s_cselect_b32 s21, 0x40000000, 0
    v_lshlrev_b32 v244, 3, v1
    v_add_u32 v245, s21, v244
    s_lshl_b32 s69, s8, 2
    s_add_u32 s69, s69, s3
    s_lshl_b32 s69, s69, 7
    s_mov_b32 s20, 0xffff0000
    v_mov_b32 v16, 0
    v_mov_b32 v17, 0
    v_mov_b32 v18, 0
    v_mov_b32 v19, 0
    v_mov_b32 v20, 0
    v_mov_b32 v21, 0
    v_mov_b32 v22, 0
    v_mov_b32 v23, 0
    v_mov_b32 v24, 0
    v_mov_b32 v25, 0
    v_mov_b32 v26, 0
    v_mov_b32 v27, 0
    v_mov_b32 v28, 0
    v_mov_b32 v29, 0
    v_mov_b32 v30, 0
    v_mov_b32 v31, 0
    v_mov_b32 v32, 0
    v_mov_b32 v33, 0
    v_mov_b32 v34, 0
    v_mov_b32 v35, 0
    v_mov_b32 v36, 0
    v_mov_b32 v37, 0
    v_mov_b32 v38, 0
    v_mov_b32 v39, 0
    v_mov_b32 v40, 0
    v_mov_b32 v41, 0
    v_mov_b32 v42, 0
    v_mov_b32 v43, 0
    v_mov_b32 v44, 0
    v_mov_b32 v45, 0
    v_mov_b32 v46, 0
    v_mov_b32 v47, 0
    v_mov_b32 v48, 0
    v_mov_b32 v49, 0
    v_mov_b32 v50, 0
    v_mov_b32 v51, 0
    v_mov_b32 v52, 0
    v_mov_b32 v53, 0
    v_mov_b32 v54, 0
    v_mov_b32 v55, 0
    v_mov_b32 v56, 0
    v_mov_b32 v57, 0
    v_mov_b32 v58, 0
    v_mov_b32 v59, 0
    v_mov_b32 v60, 0
    v_mov_b32 v61, 0
    v_mov_b32 v62, 0
    v_mov_b32 v63, 0
    v_mov_b32 v64, 0
    v_mov_b32 v65, 0
    v_mov_b32 v66, 0
    v_mov_b32 v67, 0
    v_mov_b32 v68, 0
    v_mov_b32 v69, 0
    v_mov_b32 v70, 0
    v_mov_b32 v71, 0
    v_mov_b32 v72, 0
    v_mov_b32 v73, 0
    v_mov_b32 v74, 0
    v_mov_b32 v75, 0
    v_mov_b32 v76, 0
    v_mov_b32 v77, 0
    v_mov_b32 v78, 0
    v_mov_b32 v79, 0
    v_mov_b32 v80, 0
    v_mov_b32 v81, 0
    v_mov_b32 v82, 0
    v_mov_b32 v83, 0
    v_mov_b32 v84, 0
    v_mov_b32 v85, 0
    v_mov_b32 v86, 0
    v_mov_b32 v87, 0
    ds_read_b128 a[0:3], v3 offset:0
    ds_read_b128 a[4:7], v3 offset:9216
    ds_read_b128 a[8:11], v3 offset:18432
    ds_read_b128 a[12:15], v3 offset:27648
    ds_read_b128 a[16:19], v3 offset:1024
    ds_read_b128 a[20:23], v3 offset:10240
    ds_read_b128 a[24:27], v3 offset:19456
    ds_read_b128 a[28:31], v3 offset:28672
    s_mov_b32 s10, 0
LF_b_poll:
    s_mov_b32 s11, 0
    s_atomic_add s11, s[12:13], s17 glc
    s_add_u32 s10, s10, 1
    s_waitcnt lgkmcnt(0)
    s_cmp_ge_u32 s11, 8
    s_cbranch_scc1 LF_b_go
    s_cmp_lt_u32 s10, 0x20000
    s_cbranch_scc1 LF_b_poll
LF_b_go:
    s_add_u32 s17, s17, 16384
    v_lshrrev_b32 v10, 1, v2
    v_and_b32 v11, 1024, v8
    v_add_u32 v10, v10, v11
    v_xor_b32 v11, 1024, v10
    buffer_load_dwordx2 v[88:89], v10, s[32:35], s48 offen offset:0 sc1
    buffer_load_dwordx2 v[90:91], v10, s[32:35], s48 offen offset:512 sc1
    buffer_load_dwordx2 v[92:93], v11, s[32:35], s48 offen offset:0 sc1
    buffer_load_dwordx2 v[94:95], v11, s[32:35], s48 offen offset:512 sc1
    s_add_u32 s48, s48, 131072
    buffer_load_dwordx2 v[96:97], v10, s[32:35], s48 offen offset:0 sc1
    buffer_load_dwordx2 v[98:99], v10, s[32:35], s48 offen offset:512 sc1
    buffer_load_dwordx2 v[100:101], v11, s[32:35], s48 offen offset:0 sc1
    buffer_load_dwordx2 v[102:103], v11, s[32:35], s48 offen offset:512 sc1
    s_add_u32 s48, s48, 131072
    buffer_load_dwordx2 v[104:105], v10, s[32:35], s48 offen offset:0 sc1
    buffer_load_dwordx2 v[106:107], v10, s[32:35], s48 offen offset:512 sc1
    buffer_load_dwordx2 v[108:109], v11, s[32:35], s48 offen offset:0 sc1
    buffer_load_dwordx2 v[110:111], v11, s[32:35], s48 offen offset:512 sc1
    s_add_u32 s48, s48, 131072
    buffer_load_dwordx2 v[112:113], v10, s[32:35], s48 offen offset:0 sc1
    buffer_load_dwordx2 v[114:115], v10, s[32:35], s48 offen offset:512 sc1
    buffer_load_dwordx2 v[116:117], v11, s[32:35], s48 offen offset:0 sc1
    buffer_load_dwordx2 v[118:119], v11, s[32:35], s48 offen offset:512 sc1
    s_add_u32 s48, s48, 131072
    buffer_load_dwordx4 v[120:123], v8, s[32:35], s48 offen sc1
    buffer_load_dwordx4 v[124:127], v9, s[32:35], s48 offen sc1
    s_add_u32 s48, s48, 131072
    buffer_load_dwordx4 v[128:131], v8, s[32:35], s48 offen sc1
    buffer_load_dwordx4 v[132:135], v9, s[32:35], s48 offen sc1
    s_add_u32 s48, s48, 131072
    buffer_load_dwordx4 v[136:139], v8, s[32:35], s48 offen sc1
    buffer_load_dwordx4 v[140:143], v9, s[32:35], s48 offen sc1
    s_add_u32 s48, s48, 131072
    buffer_load_dwordx4 v[144:147], v8, s[32:35], s48 offen sc1
    buffer_load_dwordx4 v[148:151], v9, s[32:35], s48 offen sc1
    s_add_u32 s48, s48, 131072
    s_waitcnt vmcnt(24)
    buffer_atomic_add v14, v15, s[12:15], s24 offen sc1
    v_and_b32 v10, 15, v1
    v_lshrrev_b32 v11, 4, v1
    s_mov_b32 s10, 0
    s_cmp_eq_u32 s29, 1
    s_cselect_b32 s10, 144, s10
    s_cmp_eq_u32 s29, 2
    s_cselect_b32 s10, 288, s10
    s_cmp_eq_u32 s29, 3
    s_cselect_b32 s10, 512, s10
    s_mov_b32 s4, 32
    s_cmp_eq_u32 s29, 1
    s_cselect_b32 s4, 256, s4
    s_cmp_eq_u32 s29, 2
    s_cselect_b32 s4, 384, s4
    s_cmp_eq_u32 s29, 3
    s_cselect_b32 s4, 544, s4
    s_mov_b32 s9, 128
    s_cmp_eq_u32 s29, 1
    s_cselect_b32 s9, 176, s9
    s_cmp_eq_u32 s29, 2
    s_cselect_b32 s9, 416, s9
    s_cmp_eq_u32 s29, 3
    s_cselect_b32 s9, 432, s9
    s_lshl_b32 s5, s29, 7
    s_add_u32 s5, s5, 64
    s_add_u32 s6, s5, 32
    s_bitcmp1_b32 s31, 0
    s_cselect_b32 s10, s5, s10
    s_cselect_b32 s4, s6, s4
    v_lshl_add_u32 v12, v11, 3, s10
    v_lshl_add_u32 v13, v11, 2, s9
    v_lshl_add_u32 v250, v11, 3, s4
    s_lshr_b32 s8, s31, 1
    s_lshl_b32 s9, s30, 1
    s_add_u32 s8, s8, s9
    s_mul_i32 s9, s8, 18432
    v_lshlrev_b32 v248, 5, v12
    v_lshl_add_u32 v248, v10, 4, v248
    v_lshlrev_b32 v249, 5, v250
    v_lshl_add_u32 v249, v10, 4, v249
    buffer_load_dwordx4 v[212:215], v248, s[44:47], s9 offen sc1
    buffer_load_dwordx4 v[216:219], v249, s[44:47], s9 offen sc1
    v_lshrrev_b32 v248, 3, v13
    v_lshlrev_b32 v248, 8, v248
    v_lshl_add_u32 v248, v10, 4, v248
    v_and_b32 v249, 4, v13
    v_lshl_add_u32 v248, v249, 1, v248
    buffer_load_dwordx2 v[220:221], v248, s[44:47], s9 offen sc1
    s_mov_b32 s10, 11520
    v_lshlrev_b32 v248, 2, v12
    v_lshlrev_b32 v249, 2, v250
    buffer_load_dwordx4 v[224:227], v248, s[56:59], s10 offen offset:0
    buffer_load_dwordx4 v[228:231], v248, s[56:59], s10 offen offset:16
    buffer_load_dwordx4 v[232:235], v249, s[56:59], s10 offen offset:0
    buffer_load_dwordx4 v[236:239], v249, s[56:59], s10 offen offset:16
    v_lshlrev_b32 v248, 2, v13
    buffer_load_dwordx4 v[240:243], v248, s[56:59], s10 offen
    s_lshl_b32 s8, s8, 4
    v_add_u32 v10, s8, v10
    v_mul_u32_u24 v10, 1152, v10
    v_lshl_add_u32 v12, v12, 1, v10
    v_lshl_add_u32 v13, v13, 1, v10
    v_add_u32 v13, s21, v13
    v_lshl_add_u32 v250, v250, 1, v10
    s_mov_b32 s19, 0
.p2align 3
LF_loop5:
    s_waitcnt vmcnt(17) lgkmcnt(0)
    v_mfma_f32_16x16x32_bf16 v[16:19], a[0:3], v[88:91], v[16:19]
    ds_read_b128 a[32:35], v3 offset:2048
    v_mfma_f32_16x16x32_bf16 v[16:19], a[4:7], v[96:99], v[16:19]
    ds_read_b128 a[36:39], v3 offset:11264
    v_mfma_f32_16x16x32_bf16 v[16:19], a[8:11], v[104:107], v[16:19]
    ds_read_b128 a[40:43], v3 offset:20480
    s_add_u32 m0, s52, 0
    v_mfma_f32_16x16x32_bf16 v[16:19], a[12:15], v[112:115], v[16:19]
    ds_read_b128 a[44:47], v3 offset:29696
    buffer_load_dwordx4 v2, s[36:39], s51 offen offset:0 lds
    v_mfma_f32_16x16x32_bf16 v[52:55], a[0:3], v[92:95], v[52:55]
    v_mfma_f32_16x16x32_bf16 v[52:55], a[4:7], v[100:103], v[52:55]
    v_mfma_f32_16x16x32_bf16 v[52:55], a[8:11], v[108:111], v[52:55]
    buffer_load_dwordx4 v2, s[36:39], s51 offen offset:1024 lds
    v_mfma_f32_16x16x32_bf16 v[52:55], a[12:15], v[116:119], v[52:55]
    s_waitcnt lgkmcnt(4)
    v_mfma_f32_16x16x32_bf16 v[20:23], a[16:19], v[88:91], v[20:23]
    ds_read_b128 a[0:3], v3 offset:3072
    v_mfma_f32_16x16x32_bf16 v[20:23], a[20:23], v[96:99], v[20:23]
    ds_read_b128 a[4:7], v3 offset:12288
    v_mfma_f32_16x16x32_bf16 v[20:23], a[24:27], v[104:107], v[20:23]
    ds_read_b128 a[8:11], v3 offset:21504
    buffer_load_dwordx4 v2, s[36:39], s51 offen offset:2048 lds
    v_mfma_f32_16x16x32_bf16 v[20:23], a[28:31], v[112:115], v[20:23]
    ds_read_b128 a[12:15], v3 offset:30720
    v_mfma_f32_16x16x32_bf16 v[56:59], a[16:19], v[92:95], v[56:59]
    v_mfma_f32_16x16x32_bf16 v[56:59], a[20:23], v[100:103], v[56:59]
    v_mfma_f32_16x16x32_bf16 v[56:59], a[24:27], v[108:111], v[56:59]
    buffer_load_dwordx4 v2, s[36:39], s51 offen offset:3072 lds
    v_mfma_f32_16x16x32_bf16 v[56:59], a[28:31], v[116:119], v[56:59]
    s_waitcnt lgkmcnt(4)
    v_mfma_f32_16x16x32_bf16 v[24:27], a[32:35], v[88:91], v[24:27]
    ds_read_b128 a[16:19], v4 offset:0
    v_mfma_f32_16x16x32_bf16 v[24:27], a[36:39], v[96:99], v[24:27]
    ds_read_b128 a[20:23], v4 offset:9216
    v_mfma_f32_16x16x32_bf16 v[24:27], a[40:43], v[104:107], v[24:27]
    ds_read_b128 a[24:27], v4 offset:18432
    s_add_u32 m0, s52, 4096
    v_mfma_f32_16x16x32_bf16 v[24:27], a[44:47], v[112:115], v[24:27]
    ds_read_b128 a[28:31], v4 offset:27648
    s_add_u32 s53, s51, 4096
    v_mfma_f32_16x16x32_bf16 v[60:63], a[32:35], v[92:95], v[60:63]
    buffer_load_dwordx4 v2, s[36:39], s53 offen offset:0 lds
    v_mfma_f32_16x16x32_bf16 v[60:63], a[36:39], v[100:103], v[60:63]
    v_mfma_f32_16x16x32_bf16 v[60:63], a[40:43], v[108:111], v[60:63]
    buffer_load_dwordx4 v2, s[36:39], s53 offen offset:1024 lds
    v_mfma_f32_16x16x32_bf16 v[60:63], a[44:47], v[116:119], v[60:63]
    s_waitcnt lgkmcnt(4)
    v_mfma_f32_16x16x32_bf16 v[28:31], a[0:3], v[88:91], v[28:31]
    ds_read_b128 a[32:35], v4 offset:1024
    v_mfma_f32_16x16x32_bf16 v[28:31], a[4:7], v[96:99], v[28:31]
    ds_read_b128 a[36:39], v4 offset:10240
    v_mfma_f32_16x16x32_bf16 v[28:31], a[8:11], v[104:107], v[28:31]
    ds_read_b128 a[40:43], v4 offset:19456
    buffer_load_dwordx4 v2, s[36:39], s53 offen offset:2048 lds
    v_mfma_f32_16x16x32_bf16 v[28:31], a[12:15], v[112:115], v[28:31]
    ds_read_b128 a[44:47], v4 offset:28672
    v_mfma_f32_16x16x32_bf16 v[64:67], a[0:3], v[92:95], v[64:67]
    v_mfma_f32_16x16x32_bf16 v[64:67], a[4:7], v[100:103], v[64:67]
    v_mfma_f32_16x16x32_bf16 v[64:67], a[8:11], v[108:111], v[64:67]
    buffer_load_dwordx4 v2, s[36:39], s53 offen offset:3072 lds
    v_mfma_f32_16x16x32_bf16 v[64:67], a[12:15], v[116:119], v[64:67]
    s_waitcnt lgkmcnt(4)
    v_mfma_f32_16x16x32_bf16 v[32:35], a[16:19], v[88:91], v[32:35]
    ds_read_b128 a[0:3], v4 offset:2048
    v_mfma_f32_16x16x32_bf16 v[32:35], a[20:23], v[96:99], v[32:35]
    ds_read_b128 a[4:7], v4 offset:11264
    v_mfma_f32_16x16x32_bf16 v[32:35], a[24:27], v[104:107], v[32:35]
    ds_read_b128 a[8:11], v4 offset:20480
    s_add_u32 m0, s52, 8192
    v_mfma_f32_16x16x32_bf16 v[32:35], a[28:31], v[112:115], v[32:35]
    ds_read_b128 a[12:15], v4 offset:29696
    s_add_u32 s53, s51, 8192
    v_mfma_f32_16x16x32_bf16 v[68:71], a[16:19], v[92:95], v[68:71]
    buffer_load_dwordx4 v2, s[36:39], s53 offen offset:0 lds
    v_mfma_f32_16x16x32_bf16 v[68:71], a[20:23], v[100:103], v[68:71]
    v_mfma_f32_16x16x32_bf16 v[68:71], a[24:27], v[108:111], v[68:71]
    s_add_u32 s51, s51, 36864
    s_add_u32 s52, s52, 36864
    s_cmp_ge_u32 s52, 147456
    s_cselect_b32 s52, s50, s52
    v_mfma_f32_16x16x32_bf16 v[68:71], a[28:31], v[116:119], v[68:71]
    buffer_load_dwordx4 v[152:155], v8, s[32:35], s48 offen sc1
    s_waitcnt lgkmcnt(4)
    v_mfma_f32_16x16x32_bf16 v[36:39], a[32:35], v[88:91], v[36:39]
    ds_read_b128 a[16:19], v4 offset:3072
    v_mfma_f32_16x16x32_bf16 v[36:39], a[36:39], v[96:99], v[36:39]
    ds_read_b128 a[20:23], v4 offset:12288
    v_mfma_f32_16x16x32_bf16 v[36:39], a[40:43], v[104:107], v[36:39]
    ds_read_b128 a[24:27], v4 offset:21504
    buffer_load_dwordx4 v[156:159], v9, s[32:35], s48 offen sc1
    v_mfma_f32_16x16x32_bf16 v[36:39], a[44:47], v[112:115], v[36:39]
    ds_read_b128 a[28:31], v4 offset:30720
    v_mfma_f32_16x16x32_bf16 v[72:75], a[32:35], v[92:95], v[72:75]
    v_mfma_f32_16x16x32_bf16 v[72:75], a[36:39], v[100:103], v[72:75]
    v_mfma_f32_16x16x32_bf16 v[72:75], a[40:43], v[108:111], v[72:75]
    s_add_u32 s48, s48, 131072
    v_mfma_f32_16x16x32_bf16 v[72:75], a[44:47], v[116:119], v[72:75]
    buffer_load_dwordx4 v[160:163], v8, s[32:35], s48 offen sc1
    s_waitcnt lgkmcnt(4)
    v_mfma_f32_16x16x32_bf16 v[40:43], a[0:3], v[88:91], v[40:43]
    ds_read_b128 a[32:35], v5 offset:8192
    v_mfma_f32_16x16x32_bf16 v[40:43], a[4:7], v[96:99], v[40:43]
    ds_read_b128 a[36:39], v5 offset:17408
    v_mfma_f32_16x16x32_bf16 v[40:43], a[8:11], v[104:107], v[40:43]
    ds_read_b128 a[40:43], v5 offset:26624
    buffer_load_dwordx4 v[164:167], v9, s[32:35], s48 offen sc1
    v_mfma_f32_16x16x32_bf16 v[40:43], a[12:15], v[112:115], v[40:43]
    ds_read_b128 a[44:47], v5 offset:35840
    v_mfma_f32_16x16x32_bf16 v[76:79], a[0:3], v[92:95], v[76:79]
    v_mfma_f32_16x16x32_bf16 v[76:79], a[4:7], v[100:103], v[76:79]
    v_mfma_f32_16x16x32_bf16 v[76:79], a[8:11], v[108:111], v[76:79]
    s_add_u32 s48, s48, 131072
    v_mfma_f32_16x16x32_bf16 v[76:79], a[12:15], v[116:119], v[76:79]
    buffer_load_dwordx4 v[168:171], v8, s[32:35], s48 offen sc1
    s_waitcnt lgkmcnt(4)
    v_mfma_f32_16x16x32_bf16 v[44:47], a[16:19], v[88:91], v[44:47]
    s_waitcnt vmcnt(31) lgkmcnt(0)
    s_barrier
    v_mfma_f32_16x16x32_bf16 v[44:47], a[20:23], v[96:99], v[44:47]
    s_add_u32 s54, s54, 36864
    s_cmp_ge_u32 s54, 147456
    s_cselect_b32 s54, 0, s54
    v_mfma_f32_16x16x32_bf16 v[44:47], a[24:27], v[104:107], v[44:47]
    v_add_u32 v3, s54, v6
    buffer_load_dwordx4 v[172:175], v9, s[32:35], s48 offen sc1
    v_mfma_f32_16x16x32_bf16 v[44:47], a[28:31], v[112:115], v[44:47]
    ds_read_b128 a[0:3], v3 offset:0
    v_mfma_f32_16x16x32_bf16 v[80:83], a[16:19], v[92:95], v[80:83]
    ds_read_b128 a[4:7], v3 offset:9216
    v_mfma_f32_16x16x32_bf16 v[80:83], a[20:23], v[100:103], v[80:83]
    ds_read_b128 a[8:11], v3 offset:18432
    v_mfma_f32_16x16x32_bf16 v[80:83], a[24:27], v[108:111], v[80:83]
    ds_read_b128 a[12:15], v3 offset:27648
    s_add_u32 s48, s48, 131072
    v_mfma_f32_16x16x32_bf16 v[80:83], a[28:31], v[116:119], v[80:83]
    buffer_load_dwordx4 v[176:179], v8, s[32:35], s48 offen sc1
    s_waitcnt lgkmcnt(4)
    v_mfma_f32_16x16x32_bf16 v[48:51], a[32:35], v[88:91], v[48:51]
    ds_read_b128 a[16:19], v3 offset:1024
    v_mfma_f32_16x16x32_bf16 v[48:51], a[36:39], v[96:99], v[48:51]
    ds_read_b128 a[20:23], v3 offset:10240
    v_mfma_f32_16x16x32_bf16 v[48:51], a[40:43], v[104:107], v[48:51]
    ds_read_b128 a[24:27], v3 offset:19456
    buffer_load_dwordx4 v[180:183], v9, s[32:35], s48 offen sc1
    v_mfma_f32_16x16x32_bf16 v[48:51], a[44:47], v[112:115], v[48:51]
    ds_read_b128 a[28:31], v3 offset:28672
    v_mfma_f32_16x16x32_bf16 v[84:87], a[32:35], v[92:95], v[84:87]
    v_mfma_f32_16x16x32_bf16 v[84:87], a[36:39], v[100:103], v[84:87]
    v_add_u32 v4, s54, v7
    v_add_u32 v5, s54, v2
    v_mfma_f32_16x16x32_bf16 v[84:87], a[40:43], v[108:111], v[84:87]
    s_add_u32 s48, s48, 131072
    v_mfma_f32_16x16x32_bf16 v[84:87], a[44:47], v[116:119], v[84:87]
    s_waitcnt vmcnt(17) lgkmcnt(4)
    v_mfma_f32_16x16x32_bf16 v[16:19], a[0:3], v[120:123], v[16:19]
    ds_read_b128 a[32:35], v3 offset:2048
    v_mov_b32 v247, 0
    v_mfma_f32_16x16x32_bf16 v[16:19], a[4:7], v[128:131], v[16:19]
    ds_read_b128 a[36:39], v3 offset:11264
    buffer_atomic_add v247, v15, s[12:15], s17 offen sc0 sc1
    v_mfma_f32_16x16x32_bf16 v[16:19], a[8:11], v[136:139], v[16:19]
    ds_read_b128 a[40:43], v3 offset:20480
    s_add_u32 m0, s52, 0
    v_mfma_f32_16x16x32_bf16 v[16:19], a[12:15], v[144:147], v[16:19]
    ds_read_b128 a[44:47], v3 offset:29696
    buffer_load_dwordx4 v2, s[36:39], s51 offen offset:0 lds
    v_mfma_f32_16x16x32_bf16 v[52:55], a[0:3], v[124:127], v[52:55]
    v_mfma_f32_16x16x32_bf16 v[52:55], a[4:7], v[132:135], v[52:55]
    v_mfma_f32_16x16x32_bf16 v[52:55], a[8:11], v[140:143], v[52:55]
    buffer_load_dwordx4 v2, s[36:39], s51 offen offset:1024 lds
    v_mfma_f32_16x16x32_bf16 v[52:55], a[12:15], v[148:151], v[52:55]
    s_waitcnt lgkmcnt(4)
    v_mfma_f32_16x16x32_bf16 v[20:23], a[16:19], v[120:123], v[20:23]
    ds_read_b128 a[0:3], v3 offset:3072
    v_mfma_f32_16x16x32_bf16 v[20:23], a[20:23], v[128:131], v[20:23]
    ds_read_b128 a[4:7], v3 offset:12288
    v_mfma_f32_16x16x32_bf16 v[20:23], a[24:27], v[136:139], v[20:23]
    ds_read_b128 a[8:11], v3 offset:21504
    buffer_load_dwordx4 v2, s[36:39], s51 offen offset:2048 lds
    v_mfma_f32_16x16x32_bf16 v[20:23], a[28:31], v[144:147], v[20:23]
    ds_read_b128 a[12:15], v3 offset:30720
    v_mfma_f32_16x16x32_bf16 v[56:59], a[16:19], v[124:127], v[56:59]
    v_mfma_f32_16x16x32_bf16 v[56:59], a[20:23], v[132:135], v[56:59]
    v_mfma_f32_16x16x32_bf16 v[56:59], a[24:27], v[140:143], v[56:59]
    buffer_load_dwordx4 v2, s[36:39], s51 offen offset:3072 lds
    v_mfma_f32_16x16x32_bf16 v[56:59], a[28:31], v[148:151], v[56:59]
    s_waitcnt lgkmcnt(4)
    v_mfma_f32_16x16x32_bf16 v[24:27], a[32:35], v[120:123], v[24:27]
    ds_read_b128 a[16:19], v4 offset:0
    v_mfma_f32_16x16x32_bf16 v[24:27], a[36:39], v[128:131], v[24:27]
    ds_read_b128 a[20:23], v4 offset:9216
    v_mfma_f32_16x16x32_bf16 v[24:27], a[40:43], v[136:139], v[24:27]
    ds_read_b128 a[24:27], v4 offset:18432
    s_add_u32 m0, s52, 4096
    v_mfma_f32_16x16x32_bf16 v[24:27], a[44:47], v[144:147], v[24:27]
    ds_read_b128 a[28:31], v4 offset:27648
    s_add_u32 s53, s51, 4096
    v_mfma_f32_16x16x32_bf16 v[60:63], a[32:35], v[124:127], v[60:63]
    buffer_load_dwordx4 v2, s[36:39], s53 offen offset:0 lds
    v_mfma_f32_16x16x32_bf16 v[60:63], a[36:39], v[132:135], v[60:63]
    v_mfma_f32_16x16x32_bf16 v[60:63], a[40:43], v[140:143], v[60:63]
    buffer_load_dwordx4 v2, s[36:39], s53 offen offset:1024 lds
    v_mfma_f32_16x16x32_bf16 v[60:63], a[44:47], v[148:151], v[60:63]
    s_waitcnt lgkmcnt(4)
    v_mfma_f32_16x16x32_bf16 v[28:31], a[0:3], v[120:123], v[28:31]
    ds_read_b128 a[32:35], v4 offset:1024
    v_mfma_f32_16x16x32_bf16 v[28:31], a[4:7], v[128:131], v[28:31]
    ds_read_b128 a[36:39], v4 offset:10240
    v_mfma_f32_16x16x32_bf16 v[28:31], a[8:11], v[136:139], v[28:31]
    ds_read_b128 a[40:43], v4 offset:19456
    buffer_load_dwordx4 v2, s[36:39], s53 offen offset:2048 lds
    v_mfma_f32_16x16x32_bf16 v[28:31], a[12:15], v[144:147], v[28:31]
    ds_read_b128 a[44:47], v4 offset:28672
    v_mfma_f32_16x16x32_bf16 v[64:67], a[0:3], v[124:127], v[64:67]
    v_mfma_f32_16x16x32_bf16 v[64:67], a[4:7], v[132:135], v[64:67]
    v_mfma_f32_16x16x32_bf16 v[64:67], a[8:11], v[140:143], v[64:67]
    buffer_load_dwordx4 v2, s[36:39], s53 offen offset:3072 lds
    v_mfma_f32_16x16x32_bf16 v[64:67], a[12:15], v[148:151], v[64:67]
    s_waitcnt lgkmcnt(4)
    v_mfma_f32_16x16x32_bf16 v[32:35], a[16:19], v[120:123], v[32:35]
    ds_read_b128 a[0:3], v4 offset:2048
    v_mfma_f32_16x16x32_bf16 v[32:35], a[20:23], v[128:131], v[32:35]
    ds_read_b128 a[4:7], v4 offset:11264
    v_mfma_f32_16x16x32_bf16 v[32:35], a[24:27], v[136:139], v[32:35]
    ds_read_b128 a[8:11], v4 offset:20480
    s_add_u32 m0, s52, 8192
    v_mfma_f32_16x16x32_bf16 v[32:35], a[28:31], v[144:147], v[32:35]
    ds_read_b128 a[12:15], v4 offset:29696
    s_add_u32 s53, s51, 8192
    v_mfma_f32_16x16x32_bf16 v[68:71], a[16:19], v[124:127], v[68:71]
    buffer_load_dwordx4 v2, s[36:39], s53 offen offset:0 lds
    v_mfma_f32_16x16x32_bf16 v[68:71], a[20:23], v[132:135], v[68:71]
    v_mfma_f32_16x16x32_bf16 v[68:71], a[24:27], v[140:143], v[68:71]
    s_add_u32 s51, s51, 36864
    s_add_u32 s52, s52, 36864
    s_cmp_ge_u32 s52, 147456
    s_cselect_b32 s52, s50, s52
    v_mfma_f32_16x16x32_bf16 v[68:71], a[28:31], v[148:151], v[68:71]
    buffer_load_dwordx4 v[88:91], v8, s[32:35], s48 offen sc1
    s_waitcnt lgkmcnt(4)
    v_mfma_f32_16x16x32_bf16 v[36:39], a[32:35], v[120:123], v[36:39]
    ds_read_b128 a[16:19], v4 offset:3072
    v_mfma_f32_16x16x32_bf16 v[36:39], a[36:39], v[128:131], v[36:39]
    ds_read_b128 a[20:23], v4 offset:12288
    v_mfma_f32_16x16x32_bf16 v[36:39], a[40:43], v[136:139], v[36:39]
    ds_read_b128 a[24:27], v4 offset:21504
    buffer_load_dwordx4 v[92:95], v9, s[32:35], s48 offen sc1
    v_mfma_f32_16x16x32_bf16 v[36:39], a[44:47], v[144:147], v[36:39]
    ds_read_b128 a[28:31], v4 offset:30720
    v_mfma_f32_16x16x32_bf16 v[72:75], a[32:35], v[124:127], v[72:75]
    v_mfma_f32_16x16x32_bf16 v[72:75], a[36:39], v[132:135], v[72:75]
    v_mfma_f32_16x16x32_bf16 v[72:75], a[40:43], v[140:143], v[72:75]
    s_add_u32 s48, s48, 131072
    v_mfma_f32_16x16x32_bf16 v[72:75], a[44:47], v[148:151], v[72:75]
    buffer_load_dwordx4 v[96:99], v8, s[32:35], s48 offen sc1
    s_waitcnt lgkmcnt(4)
    v_mfma_f32_16x16x32_bf16 v[40:43], a[0:3], v[120:123], v[40:43]
    ds_read_b128 a[32:35], v5 offset:8192
    v_mfma_f32_16x16x32_bf16 v[40:43], a[4:7], v[128:131], v[40:43]
    ds_read_b128 a[36:39], v5 offset:17408
    v_mfma_f32_16x16x32_bf16 v[40:43], a[8:11], v[136:139], v[40:43]
    ds_read_b128 a[40:43], v5 offset:26624
    buffer_load_dwordx4 v[100:103], v9, s[32:35], s48 offen sc1
    v_mfma_f32_16x16x32_bf16 v[40:43], a[12:15], v[144:147], v[40:43]
    ds_read_b128 a[44:47], v5 offset:35840
    v_mfma_f32_16x16x32_bf16 v[76:79], a[0:3], v[124:127], v[76:79]
    v_mfma_f32_16x16x32_bf16 v[76:79], a[4:7], v[132:135], v[76:79]
    v_mfma_f32_16x16x32_bf16 v[76:79], a[8:11], v[140:143], v[76:79]
    s_add_u32 s48, s48, 131072
    v_mfma_f32_16x16x32_bf16 v[76:79], a[12:15], v[148:151], v[76:79]
    buffer_load_dwordx4 v[104:107], v8, s[32:35], s48 offen sc1
    s_waitcnt lgkmcnt(4)
    v_mfma_f32_16x16x32_bf16 v[44:47], a[16:19], v[120:123], v[44:47]
    s_waitcnt vmcnt(32) lgkmcnt(0)
    s_barrier
    v_mfma_f32_16x16x32_bf16 v[44:47], a[20:23], v[128:131], v[44:47]
    s_add_u32 s54, s54, 36864
    s_cmp_ge_u32 s54, 147456
    s_cselect_b32 s54, 0, s54
    v_mfma_f32_16x16x32_bf16 v[44:47], a[24:27], v[136:139], v[44:47]
    v_add_u32 v3, s54, v6
    buffer_load_dwordx4 v[108:111], v9, s[32:35], s48 offen sc1
    v_mfma_f32_16x16x32_bf16 v[44:47], a[28:31], v[144:147], v[44:47]
    ds_read_b128 a[0:3], v3 offset:0
    v_mfma_f32_16x16x32_bf16 v[80:83], a[16:19], v[124:127], v[80:83]
    ds_read_b128 a[4:7], v3 offset:9216
    v_mfma_f32_16x16x32_bf16 v[80:83], a[20:23], v[132:135], v[80:83]
    ds_read_b128 a[8:11], v3 offset:18432
    v_mfma_f32_16x16x32_bf16 v[80:83], a[24:27], v[140:143], v[80:83]
    ds_read_b128 a[12:15], v3 offset:27648
    s_add_u32 s48, s48, 131072
    v_mfma_f32_16x16x32_bf16 v[80:83], a[28:31], v[148:151], v[80:83]
    buffer_load_dwordx4 v[112:115], v8, s[32:35], s48 offen sc1
    s_waitcnt lgkmcnt(4)
    v_mfma_f32_16x16x32_bf16 v[48:51], a[32:35], v[120:123], v[48:51]
    ds_read_b128 a[16:19], v3 offset:1024
    v_mfma_f32_16x16x32_bf16 v[48:51], a[36:39], v[128:131], v[48:51]
    ds_read_b128 a[20:23], v3 offset:10240
    v_mfma_f32_16x16x32_bf16 v[48:51], a[40:43], v[136:139], v[48:51]
    ds_read_b128 a[24:27], v3 offset:19456
    buffer_load_dwordx4 v[116:119], v9, s[32:35], s48 offen sc1
    v_mfma_f32_16x16x32_bf16 v[48:51], a[44:47], v[144:147], v[48:51]
    ds_read_b128 a[28:31], v3 offset:28672
    v_mfma_f32_16x16x32_bf16 v[84:87], a[32:35], v[124:127], v[84:87]
    v_mfma_f32_16x16x32_bf16 v[84:87], a[36:39], v[132:135], v[84:87]
    v_add_u32 v4, s54, v7
    v_add_u32 v5, s54, v2
    v_mfma_f32_16x16x32_bf16 v[84:87], a[40:43], v[140:143], v[84:87]
    s_add_u32 s48, s48, 131072
    v_mfma_f32_16x16x32_bf16 v[84:87], a[44:47], v[148:151], v[84:87]
    s_waitcnt vmcnt(17)
    v_readfirstlane_b32 s11, v247
    s_cmp_lg_u32 s19, 1
    s_cbranch_scc1 LF_b2_ok
    s_cmp_ge_u32 s11, 8
    s_cbranch_scc1 LF_b2_ok
    s_mov_b32 s10, 0
LF_b2_poll:
    v_mov_b32 v247, 0
    buffer_atomic_add v247, v15, s[12:15], s17 offen sc0 sc1
    s_add_u32 s10, s10, 1
    s_waitcnt vmcnt(0)
    v_readfirstlane_b32 s11, v247
    s_nop 0
    s_cmp_ge_u32 s11, 8
    s_cbranch_scc1 LF_b2_go
    s_cmp_lt_u32 s10, 0x20000
    s_cbranch_scc1 LF_b2_poll
LF_b2_go:
LF_b2_ok:
    s_waitcnt vmcnt(17) lgkmcnt(4)
    v_mfma_f32_16x16x32_bf16 v[16:19], a[0:3], v[152:155], v[16:19]
    ds_read_b128 a[32:35], v3 offset:2048
    v_mfma_f32_16x16x32_bf16 v[16:19], a[4:7], v[160:163], v[16:19]
    ds_read_b128 a[36:39], v3 offset:11264
    v_mfma_f32_16x16x32_bf16 v[16:19], a[8:11], v[168:171], v[16:19]
    ds_read_b128 a[40:43], v3 offset:20480
    s_add_u32 m0, s52, 0
    v_mfma_f32_16x16x32_bf16 v[16:19], a[12:15], v[176:179], v[16:19]
    ds_read_b128 a[44:47], v3 offset:29696
    buffer_load_dwordx4 v2, s[36:39], s51 offen offset:0 lds
    v_mfma_f32_16x16x32_bf16 v[52:55], a[0:3], v[156:159], v[52:55]
    v_mfma_f32_16x16x32_bf16 v[52:55], a[4:7], v[164:167], v[52:55]
    v_mfma_f32_16x16x32_bf16 v[52:55], a[8:11], v[172:175], v[52:55]
    buffer_load_dwordx4 v2, s[36:39], s51 offen offset:1024 lds
    v_mfma_f32_16x16x32_bf16 v[52:55], a[12:15], v[180:183], v[52:55]
    s_waitcnt lgkmcnt(4)
    v_mfma_f32_16x16x32_bf16 v[20:23], a[16:19], v[152:155], v[20:23]
    ds_read_b128 a[0:3], v3 offset:3072
    v_mfma_f32_16x16x32_bf16 v[20:23], a[20:23], v[160:163], v[20:23]
    ds_read_b128 a[4:7], v3 offset:12288
    v_mfma_f32_16x16x32_bf16 v[20:23], a[24:27], v[168:171], v[20:23]
    ds_read_b128 a[8:11], v3 offset:21504
    buffer_load_dwordx4 v2, s[36:39], s51 offen offset:2048 lds
    v_mfma_f32_16x16x32_bf16 v[20:23], a[28:31], v[176:179], v[20:23]
    ds_read_b128 a[12:15], v3 offset:30720
    v_mfma_f32_16x16x32_bf16 v[56:59], a[16:19], v[156:159], v[56:59]
    v_mfma_f32_16x16x32_bf16 v[56:59], a[20:23], v[164:167], v[56:59]
    v_mfma_f32_16x16x32_bf16 v[56:59], a[24:27], v[172:175], v[56:59]
    buffer_load_dwordx4 v2, s[36:39], s51 offen offset:3072 lds
    v_mfma_f32_16x16x32_bf16 v[56:59], a[28:31], v[180:183], v[56:59]
    s_waitcnt lgkmcnt(4)
    v_mfma_f32_16x16x32_bf16 v[24:27], a[32:35], v[152:155], v[24:27]
    ds_read_b128 a[16:19], v4 offset:0
    v_mfma_f32_16x16x32_bf16 v[24:27], a[36:39], v[160:163], v[24:27]
    ds_read_b128 a[20:23], v4 offset:9216
    v_mfma_f32_16x16x32_bf16 v[24:27], a[40:43], v[168:171], v[24:27]
    ds_read_b128 a[24:27], v4 offset:18432
    s_add_u32 m0, s52, 4096
    v_mfma_f32_16x16x32_bf16 v[24:27], a[44:47], v[176:179], v[24:27]
    ds_read_b128 a[28:31], v4 offset:27648
    s_add_u32 s53, s51, 4096
    v_mfma_f32_16x16x32_bf16 v[60:63], a[32:35], v[156:159], v[60:63]
    buffer_load_dwordx4 v2, s[36:39], s53 offen offset:0 lds
    v_mfma_f32_16x16x32_bf16 v[60:63], a[36:39], v[164:167], v[60:63]
    v_mfma_f32_16x16x32_bf16 v[60:63], a[40:43], v[172:175], v[60:63]
    buffer_load_dwordx4 v2, s[36:39], s53 offen offset:1024 lds
    v_mfma_f32_16x16x32_bf16 v[60:63], a[44:47], v[180:183], v[60:63]
    s_waitcnt lgkmcnt(4)
    v_mfma_f32_16x16x32_bf16 v[28:31], a[0:3], v[152:155], v[28:31]
    ds_read_b128 a[32:35], v4 offset:1024
    v_mfma_f32_16x16x32_bf16 v[28:31], a[4:7], v[160:163], v[28:31]
    ds_read_b128 a[36:39], v4 offset:10240
    v_mfma_f32_16x16x32_bf16 v[28:31], a[8:11], v[168:171], v[28:31]
    ds_read_b128 a[40:43], v4 offset:19456
    buffer_load_dwordx4 v2, s[36:39], s53 offen offset:2048 lds
    v_mfma_f32_16x16x32_bf16 v[28:31], a[12:15], v[176:179], v[28:31]
    ds_read_b128 a[44:47], v4 offset:28672
    v_mfma_f32_16x16x32_bf16 v[64:67], a[0:3], v[156:159], v[64:67]
    v_mfma_f32_16x16x32_bf16 v[64:67], a[4:7], v[164:167], v[64:67]
    v_mfma_f32_16x16x32_bf16 v[64:67], a[8:11], v[172:175], v[64:67]
    buffer_load_dwordx4 v2, s[36:39], s53 offen offset:3072 lds
    v_mfma_f32_16x16x32_bf16 v[64:67], a[12:15], v[180:183], v[64:67]
    s_waitcnt lgkmcnt(4)
    v_mfma_f32_16x16x32_bf16 v[32:35], a[16:19], v[152:155], v[32:35]
    ds_read_b128 a[0:3], v4 offset:2048
    v_mfma_f32_16x16x32_bf16 v[32:35], a[20:23], v[160:163], v[32:35]
    ds_read_b128 a[4:7], v4 offset:11264
    v_mfma_f32_16x16x32_bf16 v[32:35], a[24:27], v[168:171], v[32:35]
    ds_read_b128 a[8:11], v4 offset:20480
    s_add_u32 m0, s52, 8192
    v_mfma_f32_16x16x32_bf16 v[32:35], a[28:31], v[176:179], v[32:35]
    ds_read_b128 a[12:15], v4 offset:29696
    s_add_u32 s53, s51, 8192
    v_mfma_f32_16x16x32_bf16 v[68:71], a[16:19], v[156:159], v[68:71]
    buffer_load_dwordx4 v2, s[36:39], s53 offen offset:0 lds
    v_mfma_f32_16x16x32_bf16 v[68:71], a[20:23], v[164:167], v[68:71]
    v_mfma_f32_16x16x32_bf16 v[68:71], a[24:27], v[172:175], v[68:71]
    s_add_u32 s51, s51, 36864
    s_add_u32 s52, s52, 36864
    s_cmp_ge_u32 s52, 147456
    s_cselect_b32 s52, s50, s52
    v_mfma_f32_16x16x32_bf16 v[68:71], a[28:31], v[180:183], v[68:71]
    buffer_load_dwordx4 v[120:123], v8, s[32:35], s48 offen sc1
    s_waitcnt lgkmcnt(4)
    v_mfma_f32_16x16x32_bf16 v[36:39], a[32:35], v[152:155], v[36:39]
    ds_read_b128 a[16:19], v4 offset:3072
    v_mfma_f32_16x16x32_bf16 v[36:39], a[36:39], v[160:163], v[36:39]
    ds_read_b128 a[20:23], v4 offset:12288
    v_mfma_f32_16x16x32_bf16 v[36:39], a[40:43], v[168:171], v[36:39]
    ds_read_b128 a[24:27], v4 offset:21504
    buffer_load_dwordx4 v[124:127], v9, s[32:35], s48 offen sc1
    v_mfma_f32_16x16x32_bf16 v[36:39], a[44:47], v[176:179], v[36:39]
    ds_read_b128 a[28:31], v4 offset:30720
    v_mfma_f32_16x16x32_bf16 v[72:75], a[32:35], v[156:159], v[72:75]
    v_mfma_f32_16x16x32_bf16 v[72:75], a[36:39], v[164:167], v[72:75]
    v_mfma_f32_16x16x32_bf16 v[72:75], a[40:43], v[172:175], v[72:75]
    s_add_u32 s48, s48, 131072
    v_mfma_f32_16x16x32_bf16 v[72:75], a[44:47], v[180:183], v[72:75]
    buffer_load_dwordx4 v[128:131], v8, s[32:35], s48 offen sc1
    s_waitcnt lgkmcnt(4)
    v_mfma_f32_16x16x32_bf16 v[40:43], a[0:3], v[152:155], v[40:43]
    ds_read_b128 a[32:35], v5 offset:8192
    v_mfma_f32_16x16x32_bf16 v[40:43], a[4:7], v[160:163], v[40:43]
    ds_read_b128 a[36:39], v5 offset:17408
    v_mfma_f32_16x16x32_bf16 v[40:43], a[8:11], v[168:171], v[40:43]
    ds_read_b128 a[40:43], v5 offset:26624
    buffer_load_dwordx4 v[132:135], v9, s[32:35], s48 offen sc1
    v_mfma_f32_16x16x32_bf16 v[40:43], a[12:15], v[176:179], v[40:43]
    ds_read_b128 a[44:47], v5 offset:35840
    v_mfma_f32_16x16x32_bf16 v[76:79], a[0:3], v[156:159], v[76:79]
    v_mfma_f32_16x16x32_bf16 v[76:79], a[4:7], v[164:167], v[76:79]
    v_mfma_f32_16x16x32_bf16 v[76:79], a[8:11], v[172:175], v[76:79]
    s_add_u32 s48, s48, 131072
    v_mfma_f32_16x16x32_bf16 v[76:79], a[12:15], v[180:183], v[76:79]
    buffer_load_dwordx4 v[136:139], v8, s[32:35], s48 offen sc1
    s_waitcnt lgkmcnt(4)
    v_mfma_f32_16x16x32_bf16 v[44:47], a[16:19], v[152:155], v[44:47]
    s_waitcnt vmcnt(31) lgkmcnt(0)
    s_barrier
    v_mfma_f32_16x16x32_bf16 v[44:47], a[20:23], v[160:163], v[44:47]
    s_add_u32 s54, s54, 36864
    s_cmp_ge_u32 s54, 147456
    s_cselect_b32 s54, 0, s54
    v_mfma_f32_16x16x32_bf16 v[44:47], a[24:27], v[168:171], v[44:47]
    v_add_u32 v3, s54, v6
    buffer_load_dwordx4 v[140:143], v9, s[32:35], s48 offen sc1
    v_mfma_f32_16x16x32_bf16 v[44:47], a[28:31], v[176:179], v[44:47]
    ds_read_b128 a[0:3], v3 offset:0
    v_mfma_f32_16x16x32_bf16 v[80:83], a[16:19], v[156:159], v[80:83]
    ds_read_b128 a[4:7], v3 offset:9216
    v_mfma_f32_16x16x32_bf16 v[80:83], a[20:23], v[164:167], v[80:83]
    ds_read_b128 a[8:11], v3 offset:18432
    v_mfma_f32_16x16x32_bf16 v[80:83], a[24:27], v[172:175], v[80:83]
    ds_read_b128 a[12:15], v3 offset:27648
    s_add_u32 s48, s48, 131072
    v_mfma_f32_16x16x32_bf16 v[80:83], a[28:31], v[180:183], v[80:83]
    buffer_load_dwordx4 v[144:147], v8, s[32:35], s48 offen sc1
    s_waitcnt lgkmcnt(4)
    v_mfma_f32_16x16x32_bf16 v[48:51], a[32:35], v[152:155], v[48:51]
    ds_read_b128 a[16:19], v3 offset:1024
    v_mfma_f32_16x16x32_bf16 v[48:51], a[36:39], v[160:163], v[48:51]
    ds_read_b128 a[20:23], v3 offset:10240
    v_mfma_f32_16x16x32_bf16 v[48:51], a[40:43], v[168:171], v[48:51]
    ds_read_b128 a[24:27], v3 offset:19456
    buffer_load_dwordx4 v[148:151], v9, s[32:35], s48 offen sc1
    v_mfma_f32_16x16x32_bf16 v[48:51], a[44:47], v[176:179], v[48:51]
    ds_read_b128 a[28:31], v3 offset:28672
    v_mfma_f32_16x16x32_bf16 v[84:87], a[32:35], v[156:159], v[84:87]
    v_mfma_f32_16x16x32_bf16 v[84:87], a[36:39], v[164:167], v[84:87]
    v_add_u32 v4, s54, v7
    v_add_u32 v5, s54, v2
    v_mfma_f32_16x16x32_bf16 v[84:87], a[40:43], v[172:175], v[84:87]
    s_add_u32 s48, s48, 131072
    v_mfma_f32_16x16x32_bf16 v[84:87], a[44:47], v[180:183], v[84:87]
    s_add_u32 s19, s19, 1
    s_cmp_lt_u32 s19, 2
    s_cbranch_scc1 LF_loop5
    s_waitcnt vmcnt(17) lgkmcnt(4)
    v_mfma_f32_16x16x32_bf16 v[16:19], a[0:3], v[88:91], v[16:19]
    ds_read_b128 a[32:35], v3 offset:2048
    v_mfma_f32_16x16x32_bf16 v[16:19], a[4:7], v[96:99], v[16:19]
    ds_read_b128 a[36:39], v3 offset:11264
    v_mfma_f32_16x16x32_bf16 v[16:19], a[8:11], v[104:107], v[16:19]
    ds_read_b128 a[40:43], v3 offset:20480
    buffer_load_dwordx4 v[152:155], v8, s[32:35], s48 offen sc1
    v_mfma_f32_16x16x32_bf16 v[16:19], a[12:15], v[112:115], v[16:19]
    ds_read_b128 a[44:47], v3 offset:29696
    v_mfma_f32_16x16x32_bf16 v[52:55], a[0:3], v[92:95], v[52:55]
    v_mfma_f32_16x16x32_bf16 v[52:55], a[4:7], v[100:103], v[52:55]
    v_mfma_f32_16x16x32_bf16 v[52:55], a[8:11], v[108:111], v[52:55]
    buffer_load_dwordx4 v[156:159], v9, s[32:35], s48 offen sc1
    v_mfma_f32_16x16x32_bf16 v[52:55], a[12:15], v[116:119], v[52:55]
    s_waitcnt lgkmcnt(4)
    v_mfma_f32_16x16x32_bf16 v[20:23], a[16:19], v[88:91], v[20:23]
    ds_read_b128 a[0:3], v3 offset:3072
    v_mfma_f32_16x16x32_bf16 v[20:23], a[20:23], v[96:99], v[20:23]
    ds_read_b128 a[4:7], v3 offset:12288
    v_mfma_f32_16x16x32_bf16 v[20:23], a[24:27], v[104:107], v[20:23]
    ds_read_b128 a[8:11], v3 offset:21504
    v_mfma_f32_16x16x32_bf16 v[20:23], a[28:31], v[112:115], v[20:23]
    ds_read_b128 a[12:15], v3 offset:30720
    s_add_u32 s48, s48, 131072
    v_mfma_f32_16x16x32_bf16 v[56:59], a[16:19], v[92:95], v[56:59]
    buffer_load_dwordx4 v[160:163], v8, s[32:35], s48 offen sc1
    v_mfma_f32_16x16x32_bf16 v[56:59], a[20:23], v[100:103], v[56:59]
    v_mfma_f32_16x16x32_bf16 v[56:59], a[24:27], v[108:111], v[56:59]
    v_mfma_f32_16x16x32_bf16 v[56:59], a[28:31], v[116:119], v[56:59]
    s_waitcnt lgkmcnt(4)
    v_mfma_f32_16x16x32_bf16 v[24:27], a[32:35], v[88:91], v[24:27]
    ds_read_b128 a[16:19], v4 offset:0
    buffer_load_dwordx4 v[164:167], v9, s[32:35], s48 offen sc1
    v_mfma_f32_16x16x32_bf16 v[24:27], a[36:39], v[96:99], v[24:27]
    ds_read_b128 a[20:23], v4 offset:9216
    v_mfma_f32_16x16x32_bf16 v[24:27], a[40:43], v[104:107], v[24:27]
    ds_read_b128 a[24:27], v4 offset:18432
    v_mfma_f32_16x16x32_bf16 v[24:27], a[44:47], v[112:115], v[24:27]
    ds_read_b128 a[28:31], v4 offset:27648
    v_mfma_f32_16x16x32_bf16 v[60:63], a[32:35], v[92:95], v[60:63]
    v_mfma_f32_16x16x32_bf16 v[60:63], a[36:39], v[100:103], v[60:63]
    s_add_u32 s48, s48, 131072
    v_mfma_f32_16x16x32_bf16 v[60:63], a[40:43], v[108:111], v[60:63]
    buffer_load_dwordx4 v[168:171], v8, s[32:35], s48 offen sc1
    v_mfma_f32_16x16x32_bf16 v[60:63], a[44:47], v[116:119], v[60:63]
    s_waitcnt lgkmcnt(4)
    v_mfma_f32_16x16x32_bf16 v[28:31], a[0:3], v[88:91], v[28:31]
    ds_read_b128 a[32:35], v4 offset:1024
    v_mfma_f32_16x16x32_bf16 v[28:31], a[4:7], v[96:99], v[28:31]
    ds_read_b128 a[36:39], v4 offset:10240
    buffer_load_dwordx4 v[172:175], v9, s[32:35], s48 offen sc1
    v_mfma_f32_16x16x32_bf16 v[28:31], a[8:11], v[104:107], v[28:31]
    ds_read_b128 a[40:43], v4 offset:19456
    v_mfma_f32_16x16x32_bf16 v[28:31], a[12:15], v[112:115], v[28:31]
    ds_read_b128 a[44:47], v4 offset:28672
    v_mfma_f32_16x16x32_bf16 v[64:67], a[0:3], v[92:95], v[64:67]
    v_mfma_f32_16x16x32_bf16 v[64:67], a[4:7], v[100:103], v[64:67]
    v_mfma_f32_16x16x32_bf16 v[64:67], a[8:11], v[108:111], v[64:67]
    s_add_u32 s48, s48, 131072
    v_mfma_f32_16x16x32_bf16 v[64:67], a[12:15], v[116:119], v[64:67]
    buffer_load_dwordx4 v[176:179], v8, s[32:35], s48 offen sc1
    s_waitcnt lgkmcnt(4)
    v_mfma_f32_16x16x32_bf16 v[32:35], a[16:19], v[88:91], v[32:35]
    ds_read_b128 a[0:3], v4 offset:2048
    v_mfma_f32_16x16x32_bf16 v[32:35], a[20:23], v[96:99], v[32:35]
    ds_read_b128 a[4:7], v4 offset:11264
    v_mfma_f32_16x16x32_bf16 v[32:35], a[24:27], v[104:107], v[32:35]
    ds_read_b128 a[8:11], v4 offset:20480
    v_mfma_f32_16x16x32_bf16 v[32:35], a[28:31], v[112:115], v[32:35]
    ds_read_b128 a[12:15], v4 offset:29696
    buffer_load_dwordx4 v[180:183], v9, s[32:35], s48 offen sc1
    v_mfma_f32_16x16x32_bf16 v[68:71], a[16:19], v[92:95], v[68:71]
    v_mfma_f32_16x16x32_bf16 v[68:71], a[20:23], v[100:103], v[68:71]
    v_mfma_f32_16x16x32_bf16 v[68:71], a[24:27], v[108:111], v[68:71]
    v_mfma_f32_16x16x32_bf16 v[68:71], a[28:31], v[116:119], v[68:71]
    s_waitcnt lgkmcnt(4)
    v_mfma_f32_16x16x32_bf16 v[36:39], a[32:35], v[88:91], v[36:39]
    ds_read_b128 a[16:19], v4 offset:3072
    s_add_u32 s48, s48, 131072
    v_mfma_f32_16x16x32_bf16 v[36:39], a[36:39], v[96:99], v[36:39]
    ds_read_b128 a[20:23], v4 offset:12288
    v_mfma_f32_16x16x32_bf16 v[36:39], a[40:43], v[104:107], v[36:39]
    ds_read_b128 a[24:27], v4 offset:21504
    v_mfma_f32_16x16x32_bf16 v[36:39], a[44:47], v[112:115], v[36:39]
    ds_read_b128 a[28:31], v4 offset:30720
    v_mfma_f32_16x16x32_bf16 v[72:75], a[32:35], v[92:95], v[72:75]
    v_mfma_f32_16x16x32_bf16 v[72:75], a[36:39], v[100:103], v[72:75]
    v_mfma_f32_16x16x32_bf16 v[72:75], a[40:43], v[108:111], v[72:75]
    v_mfma_f32_16x16x32_bf16 v[72:75], a[44:47], v[116:119], v[72:75]
    s_waitcnt lgkmcnt(4)
    v_mfma_f32_16x16x32_bf16 v[40:43], a[0:3], v[88:91], v[40:43]
    ds_read_b128 a[32:35], v5 offset:8192
    v_mfma_f32_16x16x32_bf16 v[40:43], a[4:7], v[96:99], v[40:43]
    ds_read_b128 a[36:39], v5 offset:17408
    v_mfma_f32_16x16x32_bf16 v[40:43], a[8:11], v[104:107], v[40:43]
    ds_read_b128 a[40:43], v5 offset:26624
    v_mfma_f32_16x16x32_bf16 v[40:43], a[12:15], v[112:115], v[40:43]
    ds_read_b128 a[44:47], v5 offset:35840
    v_mfma_f32_16x16x32_bf16 v[76:79], a[0:3], v[92:95], v[76:79]
    v_mfma_f32_16x16x32_bf16 v[76:79], a[4:7], v[100:103], v[76:79]
    v_mfma_f32_16x16x32_bf16 v[76:79], a[8:11], v[108:111], v[76:79]
    v_mfma_f32_16x16x32_bf16 v[76:79], a[12:15], v[116:119], v[76:79]
    s_waitcnt lgkmcnt(4)
    v_mfma_f32_16x16x32_bf16 v[44:47], a[16:19], v[88:91], v[44:47]
    s_waitcnt vmcnt(25) lgkmcnt(0)
    s_barrier
    v_mfma_f32_16x16x32_bf16 v[44:47], a[20:23], v[96:99], v[44:47]
    s_add_u32 s54, s54, 36864
    s_cmp_ge_u32 s54, 147456
    s_cselect_b32 s54, 0, s54
    v_mfma_f32_16x16x32_bf16 v[44:47], a[24:27], v[104:107], v[44:47]
    v_add_u32 v3, s54, v6
    v_add_u32 v4, s54, v7
    v_mfma_f32_16x16x32_bf16 v[44:47], a[28:31], v[112:115], v[44:47]
    ds_read_b128 a[0:3], v4 offset:0
    v_mfma_f32_16x16x32_bf16 v[80:83], a[16:19], v[92:95], v[80:83]
    ds_read_b128 a[4:7], v4 offset:9216
    v_mfma_f32_16x16x32_bf16 v[80:83], a[20:23], v[100:103], v[80:83]
    ds_read_b128 a[8:11], v4 offset:18432
    v_mfma_f32_16x16x32_bf16 v[80:83], a[24:27], v[108:111], v[80:83]
    ds_read_b128 a[12:15], v4 offset:27648
    v_mfma_f32_16x16x32_bf16 v[80:83], a[28:31], v[116:119], v[80:83]
    s_waitcnt lgkmcnt(4)
    v_mfma_f32_16x16x32_bf16 v[48:51], a[32:35], v[88:91], v[48:51]
    ds_read_b128 a[48:51], v3 offset:0
    v_mfma_f32_16x16x32_bf16 v[48:51], a[36:39], v[96:99], v[48:51]
    ds_read_b128 a[52:55], v3 offset:9216
    v_mfma_f32_16x16x32_bf16 v[48:51], a[40:43], v[104:107], v[48:51]
    ds_read_b128 a[56:59], v3 offset:18432
    v_mfma_f32_16x16x32_bf16 v[48:51], a[44:47], v[112:115], v[48:51]
    ds_read_b128 a[60:63], v3 offset:27648
    v_mfma_f32_16x16x32_bf16 v[84:87], a[32:35], v[92:95], v[84:87]
    v_mfma_f32_16x16x32_bf16 v[84:87], a[36:39], v[100:103], v[84:87]
    v_add_u32 v4, s54, v7
    v_add_u32 v5, s54, v2
    v_mfma_f32_16x16x32_bf16 v[84:87], a[40:43], v[108:111], v[84:87]
    v_mfma_f32_16x16x32_bf16 v[84:87], a[44:47], v[116:119], v[84:87]
    s_waitcnt vmcnt(8) lgkmcnt(4)
    v_mfma_f32_16x16x32_bf16 v[32:35], a[0:3], v[120:123], v[32:35]
    ds_read_b128 a[32:35], v4 offset:1024
    v_mfma_f32_16x16x32_bf16 v[32:35], a[4:7], v[128:131], v[32:35]
    ds_read_b128 a[36:39], v4 offset:10240
    v_mfma_f32_16x16x32_bf16 v[32:35], a[8:11], v[136:139], v[32:35]
    ds_read_b128 a[40:43], v4 offset:19456
    v_mfma_f32_16x16x32_bf16 v[32:35], a[12:15], v[144:147], v[32:35]
    ds_read_b128 a[44:47], v4 offset:28672
    v_mfma_f32_16x16x32_bf16 v[68:71], a[0:3], v[124:127], v[68:71]
    v_mfma_f32_16x16x32_bf16 v[68:71], a[4:7], v[132:135], v[68:71]
    v_mfma_f32_16x16x32_bf16 v[68:71], a[8:11], v[140:143], v[68:71]
    v_mfma_f32_16x16x32_bf16 v[68:71], a[12:15], v[148:151], v[68:71]
    s_waitcnt lgkmcnt(4)
    v_mfma_f32_16x16x32_bf16 v[52:55], a[48:51], v[124:127], v[52:55]
    ds_read_b128 a[64:67], v3 offset:1024
    v_mfma_f32_16x16x32_bf16 v[52:55], a[52:55], v[132:135], v[52:55]
    ds_read_b128 a[68:71], v3 offset:10240
    v_mfma_f32_16x16x32_bf16 v[52:55], a[56:59], v[140:143], v[52:55]
    ds_read_b128 a[72:75], v3 offset:19456
    v_mfma_f32_16x16x32_bf16 v[52:55], a[60:63], v[148:151], v[52:55]
    ds_read_b128 a[76:79], v3 offset:28672
    s_waitcnt lgkmcnt(4)
    v_mfma_f32_16x16x32_bf16 v[36:39], a[32:35], v[120:123], v[36:39]
    ds_read_b128 a[16:19], v4 offset:2048
    v_mfma_f32_16x16x32_bf16 v[36:39], a[36:39], v[128:131], v[36:39]
    ds_read_b128 a[20:23], v4 offset:11264
    v_mfma_f32_16x16x32_bf16 v[36:39], a[40:43], v[136:139], v[36:39]
    ds_read_b128 a[24:27], v4 offset:20480
    v_mfma_f32_16x16x32_bf16 v[36:39], a[44:47], v[144:147], v[36:39]
    ds_read_b128 a[28:31], v4 offset:29696
    v_mfma_f32_16x16x32_bf16 v[72:75], a[32:35], v[124:127], v[72:75]
    v_mfma_f32_16x16x32_bf16 v[72:75], a[36:39], v[132:135], v[72:75]
    v_mfma_f32_16x16x32_bf16 v[72:75], a[40:43], v[140:143], v[72:75]
    v_mfma_f32_16x16x32_bf16 v[72:75], a[44:47], v[148:151], v[72:75]
    s_waitcnt lgkmcnt(4)
    v_mfma_f32_16x16x32_bf16 v[56:59], a[64:67], v[124:127], v[56:59]
    ds_read_b128 a[80:83], v3 offset:2048
    v_mfma_f32_16x16x32_bf16 v[56:59], a[68:71], v[132:135], v[56:59]
    ds_read_b128 a[84:87], v3 offset:11264
    v_mfma_f32_16x16x32_bf16 v[56:59], a[72:75], v[140:143], v[56:59]
    ds_read_b128 a[88:91], v3 offset:20480
    v_mfma_f32_16x16x32_bf16 v[56:59], a[76:79], v[148:151], v[56:59]
    ds_read_b128 a[92:95], v3 offset:29696
    s_waitcnt lgkmcnt(4)
    v_mfma_f32_16x16x32_bf16 v[40:43], a[16:19], v[120:123], v[40:43]
    ds_read_b128 a[0:3], v4 offset:3072
    v_mfma_f32_16x16x32_bf16 v[40:43], a[20:23], v[128:131], v[40:43]
    ds_read_b128 a[4:7], v4 offset:12288
    v_mfma_f32_16x16x32_bf16 v[40:43], a[24:27], v[136:139], v[40:43]
    ds_read_b128 a[8:11], v4 offset:21504
    v_mfma_f32_16x16x32_bf16 v[40:43], a[28:31], v[144:147], v[40:43]
    ds_read_b128 a[12:15], v4 offset:30720
    v_mfma_f32_16x16x32_bf16 v[76:79], a[16:19], v[124:127], v[76:79]
    v_mfma_f32_16x16x32_bf16 v[76:79], a[20:23], v[132:135], v[76:79]
    v_mfma_f32_16x16x32_bf16 v[76:79], a[24:27], v[140:143], v[76:79]
    v_mfma_f32_16x16x32_bf16 v[76:79], a[28:31], v[148:151], v[76:79]
    s_waitcnt lgkmcnt(4)
    v_mfma_f32_16x16x32_bf16 v[60:63], a[80:83], v[124:127], v[60:63]
    ds_read_b128 a[96:99], v3 offset:3072
    v_mfma_f32_16x16x32_bf16 v[60:63], a[84:87], v[132:135], v[60:63]
    ds_read_b128 a[100:103], v3 offset:12288
    v_mfma_f32_16x16x32_bf16 v[60:63], a[88:91], v[140:143], v[60:63]
    ds_read_b128 a[104:107], v3 offset:21504
    v_mfma_f32_16x16x32_bf16 v[60:63], a[92:95], v[148:151], v[60:63]
    ds_read_b128 a[108:111], v3 offset:30720
    s_waitcnt lgkmcnt(4)
    v_mfma_f32_16x16x32_bf16 v[44:47], a[0:3], v[120:123], v[44:47]
    ds_read_b128 a[32:35], v5 offset:8192
    v_mfma_f32_16x16x32_bf16 v[44:47], a[4:7], v[128:131], v[44:47]
    ds_read_b128 a[36:39], v5 offset:17408
    v_mfma_f32_16x16x32_bf16 v[44:47], a[8:11], v[136:139], v[44:47]
    ds_read_b128 a[40:43], v5 offset:26624
    v_mfma_f32_16x16x32_bf16 v[44:47], a[12:15], v[144:147], v[44:47]
    ds_read_b128 a[44:47], v5 offset:35840
    v_mfma_f32_16x16x32_bf16 v[80:83], a[0:3], v[124:127], v[80:83]
    v_mfma_f32_16x16x32_bf16 v[80:83], a[4:7], v[132:135], v[80:83]
    v_mfma_f32_16x16x32_bf16 v[80:83], a[8:11], v[140:143], v[80:83]
    v_mfma_f32_16x16x32_bf16 v[80:83], a[12:15], v[148:151], v[80:83]
    s_waitcnt lgkmcnt(4)
    v_mfma_f32_16x16x32_bf16 v[64:67], a[96:99], v[124:127], v[64:67]
    s_barrier
    v_mfma_f32_16x16x32_bf16 v[64:67], a[100:103], v[132:135], v[64:67]
    s_add_u32 s54, s54, 36864
    s_cmp_ge_u32 s54, 147456
    s_cselect_b32 s54, 0, s54
    v_add_u32 v4, s54, v7
    v_mfma_f32_16x16x32_bf16 v[64:67], a[104:107], v[140:143], v[64:67]
    v_add_u32 v3, s54, v6
    ds_read_b128 a[0:3], v4 offset:0
    v_mfma_f32_16x16x32_bf16 v[64:67], a[108:111], v[148:151], v[64:67]
    ds_read_b128 a[4:7], v4 offset:9216
    ds_read_b128 a[8:11], v4 offset:18432
    s_waitcnt lgkmcnt(3)
    v_mfma_f32_16x16x32_bf16 v[48:51], a[32:35], v[120:123], v[48:51]
    ds_read_b128 a[12:15], v4 offset:27648
    v_add_u32 v5, s54, v2
    ds_read_b128 a[112:115], v3 offset:0
    v_mfma_f32_16x16x32_bf16 v[48:51], a[36:39], v[128:131], v[48:51]
    ds_read_b128 a[116:119], v3 offset:9216
    v_mfma_f32_16x16x32_bf16 v[48:51], a[40:43], v[136:139], v[48:51]
    ds_read_b128 a[120:123], v3 offset:18432
    v_mfma_f32_16x16x32_bf16 v[48:51], a[44:47], v[144:147], v[48:51]
    ds_read_b128 a[124:127], v3 offset:27648
    v_mfma_f32_16x16x32_bf16 v[84:87], a[32:35], v[124:127], v[84:87]
    v_mfma_f32_16x16x32_bf16 v[84:87], a[36:39], v[132:135], v[84:87]
    v_mfma_f32_16x16x32_bf16 v[84:87], a[40:43], v[140:143], v[84:87]
    v_mfma_f32_16x16x32_bf16 v[84:87], a[44:47], v[148:151], v[84:87]
    s_waitcnt vmcnt(0) lgkmcnt(4)
    v_mfma_f32_16x16x32_bf16 v[32:35], a[0:3], v[152:155], v[32:35]
    ds_read_b128 a[32:35], v4 offset:1024
    v_mfma_f32_16x16x32_bf16 v[32:35], a[4:7], v[160:163], v[32:35]
    ds_read_b128 a[36:39], v4 offset:10240
    v_mfma_f32_16x16x32_bf16 v[32:35], a[8:11], v[168:171], v[32:35]
    ds_read_b128 a[40:43], v4 offset:19456
    v_mfma_f32_16x16x32_bf16 v[32:35], a[12:15], v[176:179], v[32:35]
    ds_read_b128 a[44:47], v4 offset:28672
    v_mfma_f32_16x16x32_bf16 v[68:71], a[0:3], v[156:159], v[68:71]
    v_mfma_f32_16x16x32_bf16 v[68:71], a[4:7], v[164:167], v[68:71]
    v_mfma_f32_16x16x32_bf16 v[68:71], a[8:11], v[172:175], v[68:71]
    v_mfma_f32_16x16x32_bf16 v[68:71], a[12:15], v[180:183], v[68:71]
    s_waitcnt lgkmcnt(4)
    v_mfma_f32_16x16x32_bf16 v[52:55], a[112:115], v[156:159], v[52:55]
    ds_read_b128 a[128:131], v3 offset:1024
    v_mfma_f32_16x16x32_bf16 v[52:55], a[116:119], v[164:167], v[52:55]
    ds_read_b128 a[132:135], v3 offset:10240
    v_mfma_f32_16x16x32_bf16 v[52:55], a[120:123], v[172:175], v[52:55]
    ds_read_b128 a[136:139], v3 offset:19456
    v_mfma_f32_16x16x32_bf16 v[52:55], a[124:127], v[180:183], v[52:55]
    ds_read_b128 a[140:143], v3 offset:28672
    s_waitcnt lgkmcnt(4)
    v_mfma_f32_16x16x32_bf16 v[36:39], a[32:35], v[152:155], v[36:39]
    ds_read_b128 a[16:19], v4 offset:2048
    v_mfma_f32_16x16x32_bf16 v[36:39], a[36:39], v[160:163], v[36:39]
    ds_read_b128 a[20:23], v4 offset:11264
    v_mfma_f32_16x16x32_bf16 v[36:39], a[40:43], v[168:171], v[36:39]
    ds_read_b128 a[24:27], v4 offset:20480
    v_mfma_f32_16x16x32_bf16 v[36:39], a[44:47], v[176:179], v[36:39]
    ds_read_b128 a[28:31], v4 offset:29696
    v_mfma_f32_16x16x32_bf16 v[72:75], a[32:35], v[156:159], v[72:75]
    v_mfma_f32_16x16x32_bf16 v[72:75], a[36:39], v[164:167], v[72:75]
    v_mfma_f32_16x16x32_bf16 v[72:75], a[40:43], v[172:175], v[72:75]
    v_mfma_f32_16x16x32_bf16 v[72:75], a[44:47], v[180:183], v[72:75]
    s_waitcnt lgkmcnt(4)
    v_mfma_f32_16x16x32_bf16 v[56:59], a[128:131], v[156:159], v[56:59]
    ds_read_b128 a[144:147], v3 offset:2048
    v_mfma_f32_16x16x32_bf16 v[56:59], a[132:135], v[164:167], v[56:59]
    ds_read_b128 a[148:151], v3 offset:11264
    v_mfma_f32_16x16x32_bf16 v[56:59], a[136:139], v[172:175], v[56:59]
    ds_read_b128 a[152:155], v3 offset:20480
    v_mfma_f32_16x16x32_bf16 v[56:59], a[140:143], v[180:183], v[56:59]
    ds_read_b128 a[156:159], v3 offset:29696
    s_waitcnt lgkmcnt(4)
    v_mfma_f32_16x16x32_bf16 v[40:43], a[16:19], v[152:155], v[40:43]
    ds_read_b128 a[0:3], v4 offset:3072
    v_cvt_pk_bf16_f32 v184, v32, v33
    v_mfma_f32_16x16x32_bf16 v[40:43], a[20:23], v[160:163], v[40:43]
    ds_read_b128 a[4:7], v4 offset:12288
    v_cvt_pk_bf16_f32 v185, v34, v35
    v_mfma_f32_16x16x32_bf16 v[40:43], a[24:27], v[168:171], v[40:43]
    ds_read_b128 a[8:11], v4 offset:21504
    v_cvt_pk_bf16_f32 v186, v36, v37
    v_mfma_f32_16x16x32_bf16 v[40:43], a[28:31], v[176:179], v[40:43]
    ds_read_b128 a[12:15], v4 offset:30720
    v_cvt_pk_bf16_f32 v187, v38, v39
    v_mfma_f32_16x16x32_bf16 v[76:79], a[16:19], v[156:159], v[76:79]
    buffer_store_dwordx4 v[184:187], v2, s[40:43], s60 offen offset:0 sc1
    v_mfma_f32_16x16x32_bf16 v[76:79], a[20:23], v[164:167], v[76:79]
    v_mfma_f32_16x16x32_bf16 v[76:79], a[24:27], v[172:175], v[76:79]
    v_cvt_pk_bf16_f32 v188, v68, v69
    v_cvt_pk_bf16_f32 v189, v70, v71
    v_mfma_f32_16x16x32_bf16 v[76:79], a[28:31], v[180:183], v[76:79]
    v_cvt_pk_bf16_f32 v190, v72, v73
    v_cvt_pk_bf16_f32 v191, v74, v75
    s_waitcnt lgkmcnt(4)
    v_mfma_f32_16x16x32_bf16 v[60:63], a[144:147], v[156:159], v[60:63]
    ds_read_b128 a[160:163], v3 offset:3072
    buffer_store_dwordx4 v[188:191], v2, s[40:43], s62 offen offset:0 sc1
    v_mfma_f32_16x16x32_bf16 v[60:63], a[148:151], v[164:167], v[60:63]
    ds_read_b128 a[164:167], v3 offset:12288
    v_mfma_f32_16x16x32_bf16 v[60:63], a[152:155], v[172:175], v[60:63]
    ds_read_b128 a[168:171], v3 offset:21504
    v_cvt_pk_bf16_f32 v192, v52, v53
    v_mfma_f32_16x16x32_bf16 v[60:63], a[156:159], v[180:183], v[60:63]
    ds_read_b128 a[172:175], v3 offset:30720
    v_cvt_pk_bf16_f32 v193, v54, v55
    s_waitcnt lgkmcnt(4)
    v_mfma_f32_16x16x32_bf16 v[44:47], a[0:3], v[152:155], v[44:47]
    ds_read_b128 a[32:35], v5 offset:8192
    v_cvt_pk_bf16_f32 v194, v56, v57
    v_mfma_f32_16x16x32_bf16 v[44:47], a[4:7], v[160:163], v[44:47]
    ds_read_b128 a[36:39], v5 offset:17408
    v_cvt_pk_bf16_f32 v195, v58, v59
    v_mfma_f32_16x16x32_bf16 v[44:47], a[8:11], v[168:171], v[44:47]
    ds_read_b128 a[40:43], v5 offset:26624
    buffer_store_dwordx4 v[192:195], v2, s[40:43], s61 offen offset:0 sc1
    v_mfma_f32_16x16x32_bf16 v[44:47], a[12:15], v[176:179], v[44:47]
    ds_read_b128 a[44:47], v5 offset:35840
    v_mfma_f32_16x16x32_bf16 v[80:83], a[0:3], v[156:159], v[80:83]
    v_mfma_f32_16x16x32_bf16 v[80:83], a[4:7], v[164:167], v[80:83]
    v_mfma_f32_16x16x32_bf16 v[80:83], a[8:11], v[172:175], v[80:83]
    v_mfma_f32_16x16x32_bf16 v[80:83], a[12:15], v[180:183], v[80:83]
    s_waitcnt lgkmcnt(4)
    v_mfma_f32_16x16x32_bf16 v[64:67], a[160:163], v[156:159], v[64:67]
    v_mfma_f32_16x16x32_bf16 v[64:67], a[164:167], v[164:167], v[64:67]
    v_mfma_f32_16x16x32_bf16 v[64:67], a[168:171], v[172:175], v[64:67]
    v_mfma_f32_16x16x32_bf16 v[64:67], a[172:175], v[180:183], v[64:67]
    s_waitcnt lgkmcnt(0)
    v_mfma_f32_16x16x32_bf16 v[48:51], a[32:35], v[152:155], v[48:51]
    v_cvt_pk_bf16_f32 v196, v40, v41
    v_cvt_pk_bf16_f32 v197, v42, v43
    v_mfma_f32_16x16x32_bf16 v[48:51], a[36:39], v[160:163], v[48:51]
    v_cvt_pk_bf16_f32 v198, v44, v45
    v_cvt_pk_bf16_f32 v199, v46, v47
    v_mfma_f32_16x16x32_bf16 v[48:51], a[40:43], v[168:171], v[48:51]
    buffer_store_dwordx4 v[196:199], v2, s[40:43], s60 offen offset:1024 sc1
    v_mfma_f32_16x16x32_bf16 v[48:51], a[44:47], v[176:179], v[48:51]
    v_mfma_f32_16x16x32_bf16 v[84:87], a[32:35], v[156:159], v[84:87]
    v_cvt_pk_bf16_f32 v200, v76, v77
    v_cvt_pk_bf16_f32 v201, v78, v79
    v_mfma_f32_16x16x32_bf16 v[84:87], a[36:39], v[164:167], v[84:87]
    v_cvt_pk_bf16_f32 v202, v80, v81
    v_cvt_pk_bf16_f32 v203, v82, v83
    v_mfma_f32_16x16x32_bf16 v[84:87], a[40:43], v[172:175], v[84:87]
    buffer_store_dwordx4 v[200:203], v2, s[40:43], s62 offen offset:1024 sc1
    v_mfma_f32_16x16x32_bf16 v[84:87], a[44:47], v[180:183], v[84:87]
    v_mfma_f32_16x16x32_bf16 v[16:19], a[48:51], v[120:123], v[16:19]
    v_cvt_pk_bf16_f32 v204, v60, v61
    v_cvt_pk_bf16_f32 v205, v62, v63
    v_mfma_f32_16x16x32_bf16 v[16:19], a[52:55], v[128:131], v[16:19]
    v_cvt_pk_bf16_f32 v206, v64, v65
    v_cvt_pk_bf16_f32 v207, v66, v67
    v_mfma_f32_16x16x32_bf16 v[16:19], a[56:59], v[136:139], v[16:19]
    buffer_store_dwordx4 v[204:207], v2, s[40:43], s61 offen offset:1024 sc1
    v_mfma_f32_16x16x32_bf16 v[16:19], a[60:63], v[144:147], v[16:19]
    v_mfma_f32_16x16x32_bf16 v[20:23], a[64:67], v[120:123], v[20:23]
    v_cvt_pk_bf16_f32 v208, v48, v49
    v_cvt_pk_bf16_f32 v209, v50, v51
    v_mfma_f32_16x16x32_bf16 v[20:23], a[68:71], v[128:131], v[20:23]
    buffer_store_dwordx2 v[208:209], v244, s[40:43], s63 offen offset:2048 sc1
    v_mfma_f32_16x16x32_bf16 v[20:23], a[72:75], v[136:139], v[20:23]
    v_mfma_f32_16x16x32_bf16 v[20:23], a[76:79], v[144:147], v[20:23]
    v_cvt_pk_bf16_f32 v210, v84, v85
    v_cvt_pk_bf16_f32 v211, v86, v87
    v_mfma_f32_16x16x32_bf16 v[24:27], a[80:83], v[120:123], v[24:27]
    buffer_store_dwordx2 v[210:211], v244, s[40:43], s68 offen offset:2048 sc1
    v_mfma_f32_16x16x32_bf16 v[24:27], a[84:87], v[128:131], v[24:27]
    v_mfma_f32_16x16x32_bf16 v[24:27], a[88:91], v[136:139], v[24:27]
    v_mfma_f32_16x16x32_bf16 v[24:27], a[92:95], v[144:147], v[24:27]
    v_mfma_f32_16x16x32_bf16 v[28:31], a[96:99], v[120:123], v[28:31]
    v_mfma_f32_16x16x32_bf16 v[28:31], a[100:103], v[128:131], v[28:31]
    v_mfma_f32_16x16x32_bf16 v[28:31], a[104:107], v[136:139], v[28:31]
    v_mfma_f32_16x16x32_bf16 v[28:31], a[108:111], v[144:147], v[28:31]
    v_mfma_f32_16x16x32_bf16 v[16:19], a[112:115], v[152:155], v[16:19]
    v_mfma_f32_16x16x32_bf16 v[16:19], a[116:119], v[160:163], v[16:19]
    v_mfma_f32_16x16x32_bf16 v[16:19], a[120:123], v[168:171], v[16:19]
    v_mfma_f32_16x16x32_bf16 v[16:19], a[124:127], v[176:179], v[16:19]
    v_mfma_f32_16x16x32_bf16 v[20:23], a[128:131], v[152:155], v[20:23]
    v_mfma_f32_16x16x32_bf16 v[20:23], a[132:135], v[160:163], v[20:23]
    v_mfma_f32_16x16x32_bf16 v[20:23], a[136:139], v[168:171], v[20:23]
    v_mfma_f32_16x16x32_bf16 v[20:23], a[140:143], v[176:179], v[20:23]
    v_mfma_f32_16x16x32_bf16 v[24:27], a[144:147], v[152:155], v[24:27]
    v_mfma_f32_16x16x32_bf16 v[24:27], a[148:151], v[160:163], v[24:27]
    v_mfma_f32_16x16x32_bf16 v[24:27], a[152:155], v[168:171], v[24:27]
    v_mfma_f32_16x16x32_bf16 v[24:27], a[156:159], v[176:179], v[24:27]
    v_mfma_f32_16x16x32_bf16 v[28:31], a[160:163], v[152:155], v[28:31]
    v_mfma_f32_16x16x32_bf16 v[28:31], a[164:167], v[160:163], v[28:31]
    v_mfma_f32_16x16x32_bf16 v[28:31], a[168:171], v[168:171], v[28:31]
    v_mfma_f32_16x16x32_bf16 v[28:31], a[172:175], v[176:179], v[28:31]
    v_lshlrev_b32 v56, 16, v212
    v_and_b32 v57, s20, v212
    v_lshlrev_b32 v58, 16, v213
    v_and_b32 v59, s20, v213
    v_lshlrev_b32 v60, 16, v214
    v_and_b32 v61, s20, v214
    v_lshlrev_b32 v62, 16, v215
    v_and_b32 v63, s20, v215
    v_lshlrev_b32 v64, 16, v216
    v_and_b32 v65, s20, v216
    v_lshlrev_b32 v66, 16, v217
    v_and_b32 v67, s20, v217
    v_lshlrev_b32 v68, 16, v218
    v_and_b32 v69, s20, v218
    v_lshlrev_b32 v70, 16, v219
    v_and_b32 v71, s20, v219
    v_lshlrev_b32 v72, 16, v220
    v_and_b32 v73, s20, v220
    v_lshlrev_b32 v74, 16, v221
    v_and_b32 v75, s20, v221
    s_waitcnt vmcnt(0)
    buffer_atomic_add v14, v15, s[12:15], s69 offen sc1
    s_mov_b32 s10, 0
LF_c_poll:
    s_mov_b32 s11, 0
    s_atomic_add s11, s[12:13], s69 glc
    s_add_u32 s10, s10, 1
    s_waitcnt lgkmcnt(0)
    s_cmp_ge_u32 s11, 4
    s_cbranch_scc1 LF_c_go
    s_cmp_lt_u32 s10, 0x20000
    s_cbranch_scc1 LF_c_poll
LF_c_go:
    buffer_load_dwordx4 v[88:91], v2, s[40:43], s16 offen offset:0 sc1
    buffer_load_dwordx4 v[92:95], v2, s[40:43], s16 offen offset:1024 sc1
    buffer_load_dwordx2 v[96:97], v245, s[40:43], s16 offen offset:2048 sc1
    s_add_u32 s16, s16, 10240
    buffer_load_dwordx4 v[100:103], v2, s[40:43], s16 offen offset:0 sc1
    buffer_load_dwordx4 v[104:107], v2, s[40:43], s16 offen offset:1024 sc1
    buffer_load_dwordx2 v[108:109], v245, s[40:43], s16 offen offset:2048 sc1
    s_add_u32 s16, s16, 10240
    buffer_load_dwordx4 v[112:115], v2, s[40:43], s16 offen offset:0 sc1
    buffer_load_dwordx4 v[116:119], v2, s[40:43], s16 offen offset:1024 sc1
    buffer_load_dwordx2 v[120:121], v245, s[40:43], s16 offen offset:2048 sc1
    s_waitcnt vmcnt(6)
    v_lshlrev_b32 v128, 16, v88
    v_and_b32 v129, s20, v88
    v_lshlrev_b32 v130, 16, v89
    v_and_b32 v131, s20, v89
    v_lshlrev_b32 v132, 16, v90
    v_and_b32 v133, s20, v90
    v_lshlrev_b32 v134, 16, v91
    v_and_b32 v135, s20, v91
    v_lshlrev_b32 v136, 16, v92
    v_and_b32 v137, s20, v92
    v_lshlrev_b32 v138, 16, v93
    v_and_b32 v139, s20, v93
    v_lshlrev_b32 v140, 16, v94
    v_and_b32 v141, s20, v94
    v_lshlrev_b32 v142, 16, v95
    v_and_b32 v143, s20, v95
    v_lshlrev_b32 v144, 16, v96
    v_and_b32 v145, s20, v96
    v_lshlrev_b32 v146, 16, v97
    v_and_b32 v147, s20, v97
    v_pk_add_f32 v[16:17], v[16:17], v[128:129]
    v_pk_add_f32 v[18:19], v[18:19], v[130:131]
    v_pk_add_f32 v[20:21], v[20:21], v[132:133]
    v_pk_add_f32 v[22:23], v[22:23], v[134:135]
    v_pk_add_f32 v[24:25], v[24:25], v[136:137]
    v_pk_add_f32 v[26:27], v[26:27], v[138:139]
    v_pk_add_f32 v[28:29], v[28:29], v[140:141]
    v_pk_add_f32 v[30:31], v[30:31], v[142:143]
    v_pk_add_f32 v[48:49], v[48:49], v[144:145]
    v_pk_add_f32 v[50:51], v[50:51], v[146:147]
    s_waitcnt vmcnt(3)
    v_lshlrev_b32 v128, 16, v100
    v_and_b32 v129, s20, v100
    v_lshlrev_b32 v130, 16, v101
    v_and_b32 v131, s20, v101
    v_lshlrev_b32 v132, 16, v102
    v_and_b32 v133, s20, v102
    v_lshlrev_b32 v134, 16, v103
    v_and_b32 v135, s20, v103
    v_lshlrev_b32 v136, 16, v104
    v_and_b32 v137, s20, v104
    v_lshlrev_b32 v138, 16, v105
    v_and_b32 v139, s20, v105
    v_lshlrev_b32 v140, 16, v106
    v_and_b32 v141, s20, v106
    v_lshlrev_b32 v142, 16, v107
    v_and_b32 v143, s20, v107
    v_lshlrev_b32 v144, 16, v108
    v_and_b32 v145, s20, v108
    v_lshlrev_b32 v146, 16, v109
    v_and_b32 v147, s20, v109
    v_pk_add_f32 v[16:17], v[16:17], v[128:129]
    v_pk_add_f32 v[18:19], v[18:19], v[130:131]
    v_pk_add_f32 v[20:21], v[20:21], v[132:133]
    v_pk_add_f32 v[22:23], v[22:23], v[134:135]
    v_pk_add_f32 v[24:25], v[24:25], v[136:137]
    v_pk_add_f32 v[26:27], v[26:27], v[138:139]
    v_pk_add_f32 v[28:29], v[28:29], v[140:141]
    v_pk_add_f32 v[30:31], v[30:31], v[142:143]
    v_pk_add_f32 v[48:49], v[48:49], v[144:145]
    v_pk_add_f32 v[50:51], v[50:51], v[146:147]
    s_waitcnt vmcnt(0)
    v_lshlrev_b32 v128, 16, v112
    v_and_b32 v129, s20, v112
    v_lshlrev_b32 v130, 16, v113
    v_and_b32 v131, s20, v113
    v_lshlrev_b32 v132, 16, v114
    v_and_b32 v133, s20, v114
    v_lshlrev_b32 v134, 16, v115
    v_and_b32 v135, s20, v115
    v_lshlrev_b32 v136, 16, v116
    v_and_b32 v137, s20, v116
    v_lshlrev_b32 v138, 16, v117
    v_and_b32 v139, s20, v117
    v_lshlrev_b32 v140, 16, v118
    v_and_b32 v141, s20, v118
    v_lshlrev_b32 v142, 16, v119
    v_and_b32 v143, s20, v119
    v_lshlrev_b32 v144, 16, v120
    v_and_b32 v145, s20, v120
    v_lshlrev_b32 v146, 16, v121
    v_and_b32 v147, s20, v121
    v_pk_add_f32 v[16:17], v[16:17], v[128:129]
    v_pk_add_f32 v[18:19], v[18:19], v[130:131]
    v_pk_add_f32 v[20:21], v[20:21], v[132:133]
    v_pk_add_f32 v[22:23], v[22:23], v[134:135]
    v_pk_add_f32 v[24:25], v[24:25], v[136:137]
    v_pk_add_f32 v[26:27], v[26:27], v[138:139]
    v_pk_add_f32 v[28:29], v[28:29], v[140:141]
    v_pk_add_f32 v[30:31], v[30:31], v[142:143]
    v_pk_add_f32 v[48:49], v[48:49], v[144:145]
    v_pk_add_f32 v[50:51], v[50:51], v[146:147]
    v_pk_fma_f32 v[56:57], v[16:17], v[224:225], v[56:57]
    v_pk_fma_f32 v[58:59], v[18:19], v[226:227], v[58:59]
    v_pk_fma_f32 v[60:61], v[20:21], v[228:229], v[60:61]
    v_pk_fma_f32 v[62:63], v[22:23], v[230:231], v[62:63]
    v_pk_fma_f32 v[64:65], v[24:25], v[232:233], v[64:65]
    v_pk_fma_f32 v[66:67], v[26:27], v[234:235], v[66:67]
    v_pk_fma_f32 v[68:69], v[28:29], v[236:237], v[68:69]
    v_pk_fma_f32 v[70:71], v[30:31], v[238:239], v[70:71]
    v_pk_fma_f32 v[72:73], v[48:49], v[240:241], v[72:73]
    v_pk_fma_f32 v[74:75], v[50:51], v[242:243], v[74:75]
    v_cvt_pk_bf16_f32 v212, v56, v57
    v_cvt_pk_bf16_f32 v213, v58, v59
    v_cvt_pk_bf16_f32 v214, v60, v61
    v_cvt_pk_bf16_f32 v215, v62, v63
    v_cvt_pk_bf16_f32 v216, v64, v65
    v_cvt_pk_bf16_f32 v217, v66, v67
    v_cvt_pk_bf16_f32 v218, v68, v69
    v_cvt_pk_bf16_f32 v219, v70, v71
    v_cvt_pk_bf16_f32 v220, v72, v73
    v_cvt_pk_bf16_f32 v221, v74, v75
    buffer_store_dwordx4 v[212:215], v12, s[64:67], 0 offen
    buffer_store_dwordx4 v[216:219], v250, s[64:67], 0 offen
    buffer_store_dwordx2 v[220:221], v13, s[64:67], 0 offen
LF_exit:
    s_endpgm
.section .rodata,"a"
.p2align 6
.amdhsa_kernel k0_kernel
  .amdhsa_next_free_vgpr 128
  .amdhsa_next_free_sgpr 100
  .amdhsa_accum_offset 128
  .amdhsa_group_segment_fixed_size 0
  .amdhsa_kernarg_size 96
  .amdhsa_user_sgpr_count 2
  .amdhsa_user_sgpr_kernarg_segment_ptr 1
  .amdhsa_system_sgpr_workgroup_id_x 1
  .amdhsa_float_denorm_mode_32 3
.end_amdhsa_kernel
.section .rodata,"a"
.p2align 6
.amdhsa_kernel k1_kernel
  .amdhsa_next_free_vgpr 320
  .amdhsa_next_free_sgpr 100
  .amdhsa_accum_offset 256
  .amdhsa_group_segment_fixed_size 0
  .amdhsa_kernarg_size 96
  .amdhsa_user_sgpr_count 2
  .amdhsa_user_sgpr_kernarg_segment_ptr 1
  .amdhsa_system_sgpr_workgroup_id_x 1
  .amdhsa_float_denorm_mode_32 3
.end_amdhsa_kernel
.section .rodata,"a"
.p2align 6
.amdhsa_kernel k2_kernel
  .amdhsa_next_free_vgpr 256
  .amdhsa_next_free_sgpr 100
  .amdhsa_accum_offset 256
  .amdhsa_group_segment_fixed_size 0
  .amdhsa_kernarg_size 96
  .amdhsa_user_sgpr_count 2
  .amdhsa_user_sgpr_kernarg_segment_ptr 1
  .amdhsa_system_sgpr_workgroup_id_x 1
  .amdhsa_float_denorm_mode_32 3
.end_amdhsa_kernel
.section .rodata,"a"
.p2align 6
.amdhsa_kernel kf_kernel
  .amdhsa_next_free_vgpr 512
  .amdhsa_next_free_sgpr 100
  .amdhsa_accum_offset 256
  .amdhsa_group_segment_fixed_size 0
  .amdhsa_kernarg_size 96
  .amdhsa_user_sgpr_count 2
  .amdhsa_user_sgpr_kernarg_segment_ptr 1
  .amdhsa_system_sgpr_workgroup_id_x 1
  .amdhsa_float_denorm_mode_32 3
.end_amdhsa_kernel
```
